```python
import torch

def _softmax(x, axis=-1):
    return torch.softmax(x, dim=axis)
def _gelu(x):
    return torch.nn.functional.gelu(x, approximate="tanh")
def _silu(x):
    return torch.nn.functional.silu(x)
def _sigmoid(x):
    return torch.sigmoid(x)
def _layernorm(x, axis=-1, eps=1e-5):
    m = x.mean(dim=axis, keepdim=True)
    v = x.var(dim=axis, keepdim=True, unbiased=False)
    return (x - m) / torch.sqrt(v + eps)
def _scatter_add(tgt, idx, src, axis=0):
    return tgt.clone().index_add_(axis, idx, src)
def _segment_sum(src, seg, n):
    out = torch.zeros((n,) + src.shape[1:], dtype=src.dtype)
    return out.index_add_(0, seg, src)
def _pad(x, pw):
    flat = tuple(v for pair in reversed(pw) for v in pair)
    return torch.nn.functional.pad(x, flat)

kernel_name = 'parallel_sum__ssm_conv_s4d__mixer_token_mlp__prompt'

def setup_inputs():

    _w = (lambda a: (lambda t: t.to(torch.bfloat16) if t.is_floating_point() else t)(torch.as_tensor(a)))
    def _A_setup():
        Bsz, L, D, N = 1, 2048, 576, 128
        return {
            "u": _w((lambda *s: torch.randn(*s, dtype=torch.bfloat16) * 0.05)(Bsz, L, D)),
            "log_A_real": _w((lambda *s: torch.randn(*s, dtype=torch.bfloat16) * 6.4)(D, N) * 0.5),
            "A_imag": _w((lambda *s: torch.randn(*s, dtype=torch.bfloat16) * 0.05)(D, N) * 3.14),
            "C_real": _w((lambda *s: torch.randn(*s, dtype=torch.bfloat16) * 0.05)(D, N) / N ** 0.5),
            "C_imag": _w((lambda *s: torch.randn(*s, dtype=torch.bfloat16) * 0.1)(D, N) / N ** 0.5),
            "log_dt": _w((lambda *s: torch.randn(*s, dtype=torch.bfloat16) * 0.05)(D) * 0.5 - 4.0),
            "D_skip": _w((lambda *s: torch.randn(*s, dtype=torch.bfloat16) * 0.05)(D)),
        }
    _A_in = _A_setup()

    def _B_setup():
        B, S, D, F = 1, 2048, 576, 4608
        return {
            "x": _w((lambda *s: torch.randn(*s, dtype=torch.bfloat16) * 0.05)(B, S, D)),
            "w1": _w((lambda *s: torch.randn(*s, dtype=torch.bfloat16) * 0.8)(S, F) * (S ** -0.5)),
            "b1": _w((lambda *s: torch.randn(*s, dtype=torch.bfloat16) * 12.8)(F) * 0.02),
            "w2": _w((lambda *s: torch.randn(*s, dtype=torch.bfloat16) * 0.2)(F, S) * (F ** -0.5)),
            "b2": _w((lambda *s: torch.randn(*s, dtype=torch.bfloat16) * 1.6)(S) * 0.02),
        }
    _B_in = _B_setup()

    return {
        "A_u": _A_in["u"],
        "A_log_A_real": _A_in["log_A_real"],
        "A_A_imag": _A_in["A_imag"],
        "A_C_real": _A_in["C_real"],
        "A_C_imag": _A_in["C_imag"],
        "A_log_dt": _A_in["log_dt"],
        "A_D_skip": _A_in["D_skip"],
        "B_x": _B_in["x"],
        "B_w1": _B_in["w1"],
        "B_b1": _B_in["b1"],
        "B_w2": _B_in["w2"],
        "B_b2": _B_in["b2"],
    }

def reference(A_u, A_log_A_real, A_A_imag, A_C_real, A_C_imag, A_log_dt, A_D_skip, B_x, B_w1, B_b1, B_w2, B_b2):
    def _A_ref(u, log_A_real, A_imag, C_real, C_imag, log_dt, D_skip):
        L = u.shape[1]
        dt = torch.exp(log_dt)
        A = -torch.exp(log_A_real) + 1j * A_imag
        C = (C_real + 1j * C_imag) * dt[:, None]
        pos = (lambda x, dt: x.to(dt))(torch.arange(L), log_dt.dtype)
        P = torch.exp((A * dt[:, None])[:, :, None] * pos[None, None, :])
        K = 2.0 * torch.einsum("dn,dnl->dl", C, P).real
        L2 = 2 * L
        u_t = (lambda x, *d: x.permute(*d))(u, 0, 2, 1)
        Kf = (lambda x, *a, **k: torch.fft.rfft(x.float(), *a, **k))(K, L2)
        Uf = (lambda x, *a, **k: torch.fft.rfft(x.float(), *a, **k))(u_t, L2)
        y = (lambda x, *a, **k: torch.fft.irfft(x, *a, **k).to(torch.bfloat16))(Uf * Kf[None, :, :], L2)[:, :, :L]
        y = (lambda x, *d: x.permute(*d))(y, 0, 2, 1)
        return y + u * D_skip[None, None, :]

    def _B_ref(x, w1, b1, w2, b2):
        B, S, D = x.shape
        h = _layernorm(x, axis=-1)
        u = torch.einsum("bsd,sf->bdf", h, w1) + b1
        u = _gelu(u)
        y = torch.einsum("bdf,fs->bds", u, w2) + b2
        return (lambda x, *d: x.permute(*d))(y, 0, 2, 1)

    x = A_u
    xn = _layernorm(x, axis=-1)
    return x + _A_ref(xn, A_log_A_real, A_A_imag, A_C_real, A_C_imag, A_log_dt, A_D_skip) + _B_ref(xn, B_w1, B_b1, B_w2, B_b2)
```

```asm
; @launch grid=(256,1,1) block=(512,1,1) lds=157696
.amdgcn_target "amdgcn-amd-amdhsa--gfx950"
.text
.p2align 8
.globl parallel_sum__ssm_conv_s4d__mixer_token_mlp__prompt_kernel
.type parallel_sum__ssm_conv_s4d__mixer_token_mlp__prompt_kernel,@function
parallel_sum__ssm_conv_s4d__mixer_token_mlp__prompt_kernel:
    s_cmp_ge_u32 s2, 256
    s_cbranch_scc1 k2_end
    s_load_dwordx16 s[84:99], s[0:1], 56
    s_load_dwordx2 s[6:7], s[0:1], 0
    s_load_dwordx2 s[8:9], s[0:1], 48
    v_lshrrev_b32 v1, 6, v0
    s_nop 0
    v_readfirstlane_b32 s10, v1
    v_and_b32 v1, 63, v0
    s_and_b32 s3, s2, 7
    s_lshr_b32 s11, s2, 3
    s_cmp_ge_u32 s11, 24
    s_cbranch_scc1 k2_cv
    s_mul_i32 s22, s3, 24
    s_add_u32 s22, s22, s11
    s_setprio 3
    s_cmp_lt_u32 s10, 4
    s_cbranch_scc1 ln_go
    s_setprio 0
    s_lshl_b32 s22, s3, 3
    s_add_u32 s22, s22, s11
    s_add_u32 s22, s22, 192
    s_cmp_lt_u32 s11, 8
    s_cbranch_scc1 ln_go
    v_mov_b32 v126, 157632
    v_mov_b64 v[128:129], 0
    v_mov_b64 v[130:131], 0
    ds_write_b128 v126, v[128:131]
    ds_write_b128 v126, v[128:131] offset:16
    s_waitcnt lgkmcnt(0)
    s_mov_b64 s[84:85], s[6:7]
    s_barrier
    s_branch ln_done
ln_go:
    s_and_b32 s23, s10, 3
    s_lshl_b32 s25, s22, 3
    s_lshl_b32 s28, s23, 1
    s_add_u32 s25, s25, s28
    v_lshrrev_b32 v4, 5, v1
    v_add_u32 v2, s25, v4
    v_mul_u32_u24 v2, 1152, v2
    v_and_b32 v3, 31, v1
    v_lshlrev_b32 v3, 2, v3
    v_add_u32 v2, v2, v3
    s_waitcnt lgkmcnt(0)
    s_mov_b32 s12, s6
    s_mov_b32 s13, s7
    s_mov_b32 s14, 2359296
    s_mov_b32 s15, 0x20000
    buffer_load_dword v8, v2, s[12:15], 0 offen offset:0
    buffer_load_dword v9, v2, s[12:15], 0 offen offset:128
    buffer_load_dword v10, v2, s[12:15], 0 offen offset:256
    buffer_load_dword v11, v2, s[12:15], 0 offen offset:384
    buffer_load_dword v12, v2, s[12:15], 0 offen offset:512
    buffer_load_dword v13, v2, s[12:15], 0 offen offset:640
    buffer_load_dword v14, v2, s[12:15], 0 offen offset:768
    buffer_load_dword v15, v2, s[12:15], 0 offen offset:896
    buffer_load_dword v16, v2, s[12:15], 0 offen offset:1024
    v_mov_b32 v126, 157632
    v_mov_b64 v[128:129], 0
    v_mov_b64 v[130:131], 0
    ds_write_b128 v126, v[128:131]
    ds_write_b128 v126, v[128:131] offset:16
    s_waitcnt lgkmcnt(0)
    s_mov_b64 s[84:85], s[6:7]
    s_barrier
    s_add_u32 s16, s98, 31850496
    s_addc_u32 s17, s99, 0
    s_mov_b32 s18, 73728
    s_mov_b32 s19, 0x20000
    s_cmp_lg_u32 s10, 0
    s_cbranch_scc1 ln_nz
    s_mul_i32 s31, s22, 384
    v_min_u32 v104, 23, v1
    v_lshlrev_b32 v104, 4, v104
    v_mov_b32 v108, 0
    v_mov_b32 v109, 0
    v_mov_b32 v110, 0
    v_mov_b32 v111, 0
    buffer_store_dwordx4 v[108:111], v104, s[16:19], s31 offen sc1
ln_nz:
    s_lshr_b32 s31, s10, 2
    s_mul_i32 s31, s31, 19712
    v_add_u32 v4, s28, v4
    v_mul_u32_u24 v4, 1216, v4
    v_add_u32 v4, v4, v3
    v_add_u32 v4, s31, v4
    s_and_b32 s29, s10, 1
    s_lshl_b32 s29, s29, 6
    v_bfe_u32 v5, v1, 2, 2
    v_mul_u32_u24 v5, 1216, v5
    v_and_b32 v6, 3, v1
    v_lshl_add_u32 v5, v6, 3, v5
    v_lshrrev_b32 v6, 4, v1
    v_lshl_add_u32 v5, v6, 5, v5
    s_lshl_b32 s30, s29, 1
    s_add_u32 s30, s30, s31
    v_add_u32 v5, s30, v5
    s_cmp_ge_u32 s23, 2
    s_cbranch_scc1 ln_xt
    s_mov_b32 s12, s98
    s_mov_b32 s13, s99
    s_mov_b32 s14, 2359296
    s_mov_b32 s15, 0x20000
    v_add_u32 v5, 9728, v5
    s_mul_i32 s30, s22, 2304
    v_add_u32 v6, s29, v1
    v_add_u32 v6, 0, v6
    v_mul_u32_u24 v7, 3641, v6
    v_lshrrev_b32 v7, 19, v7
    v_mul_u32_u24 v99, 144, v7
    v_sub_u32 v6, v6, v99
    v_and_b32 v99, 4, v6
    v_lshlrev_b32 v99, 2, v99
    v_and_b32 v100, 24, v6
    v_lshrrev_b32 v100, 1, v100
    v_or_b32 v99, v99, v100
    v_and_b32 v100, 0xe3, v6
    v_or_b32 v99, v99, v100
    v_lshrrev_b32 v100, 7, v6
    v_cmp_eq_u32 s[32:33], 0, v100
    s_nop 1
    v_cndmask_b32 v6, v6, v99, s[32:33]
    v_mul_u32_u24 v7, 589824, v7
    v_lshl_add_u32 v6, v6, 4, v7
    v_add_u32 v94, s30, v6
    v_add_u32 v6, s29, v1
    v_add_u32 v6, 128, v6
    v_mul_u32_u24 v7, 3641, v6
    v_lshrrev_b32 v7, 19, v7
    v_mul_u32_u24 v99, 144, v7
    v_sub_u32 v6, v6, v99
    v_and_b32 v99, 4, v6
    v_lshlrev_b32 v99, 2, v99
    v_and_b32 v100, 24, v6
    v_lshrrev_b32 v100, 1, v100
    v_or_b32 v99, v99, v100
    v_and_b32 v100, 0xe3, v6
    v_or_b32 v99, v99, v100
    v_lshrrev_b32 v100, 7, v6
    v_cmp_eq_u32 s[32:33], 0, v100
    s_nop 1
    v_cndmask_b32 v6, v6, v99, s[32:33]
    v_mul_u32_u24 v7, 589824, v7
    v_lshl_add_u32 v6, v6, 4, v7
    v_add_u32 v95, s30, v6
    v_add_u32 v6, s29, v1
    v_add_u32 v6, 256, v6
    v_mul_u32_u24 v7, 3641, v6
    v_lshrrev_b32 v7, 19, v7
    v_mul_u32_u24 v99, 144, v7
    v_sub_u32 v6, v6, v99
    v_and_b32 v99, 4, v6
    v_lshlrev_b32 v99, 2, v99
    v_and_b32 v100, 24, v6
    v_lshrrev_b32 v100, 1, v100
    v_or_b32 v99, v99, v100
    v_and_b32 v100, 0xe3, v6
    v_or_b32 v99, v99, v100
    v_lshrrev_b32 v100, 7, v6
    v_cmp_eq_u32 s[32:33], 0, v100
    s_nop 1
    v_cndmask_b32 v6, v6, v99, s[32:33]
    v_mul_u32_u24 v7, 589824, v7
    v_lshl_add_u32 v6, v6, 4, v7
    v_add_u32 v96, s30, v6
    v_add_u32 v6, s29, v1
    v_add_u32 v6, 384, v6
    v_mul_u32_u24 v7, 3641, v6
    v_lshrrev_b32 v7, 19, v7
    v_mul_u32_u24 v99, 144, v7
    v_sub_u32 v6, v6, v99
    v_and_b32 v99, 4, v6
    v_lshlrev_b32 v99, 2, v99
    v_and_b32 v100, 24, v6
    v_lshrrev_b32 v100, 1, v100
    v_or_b32 v99, v99, v100
    v_and_b32 v100, 0xe3, v6
    v_or_b32 v99, v99, v100
    v_lshrrev_b32 v100, 7, v6
    v_cmp_eq_u32 s[32:33], 0, v100
    s_nop 1
    v_cndmask_b32 v6, v6, v99, s[32:33]
    v_mul_u32_u24 v7, 589824, v7
    v_lshl_add_u32 v6, v6, 4, v7
    v_add_u32 v97, s30, v6
    v_add_u32 v6, s29, v1
    v_add_u32 v6, 512, v6
    v_mul_u32_u24 v7, 3641, v6
    v_lshrrev_b32 v7, 19, v7
    v_mul_u32_u24 v99, 144, v7
    v_sub_u32 v6, v6, v99
    v_and_b32 v99, 4, v6
    v_lshlrev_b32 v99, 2, v99
    v_and_b32 v100, 24, v6
    v_lshrrev_b32 v100, 1, v100
    v_or_b32 v99, v99, v100
    v_and_b32 v100, 0xe3, v6
    v_or_b32 v99, v99, v100
    v_lshrrev_b32 v100, 7, v6
    v_cmp_eq_u32 s[32:33], 0, v100
    s_nop 1
    v_cndmask_b32 v6, v6, v99, s[32:33]
    v_mul_u32_u24 v7, 589824, v7
    v_lshl_add_u32 v6, v6, 4, v7
    v_add_u32 v98, s30, v6
    s_branch ln_c
ln_xt:
    s_add_u32 s12, s98, 2359296
    s_addc_u32 s13, s99, 0
    s_mov_b32 s14, 2359296
    s_mov_b32 s15, 0x20000
    s_lshl_b32 s30, s22, 7
    v_add_u32 v6, s29, v1
    v_lshrrev_b32 v7, 3, v6
    v_and_b32 v99, 7, v6
    v_lshlrev_b32 v99, 4, v99
    v_lshl_add_u32 v7, v7, 15, v99
    v_add_u32 v7, s30, v7
    v_add_u32 v94, 0, v7
    v_add_u32 v95, 524288, v7
    v_add_u32 v96, 1048576, v7
    v_add_u32 v97, 1572864, v7
    v_add_u32 v98, 2097152, v7
ln_c:
    s_cmp_eq_u32 s10, 0
    s_cbranch_scc1 ln_c0
    s_waitcnt vmcnt(0)
ln_c0:
    s_waitcnt vmcnt(1)
    v_lshlrev_b32 v26, 16, v8
    v_and_b32 v27, 0xffff0000, v8
    v_lshlrev_b32 v28, 16, v9
    v_and_b32 v29, 0xffff0000, v9
    v_lshlrev_b32 v30, 16, v10
    v_and_b32 v31, 0xffff0000, v10
    v_lshlrev_b32 v32, 16, v11
    v_and_b32 v33, 0xffff0000, v11
    v_lshlrev_b32 v34, 16, v12
    v_and_b32 v35, 0xffff0000, v12
    v_lshlrev_b32 v36, 16, v13
    v_and_b32 v37, 0xffff0000, v13
    v_lshlrev_b32 v38, 16, v14
    v_and_b32 v39, 0xffff0000, v14
    v_lshlrev_b32 v40, 16, v15
    v_and_b32 v41, 0xffff0000, v15
    v_lshlrev_b32 v42, 16, v16
    v_and_b32 v43, 0xffff0000, v16
    v_pk_add_f32 v[44:45], v[26:27], v[28:29]
    v_pk_add_f32 v[46:47], v[30:31], v[32:33]
    v_pk_add_f32 v[48:49], v[34:35], v[36:37]
    v_pk_add_f32 v[50:51], v[38:39], v[40:41]
    v_pk_add_f32 v[44:45], v[44:45], v[42:43]
    v_pk_add_f32 v[46:47], v[46:47], v[48:49]
    v_pk_add_f32 v[44:45], v[44:45], v[50:51]
    v_pk_add_f32 v[72:73], v[44:45], v[46:47]
    v_add_f32 v72, v72, v73
    s_nop 1
    v_add_f32_dpp v72, v72, v72 quad_perm:[1,0,3,2] row_mask:0xf bank_mask:0xf
    s_nop 1
    v_add_f32_dpp v72, v72, v72 quad_perm:[2,3,0,1] row_mask:0xf bank_mask:0xf
    s_nop 1
    v_add_f32_dpp v72, v72, v72 row_half_mirror row_mask:0xf bank_mask:0xf
    s_nop 1
    v_add_f32_dpp v72, v72, v72 row_mirror row_mask:0xf bank_mask:0xf
    v_mov_b32 v73, v72
    s_nop 1
    v_permlane16_swap_b32 v72, v73
    v_add_f32 v72, v72, v73
    v_mul_f32 v72, 0x3ae38e39, v72
    v_pk_add_f32 v[44:45], v[26:27], v[72:73] op_sel:[0,0] op_sel_hi:[1,0] neg_lo:[0,1] neg_hi:[0,1]
    v_pk_add_f32 v[46:47], v[28:29], v[72:73] op_sel:[0,0] op_sel_hi:[1,0] neg_lo:[0,1] neg_hi:[0,1]
    v_pk_add_f32 v[48:49], v[30:31], v[72:73] op_sel:[0,0] op_sel_hi:[1,0] neg_lo:[0,1] neg_hi:[0,1]
    v_pk_add_f32 v[50:51], v[32:33], v[72:73] op_sel:[0,0] op_sel_hi:[1,0] neg_lo:[0,1] neg_hi:[0,1]
    v_pk_add_f32 v[52:53], v[34:35], v[72:73] op_sel:[0,0] op_sel_hi:[1,0] neg_lo:[0,1] neg_hi:[0,1]
    v_pk_add_f32 v[54:55], v[36:37], v[72:73] op_sel:[0,0] op_sel_hi:[1,0] neg_lo:[0,1] neg_hi:[0,1]
    v_pk_add_f32 v[56:57], v[38:39], v[72:73] op_sel:[0,0] op_sel_hi:[1,0] neg_lo:[0,1] neg_hi:[0,1]
    v_pk_add_f32 v[58:59], v[40:41], v[72:73] op_sel:[0,0] op_sel_hi:[1,0] neg_lo:[0,1] neg_hi:[0,1]
    v_pk_add_f32 v[60:61], v[42:43], v[72:73] op_sel:[0,0] op_sel_hi:[1,0] neg_lo:[0,1] neg_hi:[0,1]
    v_pk_mul_f32 v[44:45], v[44:45], v[44:45]
    v_pk_mul_f32 v[46:47], v[46:47], v[46:47]
    v_pk_mul_f32 v[48:49], v[48:49], v[48:49]
    v_pk_fma_f32 v[44:45], v[50:51], v[50:51], v[44:45]
    v_pk_fma_f32 v[46:47], v[52:53], v[52:53], v[46:47]
    v_pk_fma_f32 v[48:49], v[54:55], v[54:55], v[48:49]
    v_pk_fma_f32 v[44:45], v[56:57], v[56:57], v[44:45]
    v_pk_fma_f32 v[46:47], v[58:59], v[58:59], v[46:47]
    v_pk_fma_f32 v[48:49], v[60:61], v[60:61], v[48:49]
    v_pk_add_f32 v[44:45], v[44:45], v[46:47]
    v_pk_add_f32 v[74:75], v[44:45], v[48:49]
    v_add_f32 v74, v74, v75
    v_cvt_pk_bf16_f32 v72, v72, v72
    v_and_b32 v72, 0xffff0000, v72
    v_pk_add_f32 v[44:45], v[26:27], v[72:73] op_sel:[0,0] op_sel_hi:[1,0] neg_lo:[0,1] neg_hi:[0,1]
    v_pk_add_f32 v[46:47], v[28:29], v[72:73] op_sel:[0,0] op_sel_hi:[1,0] neg_lo:[0,1] neg_hi:[0,1]
    v_pk_add_f32 v[48:49], v[30:31], v[72:73] op_sel:[0,0] op_sel_hi:[1,0] neg_lo:[0,1] neg_hi:[0,1]
    v_pk_add_f32 v[50:51], v[32:33], v[72:73] op_sel:[0,0] op_sel_hi:[1,0] neg_lo:[0,1] neg_hi:[0,1]
    v_pk_add_f32 v[52:53], v[34:35], v[72:73] op_sel:[0,0] op_sel_hi:[1,0] neg_lo:[0,1] neg_hi:[0,1]
    v_pk_add_f32 v[54:55], v[36:37], v[72:73] op_sel:[0,0] op_sel_hi:[1,0] neg_lo:[0,1] neg_hi:[0,1]
    v_pk_add_f32 v[56:57], v[38:39], v[72:73] op_sel:[0,0] op_sel_hi:[1,0] neg_lo:[0,1] neg_hi:[0,1]
    v_pk_add_f32 v[58:59], v[40:41], v[72:73] op_sel:[0,0] op_sel_hi:[1,0] neg_lo:[0,1] neg_hi:[0,1]
    v_pk_add_f32 v[60:61], v[42:43], v[72:73] op_sel:[0,0] op_sel_hi:[1,0] neg_lo:[0,1] neg_hi:[0,1]
    v_add_f32_dpp v74, v74, v74 quad_perm:[1,0,3,2] row_mask:0xf bank_mask:0xf
    s_nop 1
    v_add_f32_dpp v74, v74, v74 quad_perm:[2,3,0,1] row_mask:0xf bank_mask:0xf
    s_nop 1
    v_add_f32_dpp v74, v74, v74 row_half_mirror row_mask:0xf bank_mask:0xf
    s_nop 1
    v_add_f32_dpp v74, v74, v74 row_mirror row_mask:0xf bank_mask:0xf
    v_mov_b32 v75, v74
    s_nop 1
    v_permlane16_swap_b32 v74, v75
    v_add_f32 v74, v74, v75
    v_mul_f32 v74, 0x3ae38e39, v74
    v_cvt_pk_bf16_f32 v74, v74, v74
    v_and_b32 v74, 0xffff0000, v74
    v_add_f32 v74, 0x3727c5ac, v74
    v_cvt_pk_bf16_f32 v74, v74, v74
    v_and_b32 v74, 0xffff0000, v74
    v_sqrt_f32 v74, v74
    v_cvt_pk_bf16_f32 v62, v44, v45
    v_cvt_pk_bf16_f32 v63, v46, v47
    v_cvt_pk_bf16_f32 v64, v48, v49
    v_cvt_pk_bf16_f32 v65, v50, v51
    v_cvt_pk_bf16_f32 v66, v52, v53
    v_cvt_pk_bf16_f32 v67, v54, v55
    v_cvt_pk_bf16_f32 v68, v56, v57
    v_cvt_pk_bf16_f32 v69, v58, v59
    v_cvt_pk_bf16_f32 v70, v60, v61
    v_cvt_pk_bf16_f32 v74, v74, v74
    v_and_b32 v74, 0xffff0000, v74
    v_rcp_f32 v74, v74
    v_lshlrev_b32 v44, 16, v62
    v_and_b32 v45, 0xffff0000, v62
    v_lshlrev_b32 v46, 16, v63
    v_and_b32 v47, 0xffff0000, v63
    v_lshlrev_b32 v48, 16, v64
    v_and_b32 v49, 0xffff0000, v64
    v_lshlrev_b32 v50, 16, v65
    v_and_b32 v51, 0xffff0000, v65
    v_lshlrev_b32 v52, 16, v66
    v_and_b32 v53, 0xffff0000, v66
    v_lshlrev_b32 v54, 16, v67
    v_and_b32 v55, 0xffff0000, v67
    v_lshlrev_b32 v56, 16, v68
    v_and_b32 v57, 0xffff0000, v68
    v_lshlrev_b32 v58, 16, v69
    v_and_b32 v59, 0xffff0000, v69
    v_lshlrev_b32 v60, 16, v70
    v_and_b32 v61, 0xffff0000, v70
    v_pk_mul_f32 v[44:45], v[44:45], v[74:75] op_sel:[0,0] op_sel_hi:[1,0]
    v_pk_mul_f32 v[46:47], v[46:47], v[74:75] op_sel:[0,0] op_sel_hi:[1,0]
    v_pk_mul_f32 v[48:49], v[48:49], v[74:75] op_sel:[0,0] op_sel_hi:[1,0]
    v_pk_mul_f32 v[50:51], v[50:51], v[74:75] op_sel:[0,0] op_sel_hi:[1,0]
    v_pk_mul_f32 v[52:53], v[52:53], v[74:75] op_sel:[0,0] op_sel_hi:[1,0]
    v_pk_mul_f32 v[54:55], v[54:55], v[74:75] op_sel:[0,0] op_sel_hi:[1,0]
    v_pk_mul_f32 v[56:57], v[56:57], v[74:75] op_sel:[0,0] op_sel_hi:[1,0]
    v_pk_mul_f32 v[58:59], v[58:59], v[74:75] op_sel:[0,0] op_sel_hi:[1,0]
    v_pk_mul_f32 v[60:61], v[60:61], v[74:75] op_sel:[0,0] op_sel_hi:[1,0]
    v_cvt_pk_bf16_f32 v62, v44, v45
    v_cvt_pk_bf16_f32 v63, v46, v47
    v_cvt_pk_bf16_f32 v64, v48, v49
    v_cvt_pk_bf16_f32 v65, v50, v51
    v_cvt_pk_bf16_f32 v66, v52, v53
    v_cvt_pk_bf16_f32 v67, v54, v55
    v_cvt_pk_bf16_f32 v68, v56, v57
    v_cvt_pk_bf16_f32 v69, v58, v59
    v_cvt_pk_bf16_f32 v70, v60, v61
    v_lshlrev_b32 v76, 16, v62
    v_and_b32 v77, 0xffff0000, v62
    v_lshlrev_b32 v78, 16, v63
    v_and_b32 v79, 0xffff0000, v63
    v_lshlrev_b32 v80, 16, v64
    v_and_b32 v81, 0xffff0000, v64
    v_lshlrev_b32 v82, 16, v65
    v_and_b32 v83, 0xffff0000, v65
    v_lshlrev_b32 v84, 16, v66
    v_and_b32 v85, 0xffff0000, v66
    v_lshlrev_b32 v86, 16, v67
    v_and_b32 v87, 0xffff0000, v67
    v_lshlrev_b32 v88, 16, v68
    v_and_b32 v89, 0xffff0000, v68
    v_lshlrev_b32 v90, 16, v69
    v_and_b32 v91, 0xffff0000, v69
    v_lshlrev_b32 v92, 16, v70
    v_and_b32 v93, 0xffff0000, v70
    ds_write_b32 v4, v62 offset:0
    ds_write_b32 v4, v63 offset:128
    ds_write_b32 v4, v64 offset:256
    ds_write_b32 v4, v65 offset:384
    ds_write_b32 v4, v66 offset:512
    ds_write_b32 v4, v67 offset:640
    ds_write_b32 v4, v68 offset:768
    ds_write_b32 v4, v69 offset:896
    ds_write_b32 v4, v70 offset:1024
    s_mov_b32 s4, s96
    s_mov_b32 s5, s97
    s_mov_b32 s6, 256
    s_mov_b32 s7, 0x20000
    v_mov_b32 v124, 0
    buffer_load_dword v125, v124, s[4:7], 0 offen sc1
    v_pk_add_f32 v[44:45], v[76:77], v[78:79]
    v_pk_add_f32 v[46:47], v[80:81], v[82:83]
    v_pk_add_f32 v[48:49], v[84:85], v[86:87]
    v_pk_add_f32 v[50:51], v[88:89], v[90:91]
    v_pk_add_f32 v[44:45], v[44:45], v[92:93]
    v_pk_add_f32 v[46:47], v[46:47], v[48:49]
    v_pk_add_f32 v[44:45], v[44:45], v[50:51]
    v_pk_add_f32 v[72:73], v[44:45], v[46:47]
    v_add_f32 v72, v72, v73
    s_nop 1
    v_add_f32_dpp v72, v72, v72 quad_perm:[1,0,3,2] row_mask:0xf bank_mask:0xf
    s_nop 1
    v_add_f32_dpp v72, v72, v72 quad_perm:[2,3,0,1] row_mask:0xf bank_mask:0xf
    s_nop 1
    v_add_f32_dpp v72, v72, v72 row_half_mirror row_mask:0xf bank_mask:0xf
    s_nop 1
    v_add_f32_dpp v72, v72, v72 row_mirror row_mask:0xf bank_mask:0xf
    v_mov_b32 v73, v72
    s_nop 1
    v_permlane16_swap_b32 v72, v73
    v_add_f32 v72, v72, v73
    v_mul_f32 v72, 0x3ae38e39, v72
    v_pk_add_f32 v[44:45], v[76:77], v[72:73] op_sel:[0,0] op_sel_hi:[1,0] neg_lo:[0,1] neg_hi:[0,1]
    v_pk_add_f32 v[46:47], v[78:79], v[72:73] op_sel:[0,0] op_sel_hi:[1,0] neg_lo:[0,1] neg_hi:[0,1]
    v_pk_add_f32 v[48:49], v[80:81], v[72:73] op_sel:[0,0] op_sel_hi:[1,0] neg_lo:[0,1] neg_hi:[0,1]
    v_pk_add_f32 v[50:51], v[82:83], v[72:73] op_sel:[0,0] op_sel_hi:[1,0] neg_lo:[0,1] neg_hi:[0,1]
    v_pk_add_f32 v[52:53], v[84:85], v[72:73] op_sel:[0,0] op_sel_hi:[1,0] neg_lo:[0,1] neg_hi:[0,1]
    v_pk_add_f32 v[54:55], v[86:87], v[72:73] op_sel:[0,0] op_sel_hi:[1,0] neg_lo:[0,1] neg_hi:[0,1]
    v_pk_add_f32 v[56:57], v[88:89], v[72:73] op_sel:[0,0] op_sel_hi:[1,0] neg_lo:[0,1] neg_hi:[0,1]
    v_pk_add_f32 v[58:59], v[90:91], v[72:73] op_sel:[0,0] op_sel_hi:[1,0] neg_lo:[0,1] neg_hi:[0,1]
    v_pk_add_f32 v[60:61], v[92:93], v[72:73] op_sel:[0,0] op_sel_hi:[1,0] neg_lo:[0,1] neg_hi:[0,1]
    v_pk_mul_f32 v[44:45], v[44:45], v[44:45]
    v_pk_mul_f32 v[46:47], v[46:47], v[46:47]
    v_pk_mul_f32 v[48:49], v[48:49], v[48:49]
    v_pk_fma_f32 v[44:45], v[50:51], v[50:51], v[44:45]
    v_pk_fma_f32 v[46:47], v[52:53], v[52:53], v[46:47]
    v_pk_fma_f32 v[48:49], v[54:55], v[54:55], v[48:49]
    v_pk_fma_f32 v[44:45], v[56:57], v[56:57], v[44:45]
    v_pk_fma_f32 v[46:47], v[58:59], v[58:59], v[46:47]
    v_pk_fma_f32 v[48:49], v[60:61], v[60:61], v[48:49]
    v_pk_add_f32 v[44:45], v[44:45], v[46:47]
    v_pk_add_f32 v[74:75], v[44:45], v[48:49]
    v_add_f32 v74, v74, v75
    v_cvt_pk_bf16_f32 v72, v72, v72
    v_and_b32 v72, 0xffff0000, v72
    v_pk_add_f32 v[44:45], v[76:77], v[72:73] op_sel:[0,0] op_sel_hi:[1,0] neg_lo:[0,1] neg_hi:[0,1]
    v_pk_add_f32 v[46:47], v[78:79], v[72:73] op_sel:[0,0] op_sel_hi:[1,0] neg_lo:[0,1] neg_hi:[0,1]
    v_pk_add_f32 v[48:49], v[80:81], v[72:73] op_sel:[0,0] op_sel_hi:[1,0] neg_lo:[0,1] neg_hi:[0,1]
    v_pk_add_f32 v[50:51], v[82:83], v[72:73] op_sel:[0,0] op_sel_hi:[1,0] neg_lo:[0,1] neg_hi:[0,1]
    v_pk_add_f32 v[52:53], v[84:85], v[72:73] op_sel:[0,0] op_sel_hi:[1,0] neg_lo:[0,1] neg_hi:[0,1]
    v_pk_add_f32 v[54:55], v[86:87], v[72:73] op_sel:[0,0] op_sel_hi:[1,0] neg_lo:[0,1] neg_hi:[0,1]
    v_pk_add_f32 v[56:57], v[88:89], v[72:73] op_sel:[0,0] op_sel_hi:[1,0] neg_lo:[0,1] neg_hi:[0,1]
    v_pk_add_f32 v[58:59], v[90:91], v[72:73] op_sel:[0,0] op_sel_hi:[1,0] neg_lo:[0,1] neg_hi:[0,1]
    v_pk_add_f32 v[60:61], v[92:93], v[72:73] op_sel:[0,0] op_sel_hi:[1,0] neg_lo:[0,1] neg_hi:[0,1]
    v_add_f32_dpp v74, v74, v74 quad_perm:[1,0,3,2] row_mask:0xf bank_mask:0xf
    s_nop 1
    v_add_f32_dpp v74, v74, v74 quad_perm:[2,3,0,1] row_mask:0xf bank_mask:0xf
    s_nop 1
    v_add_f32_dpp v74, v74, v74 row_half_mirror row_mask:0xf bank_mask:0xf
    s_nop 1
    v_add_f32_dpp v74, v74, v74 row_mirror row_mask:0xf bank_mask:0xf
    v_mov_b32 v75, v74
    s_nop 1
    v_permlane16_swap_b32 v74, v75
    v_add_f32 v74, v74, v75
    v_mul_f32 v74, 0x3ae38e39, v74
    v_cvt_pk_bf16_f32 v74, v74, v74
    v_and_b32 v74, 0xffff0000, v74
    v_add_f32 v74, 0x3727c5ac, v74
    v_cvt_pk_bf16_f32 v74, v74, v74
    v_and_b32 v74, 0xffff0000, v74
    v_sqrt_f32 v74, v74
    v_cvt_pk_bf16_f32 v62, v44, v45
    v_cvt_pk_bf16_f32 v63, v46, v47
    v_cvt_pk_bf16_f32 v64, v48, v49
    v_cvt_pk_bf16_f32 v65, v50, v51
    v_cvt_pk_bf16_f32 v66, v52, v53
    v_cvt_pk_bf16_f32 v67, v54, v55
    v_cvt_pk_bf16_f32 v68, v56, v57
    v_cvt_pk_bf16_f32 v69, v58, v59
    v_cvt_pk_bf16_f32 v70, v60, v61
    v_cvt_pk_bf16_f32 v74, v74, v74
    v_and_b32 v74, 0xffff0000, v74
    v_rcp_f32 v74, v74
    v_lshlrev_b32 v44, 16, v62
    v_and_b32 v45, 0xffff0000, v62
    v_lshlrev_b32 v46, 16, v63
    v_and_b32 v47, 0xffff0000, v63
    v_lshlrev_b32 v48, 16, v64
    v_and_b32 v49, 0xffff0000, v64
    v_lshlrev_b32 v50, 16, v65
    v_and_b32 v51, 0xffff0000, v65
    v_lshlrev_b32 v52, 16, v66
    v_and_b32 v53, 0xffff0000, v66
    v_lshlrev_b32 v54, 16, v67
    v_and_b32 v55, 0xffff0000, v67
    v_lshlrev_b32 v56, 16, v68
    v_and_b32 v57, 0xffff0000, v68
    v_lshlrev_b32 v58, 16, v69
    v_and_b32 v59, 0xffff0000, v69
    v_lshlrev_b32 v60, 16, v70
    v_and_b32 v61, 0xffff0000, v70
    v_pk_mul_f32 v[44:45], v[44:45], v[74:75] op_sel:[0,0] op_sel_hi:[1,0]
    v_pk_mul_f32 v[46:47], v[46:47], v[74:75] op_sel:[0,0] op_sel_hi:[1,0]
    v_pk_mul_f32 v[48:49], v[48:49], v[74:75] op_sel:[0,0] op_sel_hi:[1,0]
    v_pk_mul_f32 v[50:51], v[50:51], v[74:75] op_sel:[0,0] op_sel_hi:[1,0]
    v_pk_mul_f32 v[52:53], v[52:53], v[74:75] op_sel:[0,0] op_sel_hi:[1,0]
    v_pk_mul_f32 v[54:55], v[54:55], v[74:75] op_sel:[0,0] op_sel_hi:[1,0]
    v_pk_mul_f32 v[56:57], v[56:57], v[74:75] op_sel:[0,0] op_sel_hi:[1,0]
    v_pk_mul_f32 v[58:59], v[58:59], v[74:75] op_sel:[0,0] op_sel_hi:[1,0]
    v_pk_mul_f32 v[60:61], v[60:61], v[74:75] op_sel:[0,0] op_sel_hi:[1,0]
    v_cvt_pk_bf16_f32 v62, v44, v45
    v_cvt_pk_bf16_f32 v63, v46, v47
    v_cvt_pk_bf16_f32 v64, v48, v49
    v_cvt_pk_bf16_f32 v65, v50, v51
    v_cvt_pk_bf16_f32 v66, v52, v53
    v_cvt_pk_bf16_f32 v67, v54, v55
    v_cvt_pk_bf16_f32 v68, v56, v57
    v_cvt_pk_bf16_f32 v69, v58, v59
    v_cvt_pk_bf16_f32 v70, v60, v61
    ds_write_b32 v4, v62 offset:9728
    ds_write_b32 v4, v63 offset:9856
    ds_write_b32 v4, v64 offset:9984
    ds_write_b32 v4, v65 offset:10112
    ds_write_b32 v4, v66 offset:10240
    ds_write_b32 v4, v67 offset:10368
    ds_write_b32 v4, v68 offset:10496
    ds_write_b32 v4, v69 offset:10624
    ds_write_b32 v4, v70 offset:10752
    s_waitcnt vmcnt(0)
    s_lshr_b32 s31, s10, 2
    s_lshl_b32 s25, s31, 3
    v_add_u32 v126, s25, v126
    v_mov_b32 v127, 1
    s_mov_b64 exec, 1
    ds_add_u32 v126, v127
    s_mov_b64 exec, -1
    s_mov_b32 s24, 0
ln_w:
    ds_read_b32 v124, v126
    s_add_u32 s24, s24, 1
    s_waitcnt lgkmcnt(0)
    v_readfirstlane_b32 s25, v124
    s_cmp_ge_u32 s24, 0x400000
    s_cbranch_scc1 ln_wd
    s_cmp_lt_u32 s25, 4
    s_cbranch_scc1 ln_w
ln_wd:
    ds_read_b64_tr_b16 v[104:105], v5 offset:0
    ds_read_b64_tr_b16 v[106:107], v5 offset:4864
    ds_read_b64_tr_b16 v[108:109], v5 offset:256
    ds_read_b64_tr_b16 v[110:111], v5 offset:5120
    ds_read_b64_tr_b16 v[112:113], v5 offset:512
    ds_read_b64_tr_b16 v[114:115], v5 offset:5376
    ds_read_b64_tr_b16 v[116:117], v5 offset:768
    ds_read_b64_tr_b16 v[118:119], v5 offset:5632
    ds_read_b64_tr_b16 v[120:121], v5 offset:1024
    ds_read_b64_tr_b16 v[122:123], v5 offset:5888
    s_cmp_ge_u32 s23, 2
    s_cbranch_scc1 ln_x2
    s_waitcnt lgkmcnt(8)
    buffer_store_dwordx4 v[104:107], v94, s[12:15], 0 offen sc1
    s_waitcnt lgkmcnt(6)
    buffer_store_dwordx4 v[108:111], v95, s[12:15], 0 offen sc1
    s_waitcnt lgkmcnt(4)
    buffer_store_dwordx4 v[112:115], v96, s[12:15], 0 offen sc1
    s_waitcnt lgkmcnt(2)
    buffer_store_dwordx4 v[116:119], v97, s[12:15], 0 offen sc1
    s_waitcnt lgkmcnt(0)
    buffer_store_dwordx4 v[120:123], v98, s[12:15], 0 offen sc1
    s_waitcnt vmcnt(0)
    s_mov_b64 exec, 1
    ds_add_rtn_u32 v124, v126, v127 offset:4
    s_mov_b64 exec, -1
    s_waitcnt lgkmcnt(0)
    v_readfirstlane_b32 s25, v124
    s_nop 1
    s_cmp_lg_u32 s25, 1
    s_cbranch_scc1 ln_h2
    s_cmp_lg_u32 s31, 0
    s_cbranch_scc1 ln_h2
    v_readfirstlane_b32 s25, v125
    s_nop 1
    s_cmp_lg_u32 s25, 0
    s_cbranch_scc1 lna_g
    s_mov_b32 s4, s96
    s_mov_b32 s5, s97
    s_mov_b32 s6, 256
    s_mov_b32 s7, 0x20000
    v_and_b32 v70, 0, v1
    v_lshlrev_b32 v70, 7, v70
    v_add_u32 v70, 0, v70
    s_mov_b32 s24, 0
lnago_p:
    buffer_load_dword v71, v70, s[4:7], 0 offen sc1
    s_add_u32 s24, s24, 1
    s_waitcnt vmcnt(0)
    v_cmp_gt_u32 vcc, 1, v71
    s_cmp_ge_u32 s24, 0x40000
    s_cbranch_scc1 lnago_g
    s_cmp_eq_u64 vcc, 0
    s_cbranch_scc1 lnago_g
    s_sleep 8
    s_branch lnago_p
lnago_g:
lna_g:
    v_mov_b32 v124, 157660
    ds_write_b32 v124, v127
    s_add_u32 s4, s98, 31850496
    s_addc_u32 s5, s99, 0
    s_mov_b32 s6, 83968
    s_mov_b32 s7, 0x20000
    s_lshl_b32 s25, 0, 3
    s_add_u32 s25, s25, s3
    s_lshl_b32 s25, s25, 7
    s_add_u32 s25, s25, 73728
    v_mov_b32 v70, s25
    v_mov_b32 v71, 1
    s_mov_b64 exec, 1
    buffer_atomic_add v71, v70, s[4:7], 0 offen sc0 sc1
    s_mov_b64 exec, -1
    s_lshl_b32 s25, 0, 11
    s_add_u32 s25, s25, 75776
    v_lshlrev_b32 v72, 7, v1
    v_add_u32 v72, s25, v72
    s_waitcnt vmcnt(0)
    v_readfirstlane_b32 s25, v71
    s_nop 1
    s_cmp_lg_u32 s25, 23
    s_cbranch_scc1 ln_h2
    s_mov_b64 exec, 0xffff
    buffer_atomic_add v127, v72, s[4:7], 0 offen sc1
    s_mov_b64 exec, -1
ln_h2:
    s_branch ln_b
ln_x2:
    v_add_u32 v132, 4, v126
    s_mov_b32 s24, 0
ln_xw:
    ds_read_b32 v133, v132
    s_add_u32 s24, s24, 1
    s_waitcnt lgkmcnt(0)
    v_readfirstlane_b32 s25, v133
    s_cmp_ge_u32 s24, 0x400000
    s_cbranch_scc1 ln_xg
    s_cmp_ge_u32 s25, 2
    s_cbranch_scc1 ln_xg
    s_sleep 1
    s_branch ln_xw
ln_xg:
    s_waitcnt lgkmcnt(8)
    buffer_store_dwordx4 v[104:107], v94, s[12:15], 0 offen sc1
    s_waitcnt lgkmcnt(6)
    buffer_store_dwordx4 v[108:111], v95, s[12:15], 0 offen sc1
    s_waitcnt lgkmcnt(4)
    buffer_store_dwordx4 v[112:115], v96, s[12:15], 0 offen sc1
    s_waitcnt lgkmcnt(2)
    buffer_store_dwordx4 v[116:119], v97, s[12:15], 0 offen sc1
    s_waitcnt lgkmcnt(0)
    buffer_store_dwordx4 v[120:123], v98, s[12:15], 0 offen sc1
    s_waitcnt vmcnt(0)
ln_b:
    s_mov_b64 exec, 1
    ds_add_rtn_u32 v124, v126, v127 offset:16
    s_mov_b64 exec, -1
    s_waitcnt lgkmcnt(0)
    v_readfirstlane_b32 s25, v124
    s_nop 1
    s_cmp_lg_u32 s25, 3
    s_cbranch_scc1 ln_done
    v_readfirstlane_b32 s25, v125
    s_nop 1
    s_cmp_lg_u32 s25, 0
    s_cbranch_scc1 lnb_g
    s_mov_b32 s4, s96
    s_mov_b32 s5, s97
    s_mov_b32 s6, 256
    s_mov_b32 s7, 0x20000
    v_and_b32 v70, 0, v1
    v_lshlrev_b32 v70, 7, v70
    v_add_u32 v70, 0, v70
    s_mov_b32 s24, 0
lnbgo_p:
    buffer_load_dword v71, v70, s[4:7], 0 offen sc1
    s_add_u32 s24, s24, 1
    s_waitcnt vmcnt(0)
    v_cmp_gt_u32 vcc, 1, v71
    s_cmp_ge_u32 s24, 0x40000
    s_cbranch_scc1 lnbgo_g
    s_cmp_eq_u64 vcc, 0
    s_cbranch_scc1 lnbgo_g
    s_sleep 8
    s_branch lnbgo_p
lnbgo_g:
lnb_g:
    v_mov_b32 v124, 157660
    ds_write_b32 v124, v127
    s_add_u32 s4, s98, 31850496
    s_addc_u32 s5, s99, 0
    s_mov_b32 s6, 83968
    s_mov_b32 s7, 0x20000
    s_lshl_b32 s25, 1, 3
    s_add_u32 s25, s25, s3
    s_lshl_b32 s25, s25, 7
    s_add_u32 s25, s25, 73728
    v_mov_b32 v70, s25
    v_mov_b32 v71, 1
    s_mov_b64 exec, 1
    buffer_atomic_add v71, v70, s[4:7], 0 offen sc0 sc1
    s_mov_b64 exec, -1
    s_lshl_b32 s25, 1, 11
    s_add_u32 s25, s25, 75776
    v_lshlrev_b32 v72, 7, v1
    v_add_u32 v72, s25, v72
    s_waitcnt vmcnt(0)
    v_readfirstlane_b32 s25, v71
    s_nop 1
    s_cmp_lg_u32 s25, 31
    s_cbranch_scc1 ln_done
    s_mov_b64 exec, 0xffff
    buffer_atomic_add v127, v72, s[4:7], 0 offen sc1
    s_mov_b64 exec, -1
ln_done:
    s_setprio 0
    s_sub_u32 s22, s11, 18
    s_cmp_ge_u32 s11, 18
    s_cselect_b32 s22, s22, s11
    s_and_b32 s25, s3, 1
    s_mul_i32 s25, s25, 18
    s_add_u32 s27, s22, s25
    s_and_b32 s29, s27, 3
    s_lshr_b32 s28, s27, 2
    s_lshr_b32 s25, s3, 1
    s_mul_i32 s24, s25, 9
    s_add_u32 s28, s28, s24
    s_mul_i32 s25, s25, 36
    s_add_u32 s27, s27, s25
    s_lshr_b32 s24, s3, 1
    s_lshl_b32 s23, s24, 2
    s_add_u32 s23, s23, s29
    s_sub_u32 s23, s23, s24
    s_mul_i32 s23, s23, 9
    s_add_u32 s23, s23, s28
    s_lshl_b32 s23, s23, 7
    s_add_u32 s23, s23, 53248
    s_cmp_ge_u32 s11, 18
    s_cselect_b32 s23, 0, s23
    s_cmp_ge_u32 s10, 4
    s_cbranch_scc0 g1_cons
    v_lshlrev_b32 v2, 4, v1
    v_lshrrev_b32 v7, 4, v1
    v_and_b32 v8, 15, v1
    v_lshlrev_b32 v10, 1, v7
    v_xor_b32 v10, v10, v8
    v_xor_b32 v10, 0, v10
    v_add_u32 v9, 0, v7
    v_mul_u32_u24 v9, 9216, v9
    v_lshl_add_u32 v9, v10, 4, v9
    v_subrev_u32 v3, 0, v9
    v_lshlrev_b32 v10, 1, v7
    v_xor_b32 v10, v10, v8
    v_xor_b32 v10, 0, v10
    v_add_u32 v9, 4, v7
    v_mul_u32_u24 v9, 9216, v9
    v_lshl_add_u32 v9, v10, 4, v9
    v_subrev_u32 v4, 1024, v9
    v_lshlrev_b32 v10, 1, v7
    v_xor_b32 v10, v10, v8
    v_xor_b32 v10, 8, v10
    v_add_u32 v9, 8, v7
    v_mul_u32_u24 v9, 9216, v9
    v_lshl_add_u32 v9, v10, 4, v9
    v_subrev_u32 v5, 2048, v9
    v_lshlrev_b32 v10, 1, v7
    v_xor_b32 v10, v10, v8
    v_xor_b32 v10, 8, v10
    v_add_u32 v9, 12, v7
    v_mul_u32_u24 v9, 9216, v9
    v_lshl_add_u32 v9, v10, 4, v9
    v_subrev_u32 v6, 3072, v9
    s_mul_i32 s20, s29, 589824
    s_lshl_b32 s21, s28, 8
    s_lshr_b32 s30, s11, 2
    s_mov_b32 s12, s98
    s_mov_b32 s13, s99
    s_mov_b32 s14, 2359296
    s_mov_b32 s15, 0x20000
    s_mov_b32 s16, s86
    s_mov_b32 s17, s87
    s_mov_b32 s18, 18874368
    s_mov_b32 s19, 0x20000
    v_mov_b32 v70, 157660
    s_mov_b32 s24, 0
g1go:
    ds_read_b32 v71, v70
    s_add_u32 s24, s24, 1
    s_waitcnt lgkmcnt(0)
    v_readfirstlane_b32 s25, v71
    s_cmp_ge_u32 s24, 0x400000
    s_cbranch_scc1 g1go_d
    s_cmp_ge_u32 s25, 1
    s_cbranch_scc1 g1go_d
    s_sleep 2
    s_branch g1go
g1go_d:
    s_cmp_ge_u32 s11, 18
    s_cbranch_scc1 g1_hload
    s_add_u32 s20, s20, 0
    s_add_u32 s21, s21, 0
    s_lshl_b32 s62, s27, 7
    s_add_u32 s56, s62, 34816
    s_add_u32 s31, s30, 1
    s_cmp_ge_u32 s31, 6
    s_cselect_b32 s25, 6, 0
    s_sub_u32 s31, s31, s25
    s_add_u32 s32, s30, 2
    s_cmp_ge_u32 s32, 6
    s_cselect_b32 s25, 6, 0
    s_sub_u32 s32, s32, s25
    s_add_u32 s33, s30, 3
    s_cmp_ge_u32 s33, 6
    s_cselect_b32 s25, 6, 0
    s_sub_u32 s33, s33, s25
    s_add_u32 s34, s30, 4
    s_cmp_ge_u32 s34, 6
    s_cselect_b32 s25, 6, 0
    s_sub_u32 s34, s34, s25
    s_add_u32 s35, s30, 5
    s_cmp_ge_u32 s35, 6
    s_cselect_b32 s25, 6, 0
    s_sub_u32 s35, s35, s25
    s_add_u32 s36, s29, 1
    s_cmp_ge_u32 s36, 4
    s_cselect_b32 s25, 4, 0
    s_sub_u32 s36, s36, s25
    s_add_u32 s37, s29, 2
    s_cmp_ge_u32 s37, 4
    s_cselect_b32 s25, 4, 0
    s_sub_u32 s37, s37, s25
    s_add_u32 s38, s29, 3
    s_cmp_ge_u32 s38, 4
    s_cselect_b32 s25, 4, 0
    s_sub_u32 s38, s38, s25
    s_setprio 3
    s_cmp_eq_u32 s10, 5
    s_cbranch_scc1 g1l_5
    s_cmp_eq_u32 s10, 6
    s_cbranch_scc1 g1l_6
    s_cmp_eq_u32 s10, 7
    s_cbranch_scc1 g1l_7
    s_mul_i32 s41, s30, 3072
    s_add_u32 s40, s41, s20
    s_mul_i32 s43, s31, 3072
    s_add_u32 s42, s43, s20
    s_mov_b32 s44, 0
    s_mov_b32 s45, 0
    s_mul_i32 s46, s29, 147456
    s_add_u32 s46, s46, s21
    s_mul_i32 s47, s29, 4096
    s_add_u32 s47, s47, 73728
    s_mov_b32 s48, 0
    s_mov_b32 s49, 0
    s_mov_b32 m0, s47
    s_add_u32 s47, s47, 16384
    buffer_load_dwordx4 v3, s[16:19], s46 offen offset:0  lds
    buffer_load_dwordx4 v4, s[16:19], s46 offen offset:1024  lds
    buffer_load_dwordx4 v5, s[16:19], s46 offen offset:2048  lds
    buffer_load_dwordx4 v6, s[16:19], s46 offen offset:3072  lds
    s_add_u32 s46, s46, 589824
    s_mov_b32 m0, s47
    s_add_u32 s47, s47, 16384
    buffer_load_dwordx4 v3, s[16:19], s46 offen offset:0  lds
    buffer_load_dwordx4 v4, s[16:19], s46 offen offset:1024  lds
    buffer_load_dwordx4 v5, s[16:19], s46 offen offset:2048  lds
    buffer_load_dwordx4 v6, s[16:19], s46 offen offset:3072  lds
    s_add_u32 s46, s46, 589824
    s_add_u32 s4, s98, 31850496
    s_addc_u32 s5, s99, 0
    s_mov_b32 s6, 83968
    s_mov_b32 s7, 0x20000
    s_and_b32 s24, s2, 15
    s_lshl_b32 s24, s24, 7
    s_add_u32 s62, s24, 75776
    v_mov_b32 v70, s62
    s_mov_b64 exec, 1
    s_mov_b32 s24, 0
g1mln_p:
    buffer_load_dword v71, v70, s[4:7], 0 offen sc1
    s_add_u32 s24, s24, 1
    s_waitcnt vmcnt(0)
    v_readfirstlane_b32 s25, v71
    s_cmp_ge_u32 s24, 0x40000
    s_cbranch_scc1 g1mln_g
    s_cmp_ge_u32 s25, 8
    s_cbranch_scc1 g1mln_g
    s_sleep 2
    s_branch g1mln_p
g1mln_g:
    s_mov_b64 exec, -1
    s_barrier
    s_mov_b32 m0, s41
    s_add_u32 s41, s41, 18432
    buffer_load_dwordx4 v2, s[12:15], s40 offen offset:0 sc1 lds
    buffer_load_dwordx4 v2, s[12:15], s40 offen offset:1024 sc1 lds
    buffer_load_dwordx4 v2, s[12:15], s40 offen offset:2048 sc1 lds
    s_add_u32 s40, s40, 18432
    s_mov_b32 m0, s43
    s_add_u32 s43, s43, 18432
    buffer_load_dwordx4 v2, s[12:15], s42 offen offset:0 sc1 lds
    s_add_u32 s42, s42, 18432
    s_add_u32 s44, s44, 1
    s_cmp_lg_u32 s44, 4
    s_cbranch_scc1 g1l4_w0
    s_mov_b32 s44, 0
    s_sub_u32 s41, s41, 73728
    s_sub_u32 s43, s43, 73728
g1l4_w0:
    s_add_u32 s48, s48, 1
    s_cmp_lg_u32 s48, 4
    s_cbranch_scc1 g1l4_w1
    s_mov_b32 s48, 0
    s_sub_u32 s47, s47, 65536
g1l4_w1:
    s_mov_b32 m0, s41
    s_add_u32 s41, s41, 18432
    buffer_load_dwordx4 v2, s[12:15], s40 offen offset:0 sc1 lds
    buffer_load_dwordx4 v2, s[12:15], s40 offen offset:1024 sc1 lds
    buffer_load_dwordx4 v2, s[12:15], s40 offen offset:2048 sc1 lds
    s_add_u32 s40, s40, 18432
    s_mov_b32 m0, s43
    s_add_u32 s43, s43, 18432
    buffer_load_dwordx4 v2, s[12:15], s42 offen offset:0 sc1 lds
    s_add_u32 s42, s42, 18432
    s_add_u32 s44, s44, 1
    s_cmp_lg_u32 s44, 4
    s_cbranch_scc1 g1l4_w2
    s_mov_b32 s44, 0
    s_sub_u32 s41, s41, 73728
    s_sub_u32 s43, s43, 73728
g1l4_w2:
    s_add_u32 s48, s48, 1
    s_cmp_lg_u32 s48, 4
    s_cbranch_scc1 g1l4_w3
    s_mov_b32 s48, 0
    s_sub_u32 s47, s47, 65536
g1l4_w3:
    s_waitcnt vmcnt(4)
    s_barrier
    s_mov_b32 m0, s41
    s_add_u32 s41, s41, 18432
    buffer_load_dwordx4 v2, s[12:15], s40 offen offset:0 sc1 lds
    buffer_load_dwordx4 v2, s[12:15], s40 offen offset:1024 sc1 lds
    buffer_load_dwordx4 v2, s[12:15], s40 offen offset:2048 sc1 lds
    s_add_u32 s40, s40, 18432
    s_mov_b32 m0, s43
    s_add_u32 s43, s43, 18432
    buffer_load_dwordx4 v2, s[12:15], s42 offen offset:0 sc1 lds
    s_add_u32 s42, s42, 18432
    s_add_u32 s44, s44, 1
    s_cmp_lg_u32 s44, 4
    s_cbranch_scc1 g1l4_w4
    s_mov_b32 s44, 0
    s_sub_u32 s41, s41, 73728
    s_sub_u32 s43, s43, 73728
g1l4_w4:
    s_mov_b32 m0, s47
    s_add_u32 s47, s47, 16384
    buffer_load_dwordx4 v3, s[16:19], s46 offen offset:0  lds
    buffer_load_dwordx4 v4, s[16:19], s46 offen offset:1024  lds
    buffer_load_dwordx4 v5, s[16:19], s46 offen offset:2048  lds
    buffer_load_dwordx4 v6, s[16:19], s46 offen offset:3072  lds
    s_add_u32 s46, s46, 589824
    s_add_u32 s48, s48, 1
    s_cmp_lg_u32 s48, 4
    s_cbranch_scc1 g1l4_w5
    s_mov_b32 s48, 0
    s_sub_u32 s47, s47, 65536
g1l4_w5:
    s_mov_b32 s26, 0
g1l4_loop:
    s_waitcnt vmcnt(8)
    s_cmp_lg_u32 s26, 20
    s_cbranch_scc1 g1l4_c21
    v_cmp_gt_u32 vcc, 8, v75
    s_nop 1
    s_cmp_eq_u64 vcc, 0
    s_cbranch_scc1 g1l4_c21
    s_and_b32 s24, s2, 15
    s_lshl_b32 s24, s24, 7
    s_add_u32 s62, s24, 77824
    v_mov_b32 v70, s62
    s_mov_b64 exec, 1
    s_mov_b32 s24, 0
g1lo_p:
    buffer_load_dword v71, v70, s[4:7], 0 offen sc1
    s_add_u32 s24, s24, 1
    s_waitcnt vmcnt(0)
    v_readfirstlane_b32 s25, v71
    s_cmp_ge_u32 s24, 0x40000
    s_cbranch_scc1 g1lo_g
    s_cmp_ge_u32 s25, 8
    s_cbranch_scc1 g1lo_g
    s_sleep 2
    s_branch g1lo_p
g1lo_g:
    s_mov_b64 exec, -1
g1l4_c21:
    s_barrier
    s_cmp_lg_u32 s26, 19
    s_cbranch_scc1 g1l4_a21
    s_and_b32 s24, s2, 15
    s_lshl_b32 s24, s24, 7
    s_add_u32 s24, s24, 77824
    v_mov_b32 v74, s24
    buffer_load_dword v75, v74, s[4:7], 0 offen sc1
g1l4_a21:
    s_mov_b32 m0, s41
    s_add_u32 s41, s41, 18432
    buffer_load_dwordx4 v2, s[12:15], s40 offen offset:0 sc1 lds
    buffer_load_dwordx4 v2, s[12:15], s40 offen offset:1024 sc1 lds
    buffer_load_dwordx4 v2, s[12:15], s40 offen offset:2048 sc1 lds
    s_add_u32 s40, s40, 18432
    s_mov_b32 m0, s43
    s_add_u32 s43, s43, 18432
    buffer_load_dwordx4 v2, s[12:15], s42 offen offset:0 sc1 lds
    s_add_u32 s42, s42, 18432
    s_add_u32 s44, s44, 1
    s_cmp_lg_u32 s44, 4
    s_cbranch_scc1 g1l4_w6
    s_mov_b32 s44, 0
    s_sub_u32 s41, s41, 73728
    s_sub_u32 s43, s43, 73728
g1l4_w6:
    s_mov_b32 m0, s47
    s_add_u32 s47, s47, 16384
    buffer_load_dwordx4 v3, s[16:19], s46 offen offset:0  lds
    buffer_load_dwordx4 v4, s[16:19], s46 offen offset:1024  lds
    buffer_load_dwordx4 v5, s[16:19], s46 offen offset:2048  lds
    buffer_load_dwordx4 v6, s[16:19], s46 offen offset:3072  lds
    s_add_u32 s46, s46, 589824
    s_add_u32 s48, s48, 1
    s_cmp_lg_u32 s48, 4
    s_cbranch_scc1 g1l4_w7
    s_mov_b32 s48, 0
    s_sub_u32 s47, s47, 65536
g1l4_w7:
    s_add_u32 s26, s26, 1
    s_cmp_lt_u32 s26, 29
    s_cbranch_scc1 g1l4_loop
    s_waitcnt vmcnt(8)
    s_barrier
    s_waitcnt vmcnt(0)
    s_barrier
    s_branch g2_load
g1l_5:
    s_mul_i32 s41, s32, 3072
    s_add_u32 s40, s41, s20
    s_mul_i32 s43, s31, 3072
    s_add_u32 s42, s43, s20
    s_mov_b32 s44, 0
    s_mov_b32 s45, 0
    s_mul_i32 s46, s36, 147456
    s_add_u32 s46, s46, s21
    s_mul_i32 s47, s36, 4096
    s_add_u32 s47, s47, 73728
    s_mov_b32 s48, 0
    s_mov_b32 s49, 0
    s_mov_b32 m0, s47
    s_add_u32 s47, s47, 16384
    buffer_load_dwordx4 v3, s[16:19], s46 offen offset:0  lds
    buffer_load_dwordx4 v4, s[16:19], s46 offen offset:1024  lds
    buffer_load_dwordx4 v5, s[16:19], s46 offen offset:2048  lds
    buffer_load_dwordx4 v6, s[16:19], s46 offen offset:3072  lds
    s_add_u32 s46, s46, 589824
    s_mov_b32 m0, s47
    s_add_u32 s47, s47, 16384
    buffer_load_dwordx4 v3, s[16:19], s46 offen offset:0  lds
    buffer_load_dwordx4 v4, s[16:19], s46 offen offset:1024  lds
    buffer_load_dwordx4 v5, s[16:19], s46 offen offset:2048  lds
    buffer_load_dwordx4 v6, s[16:19], s46 offen offset:3072  lds
    s_add_u32 s46, s46, 589824
    s_barrier
    s_mov_b32 m0, s41
    s_add_u32 s41, s41, 18432
    buffer_load_dwordx4 v2, s[12:15], s40 offen offset:0 sc1 lds
    buffer_load_dwordx4 v2, s[12:15], s40 offen offset:1024 sc1 lds
    buffer_load_dwordx4 v2, s[12:15], s40 offen offset:2048 sc1 lds
    s_add_u32 s40, s40, 18432
    s_mov_b32 m0, s43
    s_add_u32 s43, s43, 18432
    buffer_load_dwordx4 v2, s[12:15], s42 offen offset:1024 sc1 lds
    buffer_load_dwordx4 v2, s[12:15], s42 offen offset:2048 sc1 lds
    s_add_u32 s42, s42, 18432
    s_add_u32 s44, s44, 1
    s_cmp_lg_u32 s44, 4
    s_cbranch_scc1 g1l5_w0
    s_mov_b32 s44, 0
    s_sub_u32 s41, s41, 73728
    s_sub_u32 s43, s43, 73728
g1l5_w0:
    s_add_u32 s48, s48, 1
    s_cmp_lg_u32 s48, 4
    s_cbranch_scc1 g1l5_w1
    s_mov_b32 s48, 0
    s_sub_u32 s47, s47, 65536
g1l5_w1:
    s_mov_b32 m0, s41
    s_add_u32 s41, s41, 18432
    buffer_load_dwordx4 v2, s[12:15], s40 offen offset:0 sc1 lds
    buffer_load_dwordx4 v2, s[12:15], s40 offen offset:1024 sc1 lds
    buffer_load_dwordx4 v2, s[12:15], s40 offen offset:2048 sc1 lds
    s_add_u32 s40, s40, 18432
    s_mov_b32 m0, s43
    s_add_u32 s43, s43, 18432
    buffer_load_dwordx4 v2, s[12:15], s42 offen offset:1024 sc1 lds
    buffer_load_dwordx4 v2, s[12:15], s42 offen offset:2048 sc1 lds
    s_add_u32 s42, s42, 18432
    s_add_u32 s44, s44, 1
    s_cmp_lg_u32 s44, 4
    s_cbranch_scc1 g1l5_w2
    s_mov_b32 s44, 0
    s_sub_u32 s41, s41, 73728
    s_sub_u32 s43, s43, 73728
g1l5_w2:
    s_add_u32 s48, s48, 1
    s_cmp_lg_u32 s48, 4
    s_cbranch_scc1 g1l5_w3
    s_mov_b32 s48, 0
    s_sub_u32 s47, s47, 65536
g1l5_w3:
    s_waitcnt vmcnt(5)
    s_barrier
    s_mov_b32 m0, s41
    s_add_u32 s41, s41, 18432
    buffer_load_dwordx4 v2, s[12:15], s40 offen offset:0 sc1 lds
    buffer_load_dwordx4 v2, s[12:15], s40 offen offset:1024 sc1 lds
    buffer_load_dwordx4 v2, s[12:15], s40 offen offset:2048 sc1 lds
    s_add_u32 s40, s40, 18432
    s_mov_b32 m0, s43
    s_add_u32 s43, s43, 18432
    buffer_load_dwordx4 v2, s[12:15], s42 offen offset:1024 sc1 lds
    buffer_load_dwordx4 v2, s[12:15], s42 offen offset:2048 sc1 lds
    s_add_u32 s42, s42, 18432
    s_add_u32 s44, s44, 1
    s_cmp_lg_u32 s44, 4
    s_cbranch_scc1 g1l5_w4
    s_mov_b32 s44, 0
    s_sub_u32 s41, s41, 73728
    s_sub_u32 s43, s43, 73728
g1l5_w4:
    s_mov_b32 m0, s47
    s_add_u32 s47, s47, 16384
    buffer_load_dwordx4 v3, s[16:19], s46 offen offset:0  lds
    buffer_load_dwordx4 v4, s[16:19], s46 offen offset:1024  lds
    buffer_load_dwordx4 v5, s[16:19], s46 offen offset:2048  lds
    buffer_load_dwordx4 v6, s[16:19], s46 offen offset:3072  lds
    s_add_u32 s46, s46, 589824
    s_add_u32 s48, s48, 1
    s_cmp_lg_u32 s48, 4
    s_cbranch_scc1 g1l5_w5
    s_mov_b32 s48, 0
    s_sub_u32 s47, s47, 65536
g1l5_w5:
    s_mov_b32 s26, 0
g1l5_loop:
    s_waitcnt vmcnt(9)
    s_barrier
    s_mov_b32 m0, s41
    s_add_u32 s41, s41, 18432
    buffer_load_dwordx4 v2, s[12:15], s40 offen offset:0 sc1 lds
    buffer_load_dwordx4 v2, s[12:15], s40 offen offset:1024 sc1 lds
    buffer_load_dwordx4 v2, s[12:15], s40 offen offset:2048 sc1 lds
    s_add_u32 s40, s40, 18432
    s_mov_b32 m0, s43
    s_add_u32 s43, s43, 18432
    buffer_load_dwordx4 v2, s[12:15], s42 offen offset:1024 sc1 lds
    buffer_load_dwordx4 v2, s[12:15], s42 offen offset:2048 sc1 lds
    s_add_u32 s42, s42, 18432
    s_add_u32 s44, s44, 1
    s_cmp_lg_u32 s44, 4
    s_cbranch_scc1 g1l5_w6
    s_mov_b32 s44, 0
    s_sub_u32 s41, s41, 73728
    s_sub_u32 s43, s43, 73728
g1l5_w6:
    s_mov_b32 m0, s47
    s_add_u32 s47, s47, 16384
    buffer_load_dwordx4 v3, s[16:19], s46 offen offset:0  lds
    buffer_load_dwordx4 v4, s[16:19], s46 offen offset:1024  lds
    buffer_load_dwordx4 v5, s[16:19], s46 offen offset:2048  lds
    buffer_load_dwordx4 v6, s[16:19], s46 offen offset:3072  lds
    s_add_u32 s46, s46, 589824
    s_add_u32 s48, s48, 1
    s_cmp_lg_u32 s48, 4
    s_cbranch_scc1 g1l5_w7
    s_mov_b32 s48, 0
    s_sub_u32 s47, s47, 65536
g1l5_w7:
    s_add_u32 s26, s26, 1
    s_cmp_lt_u32 s26, 29
    s_cbranch_scc1 g1l5_loop
    s_waitcnt vmcnt(9)
    s_barrier
    s_waitcnt vmcnt(0)
    s_barrier
    s_branch g2_load
g1l_6:
    s_mul_i32 s41, s33, 3072
    s_add_u32 s40, s41, s20
    s_mul_i32 s43, s34, 3072
    s_add_u32 s42, s43, s20
    s_mov_b32 s44, 0
    s_mov_b32 s45, 0
    s_mul_i32 s46, s37, 147456
    s_add_u32 s46, s46, s21
    s_mul_i32 s47, s37, 4096
    s_add_u32 s47, s47, 73728
    s_mov_b32 s48, 0
    s_mov_b32 s49, 0
    s_mov_b32 m0, s47
    s_add_u32 s47, s47, 16384
    buffer_load_dwordx4 v3, s[16:19], s46 offen offset:0  lds
    buffer_load_dwordx4 v4, s[16:19], s46 offen offset:1024  lds
    buffer_load_dwordx4 v5, s[16:19], s46 offen offset:2048  lds
    buffer_load_dwordx4 v6, s[16:19], s46 offen offset:3072  lds
    s_add_u32 s46, s46, 589824
    s_mov_b32 m0, s47
    s_add_u32 s47, s47, 16384
    buffer_load_dwordx4 v3, s[16:19], s46 offen offset:0  lds
    buffer_load_dwordx4 v4, s[16:19], s46 offen offset:1024  lds
    buffer_load_dwordx4 v5, s[16:19], s46 offen offset:2048  lds
    buffer_load_dwordx4 v6, s[16:19], s46 offen offset:3072  lds
    s_add_u32 s46, s46, 589824
    s_barrier
    s_mov_b32 m0, s41
    s_add_u32 s41, s41, 18432
    buffer_load_dwordx4 v2, s[12:15], s40 offen offset:0 sc1 lds
    buffer_load_dwordx4 v2, s[12:15], s40 offen offset:1024 sc1 lds
    buffer_load_dwordx4 v2, s[12:15], s40 offen offset:2048 sc1 lds
    s_add_u32 s40, s40, 18432
    s_mov_b32 m0, s43
    s_add_u32 s43, s43, 18432
    buffer_load_dwordx4 v2, s[12:15], s42 offen offset:0 sc1 lds
    s_add_u32 s42, s42, 18432
    s_add_u32 s44, s44, 1
    s_cmp_lg_u32 s44, 4
    s_cbranch_scc1 g1l6_w0
    s_mov_b32 s44, 0
    s_sub_u32 s41, s41, 73728
    s_sub_u32 s43, s43, 73728
g1l6_w0:
    s_add_u32 s48, s48, 1
    s_cmp_lg_u32 s48, 4
    s_cbranch_scc1 g1l6_w1
    s_mov_b32 s48, 0
    s_sub_u32 s47, s47, 65536
g1l6_w1:
    s_mov_b32 m0, s41
    s_add_u32 s41, s41, 18432
    buffer_load_dwordx4 v2, s[12:15], s40 offen offset:0 sc1 lds
    buffer_load_dwordx4 v2, s[12:15], s40 offen offset:1024 sc1 lds
    buffer_load_dwordx4 v2, s[12:15], s40 offen offset:2048 sc1 lds
    s_add_u32 s40, s40, 18432
    s_mov_b32 m0, s43
    s_add_u32 s43, s43, 18432
    buffer_load_dwordx4 v2, s[12:15], s42 offen offset:0 sc1 lds
    s_add_u32 s42, s42, 18432
    s_add_u32 s44, s44, 1
    s_cmp_lg_u32 s44, 4
    s_cbranch_scc1 g1l6_w2
    s_mov_b32 s44, 0
    s_sub_u32 s41, s41, 73728
    s_sub_u32 s43, s43, 73728
g1l6_w2:
    s_add_u32 s48, s48, 1
    s_cmp_lg_u32 s48, 4
    s_cbranch_scc1 g1l6_w3
    s_mov_b32 s48, 0
    s_sub_u32 s47, s47, 65536
g1l6_w3:
    s_waitcnt vmcnt(4)
    s_barrier
    s_mov_b32 m0, s41
    s_add_u32 s41, s41, 18432
    buffer_load_dwordx4 v2, s[12:15], s40 offen offset:0 sc1 lds
    buffer_load_dwordx4 v2, s[12:15], s40 offen offset:1024 sc1 lds
    buffer_load_dwordx4 v2, s[12:15], s40 offen offset:2048 sc1 lds
    s_add_u32 s40, s40, 18432
    s_mov_b32 m0, s43
    s_add_u32 s43, s43, 18432
    buffer_load_dwordx4 v2, s[12:15], s42 offen offset:0 sc1 lds
    s_add_u32 s42, s42, 18432
    s_add_u32 s44, s44, 1
    s_cmp_lg_u32 s44, 4
    s_cbranch_scc1 g1l6_w4
    s_mov_b32 s44, 0
    s_sub_u32 s41, s41, 73728
    s_sub_u32 s43, s43, 73728
g1l6_w4:
    s_mov_b32 m0, s47
    s_add_u32 s47, s47, 16384
    buffer_load_dwordx4 v3, s[16:19], s46 offen offset:0  lds
    buffer_load_dwordx4 v4, s[16:19], s46 offen offset:1024  lds
    buffer_load_dwordx4 v5, s[16:19], s46 offen offset:2048  lds
    buffer_load_dwordx4 v6, s[16:19], s46 offen offset:3072  lds
    s_add_u32 s46, s46, 589824
    s_add_u32 s48, s48, 1
    s_cmp_lg_u32 s48, 4
    s_cbranch_scc1 g1l6_w5
    s_mov_b32 s48, 0
    s_sub_u32 s47, s47, 65536
g1l6_w5:
    s_mov_b32 s26, 0
g1l6_loop:
    s_waitcnt vmcnt(8)
    s_barrier
    s_mov_b32 m0, s41
    s_add_u32 s41, s41, 18432
    buffer_load_dwordx4 v2, s[12:15], s40 offen offset:0 sc1 lds
    buffer_load_dwordx4 v2, s[12:15], s40 offen offset:1024 sc1 lds
    buffer_load_dwordx4 v2, s[12:15], s40 offen offset:2048 sc1 lds
    s_add_u32 s40, s40, 18432
    s_mov_b32 m0, s43
    s_add_u32 s43, s43, 18432
    buffer_load_dwordx4 v2, s[12:15], s42 offen offset:0 sc1 lds
    s_add_u32 s42, s42, 18432
    s_add_u32 s44, s44, 1
    s_cmp_lg_u32 s44, 4
    s_cbranch_scc1 g1l6_w6
    s_mov_b32 s44, 0
    s_sub_u32 s41, s41, 73728
    s_sub_u32 s43, s43, 73728
g1l6_w6:
    s_mov_b32 m0, s47
    s_add_u32 s47, s47, 16384
    buffer_load_dwordx4 v3, s[16:19], s46 offen offset:0  lds
    buffer_load_dwordx4 v4, s[16:19], s46 offen offset:1024  lds
    buffer_load_dwordx4 v5, s[16:19], s46 offen offset:2048  lds
    buffer_load_dwordx4 v6, s[16:19], s46 offen offset:3072  lds
    s_add_u32 s46, s46, 589824
    s_add_u32 s48, s48, 1
    s_cmp_lg_u32 s48, 4
    s_cbranch_scc1 g1l6_w7
    s_mov_b32 s48, 0
    s_sub_u32 s47, s47, 65536
g1l6_w7:
    s_add_u32 s26, s26, 1
    s_cmp_lt_u32 s26, 29
    s_cbranch_scc1 g1l6_loop
    s_waitcnt vmcnt(8)
    s_barrier
    s_waitcnt vmcnt(0)
    s_barrier
    s_branch g2_load
g1l_7:
    s_mul_i32 s41, s35, 3072
    s_add_u32 s40, s41, s20
    s_mul_i32 s43, s34, 3072
    s_add_u32 s42, s43, s20
    s_mov_b32 s44, 0
    s_mov_b32 s45, 0
    s_mul_i32 s46, s38, 147456
    s_add_u32 s46, s46, s21
    s_mul_i32 s47, s38, 4096
    s_add_u32 s47, s47, 73728
    s_mov_b32 s48, 0
    s_mov_b32 s49, 0
    s_mov_b32 m0, s47
    s_add_u32 s47, s47, 16384
    buffer_load_dwordx4 v3, s[16:19], s46 offen offset:0  lds
    buffer_load_dwordx4 v4, s[16:19], s46 offen offset:1024  lds
    buffer_load_dwordx4 v5, s[16:19], s46 offen offset:2048  lds
    buffer_load_dwordx4 v6, s[16:19], s46 offen offset:3072  lds
    s_add_u32 s46, s46, 589824
    s_mov_b32 m0, s47
    s_add_u32 s47, s47, 16384
    buffer_load_dwordx4 v3, s[16:19], s46 offen offset:0  lds
    buffer_load_dwordx4 v4, s[16:19], s46 offen offset:1024  lds
    buffer_load_dwordx4 v5, s[16:19], s46 offen offset:2048  lds
    buffer_load_dwordx4 v6, s[16:19], s46 offen offset:3072  lds
    s_add_u32 s46, s46, 589824
    s_barrier
    s_mov_b32 m0, s41
    s_add_u32 s41, s41, 18432
    buffer_load_dwordx4 v2, s[12:15], s40 offen offset:0 sc1 lds
    buffer_load_dwordx4 v2, s[12:15], s40 offen offset:1024 sc1 lds
    buffer_load_dwordx4 v2, s[12:15], s40 offen offset:2048 sc1 lds
    s_add_u32 s40, s40, 18432
    s_mov_b32 m0, s43
    s_add_u32 s43, s43, 18432
    buffer_load_dwordx4 v2, s[12:15], s42 offen offset:1024 sc1 lds
    buffer_load_dwordx4 v2, s[12:15], s42 offen offset:2048 sc1 lds
    s_add_u32 s42, s42, 18432
    s_add_u32 s44, s44, 1
    s_cmp_lg_u32 s44, 4
    s_cbranch_scc1 g1l7_w0
    s_mov_b32 s44, 0
    s_sub_u32 s41, s41, 73728
    s_sub_u32 s43, s43, 73728
g1l7_w0:
    s_add_u32 s48, s48, 1
    s_cmp_lg_u32 s48, 4
    s_cbranch_scc1 g1l7_w1
    s_mov_b32 s48, 0
    s_sub_u32 s47, s47, 65536
g1l7_w1:
    s_mov_b32 m0, s41
    s_add_u32 s41, s41, 18432
    buffer_load_dwordx4 v2, s[12:15], s40 offen offset:0 sc1 lds
    buffer_load_dwordx4 v2, s[12:15], s40 offen offset:1024 sc1 lds
    buffer_load_dwordx4 v2, s[12:15], s40 offen offset:2048 sc1 lds
    s_add_u32 s40, s40, 18432
    s_mov_b32 m0, s43
    s_add_u32 s43, s43, 18432
    buffer_load_dwordx4 v2, s[12:15], s42 offen offset:1024 sc1 lds
    buffer_load_dwordx4 v2, s[12:15], s42 offen offset:2048 sc1 lds
    s_add_u32 s42, s42, 18432
    s_add_u32 s44, s44, 1
    s_cmp_lg_u32 s44, 4
    s_cbranch_scc1 g1l7_w2
    s_mov_b32 s44, 0
    s_sub_u32 s41, s41, 73728
    s_sub_u32 s43, s43, 73728
g1l7_w2:
    s_add_u32 s48, s48, 1
    s_cmp_lg_u32 s48, 4
    s_cbranch_scc1 g1l7_w3
    s_mov_b32 s48, 0
    s_sub_u32 s47, s47, 65536
g1l7_w3:
    s_waitcnt vmcnt(5)
    s_barrier
    s_mov_b32 m0, s41
    s_add_u32 s41, s41, 18432
    buffer_load_dwordx4 v2, s[12:15], s40 offen offset:0 sc1 lds
    buffer_load_dwordx4 v2, s[12:15], s40 offen offset:1024 sc1 lds
    buffer_load_dwordx4 v2, s[12:15], s40 offen offset:2048 sc1 lds
    s_add_u32 s40, s40, 18432
    s_mov_b32 m0, s43
    s_add_u32 s43, s43, 18432
    buffer_load_dwordx4 v2, s[12:15], s42 offen offset:1024 sc1 lds
    buffer_load_dwordx4 v2, s[12:15], s42 offen offset:2048 sc1 lds
    s_add_u32 s42, s42, 18432
    s_add_u32 s44, s44, 1
    s_cmp_lg_u32 s44, 4
    s_cbranch_scc1 g1l7_w4
    s_mov_b32 s44, 0
    s_sub_u32 s41, s41, 73728
    s_sub_u32 s43, s43, 73728
g1l7_w4:
    s_mov_b32 m0, s47
    s_add_u32 s47, s47, 16384
    buffer_load_dwordx4 v3, s[16:19], s46 offen offset:0  lds
    buffer_load_dwordx4 v4, s[16:19], s46 offen offset:1024  lds
    buffer_load_dwordx4 v5, s[16:19], s46 offen offset:2048  lds
    buffer_load_dwordx4 v6, s[16:19], s46 offen offset:3072  lds
    s_add_u32 s46, s46, 589824
    s_add_u32 s48, s48, 1
    s_cmp_lg_u32 s48, 4
    s_cbranch_scc1 g1l7_w5
    s_mov_b32 s48, 0
    s_sub_u32 s47, s47, 65536
g1l7_w5:
    s_mov_b32 s26, 0
g1l7_loop:
    s_waitcnt vmcnt(9)
    s_barrier
    s_mov_b32 m0, s41
    s_add_u32 s41, s41, 18432
    buffer_load_dwordx4 v2, s[12:15], s40 offen offset:0 sc1 lds
    buffer_load_dwordx4 v2, s[12:15], s40 offen offset:1024 sc1 lds
    buffer_load_dwordx4 v2, s[12:15], s40 offen offset:2048 sc1 lds
    s_add_u32 s40, s40, 18432
    s_mov_b32 m0, s43
    s_add_u32 s43, s43, 18432
    buffer_load_dwordx4 v2, s[12:15], s42 offen offset:1024 sc1 lds
    buffer_load_dwordx4 v2, s[12:15], s42 offen offset:2048 sc1 lds
    s_add_u32 s42, s42, 18432
    s_add_u32 s44, s44, 1
    s_cmp_lg_u32 s44, 4
    s_cbranch_scc1 g1l7_w6
    s_mov_b32 s44, 0
    s_sub_u32 s41, s41, 73728
    s_sub_u32 s43, s43, 73728
g1l7_w6:
    s_mov_b32 m0, s47
    s_add_u32 s47, s47, 16384
    buffer_load_dwordx4 v3, s[16:19], s46 offen offset:0  lds
    buffer_load_dwordx4 v4, s[16:19], s46 offen offset:1024  lds
    buffer_load_dwordx4 v5, s[16:19], s46 offen offset:2048  lds
    buffer_load_dwordx4 v6, s[16:19], s46 offen offset:3072  lds
    s_add_u32 s46, s46, 589824
    s_add_u32 s48, s48, 1
    s_cmp_lg_u32 s48, 4
    s_cbranch_scc1 g1l7_w7
    s_mov_b32 s48, 0
    s_sub_u32 s47, s47, 65536
g1l7_w7:
    s_add_u32 s26, s26, 1
    s_cmp_lt_u32 s26, 29
    s_cbranch_scc1 g1l7_loop
    s_waitcnt vmcnt(9)
    s_barrier
    s_waitcnt vmcnt(0)
    s_barrier
    s_branch g2_load
g1_hload:
    s_cmp_lg_u32 s10, 7
    s_cbranch_scc1 g2_load
    s_add_u32 s4, s98, 31850496
    s_addc_u32 s5, s99, 0
    s_mov_b32 s6, 83968
    s_mov_b32 s7, 0x20000
    s_and_b32 s24, s2, 15
    s_lshl_b32 s24, s24, 7
    s_add_u32 s62, s24, 75776
    v_mov_b32 v70, s62
    s_mov_b64 exec, 1
    s_mov_b32 s24, 0
g1pa_p:
    buffer_load_dword v71, v70, s[4:7], 0 offen sc1
    s_add_u32 s24, s24, 1
    s_waitcnt vmcnt(0)
    v_readfirstlane_b32 s25, v71
    s_cmp_ge_u32 s24, 0x40000
    s_cbranch_scc1 g1pa_g
    s_cmp_ge_u32 s25, 8
    s_cbranch_scc1 g1pa_g
    s_sleep 2
    s_branch g1pa_p
g1pa_g:
    s_mov_b64 exec, -1
    s_sub_u32 s57, s11, 0
g1p:
    s_cmp_lt_u32 s57, 216
    s_cbranch_scc1 g1p_n
    s_cmp_ge_u32 s57, 222
    s_cbranch_scc1 g1p_n
    s_and_b32 s24, s2, 15
    s_lshl_b32 s24, s24, 7
    s_add_u32 s62, s24, 77824
    v_mov_b32 v70, s62
    s_mov_b64 exec, 1
    s_mov_b32 s24, 0
g1pb_p:
    buffer_load_dword v71, v70, s[4:7], 0 offen sc1
    s_add_u32 s24, s24, 1
    s_waitcnt vmcnt(0)
    v_readfirstlane_b32 s25, v71
    s_cmp_ge_u32 s24, 0x40000
    s_cbranch_scc1 g1pb_g
    s_cmp_ge_u32 s25, 8
    s_cbranch_scc1 g1pb_g
    s_sleep 2
    s_branch g1pb_p
g1pb_g:
    s_mov_b64 exec, -1
g1p_n:
    s_lshl_b32 s58, s57, 6
    v_add_u32 v14, s58, v1
    v_mul_u32_u24 v15, 58255, v14
    v_lshrrev_b32 v15, 19, v15
    v_lshrrev_b32 v16, 6, v15
    v_mul_u32_u24 v17, 576, v16
    v_sub_u32 v14, v14, v17
    v_mul_u32_u24 v15, 3641, v14
    v_lshrrev_b32 v15, 19, v15
    v_mul_u32_u24 v17, 144, v15
    v_sub_u32 v14, v14, v17
    v_mul_u32_u24 v16, 18432, v16
    v_mul_u32_u24 v15, 589824, v15
    v_lshl_add_u32 v14, v14, 7, v16
    v_add_u32 v14, v14, v15
    buffer_load_dword v20, v14, s[12:15], 0 offen sc1
    s_waitcnt vmcnt(2)
    s_add_u32 s57, s57, 6
    s_cmp_lt_u32 s57, 288
    s_cbranch_scc1 g1p
    s_branch g2_load
g1_cons:
    v_lshrrev_b32 v144, 4, v1
    v_and_b32 v145, 15, v1
    v_mul_u32_u24 v192, 2304, v144
    v_lshl_add_u32 v192, v145, 4, v192
    v_add_u32 v3, 55296, v192
    v_bfe_u32 v147, v1, 2, 2
    v_and_b32 v148, 1, v144
    v_lshl_add_u32 v148, v148, 2, v147
    v_lshl_add_u32 v147, v144, 3, v147
    v_lshlrev_b32 v147, 8, v147
    v_and_b32 v149, 3, v1
    v_lshl_add_u32 v147, v149, 3, v147
    v_add_u32 v147, 73728, v147
    s_lshl_b32 s25, s10, 1
    v_xor_b32 v148, s25, v148
    v_lshl_add_u32 v4, v148, 5, v147
    v_xor_b32 v148, 1, v148
    v_lshl_add_u32 v5, v148, 5, v147
    v_lshlrev_b32 v150, 3, v144
    v_lshlrev_b32 v184, 4, v1
    v_mov_b32 v2, v192
    s_cmp_lt_u32 s11, 18
    s_cbranch_scc1 g1_mc
    s_barrier
    s_branch g2_cons
g1_mc:
    s_mov_b32 s12, s88
    s_mov_b32 s13, s89
    s_mov_b32 s14, 9216
    s_mov_b32 s15, 0x20000
    s_add_u32 s16, s98, 11796480
    s_addc_u32 s17, s99, 0
    s_mov_b32 s18, 5308416
    s_mov_b32 s19, 0x20000
    s_lshl_b32 s25, s28, 8
    s_lshl_b32 s24, s10, 6
    s_add_u32 s25, s25, s24
    buffer_load_dwordx2 v[168:169], v150, s[12:15], s25 offen
    buffer_load_dwordx2 v[170:171], v150, s[12:15], s25 offen offset:32
    s_mul_i32 s32, s29, 1327104
    s_lshl_b32 s25, s28, 2
    s_add_u32 s25, s25, s10
    s_mul_i32 s25, s25, 9216
    s_add_u32 s32, s32, s25
    s_mov_b32 s25, 139264
    s_cmp_ge_u32 s10, 2
    s_cselect_b32 s25, 0, s25
    s_and_b32 s24, s10, 1
    s_mul_i32 s24, s24, 9216
    s_add_u32 s25, s25, s24
    v_add_u32 v185, s25, v184
    v_lshrrev_b32 v146, 2, v145
    v_cmp_eq_u32 s[34:35], v146, v144
    v_and_b32 v146, 1, v145
    v_lshlrev_b32 v146, 4, v146
    v_mov_b32 v149, 0x3f80
    v_lshlrev_b32 v146, v146, v149
    v_cndmask_b32 v146, 0, v146, s[34:35]
    v_and_b32 v149, 2, v145
    v_cmp_eq_u32 s[34:35], 0, v149
    s_nop 1
    v_cndmask_b32 v174, 0, v146, s[34:35]
    v_cndmask_b32 v175, v146, 0, s[34:35]
    v_mov_b32 v172, 0
    v_mov_b32 v173, 0
    v_mov_b32 v176, 0
    v_mov_b32 v177, 0
    s_waitcnt vmcnt(0)
    v_lshlrev_b32 v8, 16, v168
    v_and_b32 v9, 0xffff0000, v168
    v_lshlrev_b32 v10, 16, v169
    v_and_b32 v11, 0xffff0000, v169
    v_lshlrev_b32 v12, 16, v170
    v_and_b32 v13, 0xffff0000, v170
    v_lshlrev_b32 v14, 16, v171
    v_and_b32 v15, 0xffff0000, v171
    v_mov_b64 v[16:17], v[8:9]
    v_mov_b64 v[18:19], v[10:11]
    v_mov_b64 v[20:21], v[12:13]
    v_mov_b64 v[22:23], v[14:15]
    v_mov_b64 v[24:25], v[8:9]
    v_mov_b64 v[26:27], v[10:11]
    v_mov_b64 v[28:29], v[12:13]
    v_mov_b64 v[30:31], v[14:15]
    v_mov_b64 v[32:33], v[8:9]
    v_mov_b64 v[34:35], v[10:11]
    v_mov_b64 v[36:37], v[12:13]
    v_mov_b64 v[38:39], v[14:15]
    v_mov_b64 v[40:41], v[8:9]
    v_mov_b64 v[42:43], v[10:11]
    v_mov_b64 v[44:45], v[12:13]
    v_mov_b64 v[46:47], v[14:15]
    v_mov_b64 v[48:49], v[8:9]
    v_mov_b64 v[50:51], v[10:11]
    v_mov_b64 v[52:53], v[12:13]
    v_mov_b64 v[54:55], v[14:15]
    v_mov_b64 v[56:57], v[8:9]
    v_mov_b64 v[58:59], v[10:11]
    v_mov_b64 v[60:61], v[12:13]
    v_mov_b64 v[62:63], v[14:15]
    v_mov_b64 v[64:65], v[8:9]
    v_mov_b64 v[66:67], v[10:11]
    v_mov_b64 v[68:69], v[12:13]
    v_mov_b64 v[70:71], v[14:15]
    v_mov_b64 v[72:73], v[8:9]
    v_mov_b64 v[74:75], v[10:11]
    v_mov_b64 v[76:77], v[12:13]
    v_mov_b64 v[78:79], v[14:15]
    s_waitcnt lgkmcnt(0)
    s_barrier
    s_mov_b32 s26, 0
    s_barrier
    ds_read_b64_tr_b16 v[80:81], v4 offset:0
    ds_read_b64_tr_b16 v[82:83], v4 offset:1024
    ds_read_b64_tr_b16 v[84:85], v5 offset:0
    ds_read_b64_tr_b16 v[86:87], v5 offset:1024
    ds_read_b128 v[88:91], v2 offset:0
    ds_read_b128 v[92:95], v2 offset:256
    ds_read_b128 v[96:99], v2 offset:512
    ds_read_b128 v[100:103], v2 offset:768
    ds_read_b128 v[104:107], v2 offset:1024
    ds_read_b128 v[108:111], v2 offset:1280
    ds_read_b128 v[112:115], v2 offset:1536
    ds_read_b128 v[116:119], v2 offset:1792
    ds_read_b128 v[120:123], v2 offset:2048
    s_waitcnt lgkmcnt(0)
    s_branch g1c_mid
.p2align 6
g1c_loop:
    s_barrier
    s_waitcnt lgkmcnt(1)
    v_mfma_f32_16x16x32_bf16 v[8:11], v[124:127], v[132:135], v[8:11]
    ds_read_b64_tr_b16 v[80:81], v4 offset:0
    v_mfma_f32_16x16x32_bf16 v[12:15], v[128:131], v[132:135], v[12:15]
    ds_read_b64_tr_b16 v[82:83], v4 offset:1024
    v_mfma_f32_16x16x32_bf16 v[16:19], v[124:127], v[136:139], v[16:19]
    ds_read_b64_tr_b16 v[84:85], v5 offset:0
    v_mfma_f32_16x16x32_bf16 v[20:23], v[128:131], v[136:139], v[20:23]
    ds_read_b64_tr_b16 v[86:87], v5 offset:1024
    v_mfma_f32_16x16x32_bf16 v[24:27], v[124:127], v[140:143], v[24:27]
    ds_read_b128 v[88:91], v2 offset:0
    v_mfma_f32_16x16x32_bf16 v[28:31], v[128:131], v[140:143], v[28:31]
    ds_read_b128 v[92:95], v2 offset:256
    v_mfma_f32_16x16x32_bf16 v[32:35], v[124:127], v[144:147], v[32:35]
    ds_read_b128 v[96:99], v2 offset:512
    v_mfma_f32_16x16x32_bf16 v[36:39], v[128:131], v[144:147], v[36:39]
    ds_read_b128 v[100:103], v2 offset:768
    v_mfma_f32_16x16x32_bf16 v[40:43], v[124:127], v[148:151], v[40:43]
    ds_read_b128 v[104:107], v2 offset:1024
    v_mfma_f32_16x16x32_bf16 v[44:47], v[128:131], v[148:151], v[44:47]
    ds_read_b128 v[108:111], v2 offset:1280
    v_mfma_f32_16x16x32_bf16 v[48:51], v[124:127], v[152:155], v[48:51]
    ds_read_b128 v[112:115], v2 offset:1536
    v_mfma_f32_16x16x32_bf16 v[52:55], v[128:131], v[152:155], v[52:55]
    ds_read_b128 v[116:119], v2 offset:1792
    v_mfma_f32_16x16x32_bf16 v[56:59], v[124:127], v[156:159], v[56:59]
    ds_read_b128 v[120:123], v2 offset:2048
    v_mfma_f32_16x16x32_bf16 v[60:63], v[128:131], v[156:159], v[60:63]
    v_mfma_f32_16x16x32_bf16 v[64:67], v[124:127], v[160:163], v[64:67]
    v_mfma_f32_16x16x32_bf16 v[68:71], v[128:131], v[160:163], v[68:71]
    s_waitcnt lgkmcnt(3)
    v_mfma_f32_16x16x32_bf16 v[72:75], v[124:127], v[164:167], v[72:75]
    v_mfma_f32_16x16x32_bf16 v[76:79], v[128:131], v[164:167], v[76:79]
g1c_mid:
    v_mfma_f32_16x16x32_bf16 v[8:11], v[80:83], v[88:91], v[8:11]
    ds_read_b64_tr_b16 v[124:125], v4 offset:8192
    v_mfma_f32_16x16x32_bf16 v[12:15], v[84:87], v[88:91], v[12:15]
    ds_read_b64_tr_b16 v[126:127], v4 offset:9216
    v_mfma_f32_16x16x32_bf16 v[16:19], v[80:83], v[92:95], v[16:19]
    ds_read_b64_tr_b16 v[128:129], v5 offset:8192
    v_mfma_f32_16x16x32_bf16 v[20:23], v[84:87], v[92:95], v[20:23]
    ds_read_b64_tr_b16 v[130:131], v5 offset:9216
    v_mfma_f32_16x16x32_bf16 v[24:27], v[80:83], v[96:99], v[24:27]
    ds_read_b128 v[132:135], v2 offset:9216
    v_mfma_f32_16x16x32_bf16 v[28:31], v[84:87], v[96:99], v[28:31]
    ds_read_b128 v[136:139], v2 offset:9472
    v_mfma_f32_16x16x32_bf16 v[32:35], v[80:83], v[100:103], v[32:35]
    ds_read_b128 v[140:143], v2 offset:9728
    v_mfma_f32_16x16x32_bf16 v[36:39], v[84:87], v[100:103], v[36:39]
    ds_read_b128 v[144:147], v2 offset:9984
    v_mfma_f32_16x16x32_bf16 v[40:43], v[80:83], v[104:107], v[40:43]
    ds_read_b128 v[148:151], v2 offset:10240
    v_mfma_f32_16x16x32_bf16 v[44:47], v[84:87], v[104:107], v[44:47]
    ds_read_b128 v[152:155], v2 offset:10496
    v_mfma_f32_16x16x32_bf16 v[48:51], v[80:83], v[108:111], v[48:51]
    ds_read_b128 v[156:159], v2 offset:10752
    v_mfma_f32_16x16x32_bf16 v[52:55], v[84:87], v[108:111], v[52:55]
    ds_read_b128 v[160:163], v2 offset:11008
    s_waitcnt lgkmcnt(6)
    v_mfma_f32_16x16x32_bf16 v[56:59], v[80:83], v[112:115], v[56:59]
    ds_read_b128 v[164:167], v2 offset:11264
    v_mfma_f32_16x16x32_bf16 v[60:63], v[84:87], v[112:115], v[60:63]
    v_mfma_f32_16x16x32_bf16 v[64:67], v[80:83], v[116:119], v[64:67]
    v_mfma_f32_16x16x32_bf16 v[68:71], v[84:87], v[116:119], v[68:71]
    v_mfma_f32_16x16x32_bf16 v[72:75], v[80:83], v[120:123], v[72:75]
    v_mfma_f32_16x16x32_bf16 v[76:79], v[84:87], v[120:123], v[76:79]
    s_barrier
    s_waitcnt lgkmcnt(1)
    v_mfma_f32_16x16x32_bf16 v[8:11], v[124:127], v[132:135], v[8:11]
    ds_read_b64_tr_b16 v[80:81], v4 offset:16384
    v_mfma_f32_16x16x32_bf16 v[12:15], v[128:131], v[132:135], v[12:15]
    ds_read_b64_tr_b16 v[82:83], v4 offset:17408
    v_mfma_f32_16x16x32_bf16 v[16:19], v[124:127], v[136:139], v[16:19]
    ds_read_b64_tr_b16 v[84:85], v5 offset:16384
    v_mfma_f32_16x16x32_bf16 v[20:23], v[128:131], v[136:139], v[20:23]
    ds_read_b64_tr_b16 v[86:87], v5 offset:17408
    v_mfma_f32_16x16x32_bf16 v[24:27], v[124:127], v[140:143], v[24:27]
    ds_read_b128 v[88:91], v2 offset:18432
    v_mfma_f32_16x16x32_bf16 v[28:31], v[128:131], v[140:143], v[28:31]
    ds_read_b128 v[92:95], v2 offset:18688
    v_mfma_f32_16x16x32_bf16 v[32:35], v[124:127], v[144:147], v[32:35]
    ds_read_b128 v[96:99], v2 offset:18944
    v_mfma_f32_16x16x32_bf16 v[36:39], v[128:131], v[144:147], v[36:39]
    ds_read_b128 v[100:103], v2 offset:19200
    v_mfma_f32_16x16x32_bf16 v[40:43], v[124:127], v[148:151], v[40:43]
    ds_read_b128 v[104:107], v2 offset:19456
    v_mfma_f32_16x16x32_bf16 v[44:47], v[128:131], v[148:151], v[44:47]
    ds_read_b128 v[108:111], v2 offset:19712
    v_mfma_f32_16x16x32_bf16 v[48:51], v[124:127], v[152:155], v[48:51]
    ds_read_b128 v[112:115], v2 offset:19968
    v_mfma_f32_16x16x32_bf16 v[52:55], v[128:131], v[152:155], v[52:55]
    ds_read_b128 v[116:119], v2 offset:20224
    v_mfma_f32_16x16x32_bf16 v[56:59], v[124:127], v[156:159], v[56:59]
    ds_read_b128 v[120:123], v2 offset:20480
    v_mfma_f32_16x16x32_bf16 v[60:63], v[128:131], v[156:159], v[60:63]
    v_mfma_f32_16x16x32_bf16 v[64:67], v[124:127], v[160:163], v[64:67]
    v_mfma_f32_16x16x32_bf16 v[68:71], v[128:131], v[160:163], v[68:71]
    s_waitcnt lgkmcnt(3)
    v_mfma_f32_16x16x32_bf16 v[72:75], v[124:127], v[164:167], v[72:75]
    v_mfma_f32_16x16x32_bf16 v[76:79], v[128:131], v[164:167], v[76:79]
    v_mfma_f32_16x16x32_bf16 v[8:11], v[80:83], v[88:91], v[8:11]
    ds_read_b64_tr_b16 v[124:125], v4 offset:24576
    v_mfma_f32_16x16x32_bf16 v[12:15], v[84:87], v[88:91], v[12:15]
    ds_read_b64_tr_b16 v[126:127], v4 offset:25600
    v_mfma_f32_16x16x32_bf16 v[16:19], v[80:83], v[92:95], v[16:19]
    ds_read_b64_tr_b16 v[128:129], v5 offset:24576
    v_mfma_f32_16x16x32_bf16 v[20:23], v[84:87], v[92:95], v[20:23]
    ds_read_b64_tr_b16 v[130:131], v5 offset:25600
    v_mfma_f32_16x16x32_bf16 v[24:27], v[80:83], v[96:99], v[24:27]
    ds_read_b128 v[132:135], v2 offset:27648
    v_mfma_f32_16x16x32_bf16 v[28:31], v[84:87], v[96:99], v[28:31]
    ds_read_b128 v[136:139], v2 offset:27904
    v_mfma_f32_16x16x32_bf16 v[32:35], v[80:83], v[100:103], v[32:35]
    ds_read_b128 v[140:143], v2 offset:28160
    v_mfma_f32_16x16x32_bf16 v[36:39], v[84:87], v[100:103], v[36:39]
    ds_read_b128 v[144:147], v2 offset:28416
    v_mfma_f32_16x16x32_bf16 v[40:43], v[80:83], v[104:107], v[40:43]
    ds_read_b128 v[148:151], v2 offset:28672
    v_mfma_f32_16x16x32_bf16 v[44:47], v[84:87], v[104:107], v[44:47]
    ds_read_b128 v[152:155], v2 offset:28928
    v_mfma_f32_16x16x32_bf16 v[48:51], v[80:83], v[108:111], v[48:51]
    ds_read_b128 v[156:159], v2 offset:29184
    v_mfma_f32_16x16x32_bf16 v[52:55], v[84:87], v[108:111], v[52:55]
    ds_read_b128 v[160:163], v2 offset:29440
    s_waitcnt lgkmcnt(6)
    v_mfma_f32_16x16x32_bf16 v[56:59], v[80:83], v[112:115], v[56:59]
    ds_read_b128 v[164:167], v2 offset:29696
    v_mfma_f32_16x16x32_bf16 v[60:63], v[84:87], v[112:115], v[60:63]
    v_mfma_f32_16x16x32_bf16 v[64:67], v[80:83], v[116:119], v[64:67]
    v_mfma_f32_16x16x32_bf16 v[68:71], v[84:87], v[116:119], v[68:71]
    v_mfma_f32_16x16x32_bf16 v[72:75], v[80:83], v[120:123], v[72:75]
    v_mfma_f32_16x16x32_bf16 v[76:79], v[84:87], v[120:123], v[76:79]
    s_barrier
    s_waitcnt lgkmcnt(1)
    v_mfma_f32_16x16x32_bf16 v[8:11], v[124:127], v[132:135], v[8:11]
    ds_read_b64_tr_b16 v[80:81], v4 offset:32768
    v_mfma_f32_16x16x32_bf16 v[12:15], v[128:131], v[132:135], v[12:15]
    ds_read_b64_tr_b16 v[82:83], v4 offset:33792
    v_mfma_f32_16x16x32_bf16 v[16:19], v[124:127], v[136:139], v[16:19]
    ds_read_b64_tr_b16 v[84:85], v5 offset:32768
    v_mfma_f32_16x16x32_bf16 v[20:23], v[128:131], v[136:139], v[20:23]
    ds_read_b64_tr_b16 v[86:87], v5 offset:33792
    v_mfma_f32_16x16x32_bf16 v[24:27], v[124:127], v[140:143], v[24:27]
    ds_read_b128 v[88:91], v2 offset:36864
    v_mfma_f32_16x16x32_bf16 v[28:31], v[128:131], v[140:143], v[28:31]
    ds_read_b128 v[92:95], v2 offset:37120
    v_mfma_f32_16x16x32_bf16 v[32:35], v[124:127], v[144:147], v[32:35]
    ds_read_b128 v[96:99], v2 offset:37376
    v_mfma_f32_16x16x32_bf16 v[36:39], v[128:131], v[144:147], v[36:39]
    ds_read_b128 v[100:103], v2 offset:37632
    v_mfma_f32_16x16x32_bf16 v[40:43], v[124:127], v[148:151], v[40:43]
    ds_read_b128 v[104:107], v2 offset:37888
    v_mfma_f32_16x16x32_bf16 v[44:47], v[128:131], v[148:151], v[44:47]
    ds_read_b128 v[108:111], v2 offset:38144
    v_mfma_f32_16x16x32_bf16 v[48:51], v[124:127], v[152:155], v[48:51]
    ds_read_b128 v[112:115], v2 offset:38400
    v_mfma_f32_16x16x32_bf16 v[52:55], v[128:131], v[152:155], v[52:55]
    ds_read_b128 v[116:119], v2 offset:38656
    v_mfma_f32_16x16x32_bf16 v[56:59], v[124:127], v[156:159], v[56:59]
    ds_read_b128 v[120:123], v2 offset:38912
    v_mfma_f32_16x16x32_bf16 v[60:63], v[128:131], v[156:159], v[60:63]
    v_mfma_f32_16x16x32_bf16 v[64:67], v[124:127], v[160:163], v[64:67]
    v_mfma_f32_16x16x32_bf16 v[68:71], v[128:131], v[160:163], v[68:71]
    s_waitcnt lgkmcnt(3)
    v_mfma_f32_16x16x32_bf16 v[72:75], v[124:127], v[164:167], v[72:75]
    v_mfma_f32_16x16x32_bf16 v[76:79], v[128:131], v[164:167], v[76:79]
    v_mfma_f32_16x16x32_bf16 v[8:11], v[80:83], v[88:91], v[8:11]
    ds_read_b64_tr_b16 v[124:125], v4 offset:40960
    v_mfma_f32_16x16x32_bf16 v[12:15], v[84:87], v[88:91], v[12:15]
    ds_read_b64_tr_b16 v[126:127], v4 offset:41984
    v_mfma_f32_16x16x32_bf16 v[16:19], v[80:83], v[92:95], v[16:19]
    ds_read_b64_tr_b16 v[128:129], v5 offset:40960
    v_mfma_f32_16x16x32_bf16 v[20:23], v[84:87], v[92:95], v[20:23]
    ds_read_b64_tr_b16 v[130:131], v5 offset:41984
    v_mfma_f32_16x16x32_bf16 v[24:27], v[80:83], v[96:99], v[24:27]
    ds_read_b128 v[132:135], v2 offset:46080
    v_mfma_f32_16x16x32_bf16 v[28:31], v[84:87], v[96:99], v[28:31]
    ds_read_b128 v[136:139], v2 offset:46336
    v_mfma_f32_16x16x32_bf16 v[32:35], v[80:83], v[100:103], v[32:35]
    ds_read_b128 v[140:143], v2 offset:46592
    v_mfma_f32_16x16x32_bf16 v[36:39], v[84:87], v[100:103], v[36:39]
    ds_read_b128 v[144:147], v2 offset:46848
    v_mfma_f32_16x16x32_bf16 v[40:43], v[80:83], v[104:107], v[40:43]
    ds_read_b128 v[148:151], v2 offset:47104
    v_mfma_f32_16x16x32_bf16 v[44:47], v[84:87], v[104:107], v[44:47]
    ds_read_b128 v[152:155], v2 offset:47360
    v_mfma_f32_16x16x32_bf16 v[48:51], v[80:83], v[108:111], v[48:51]
    ds_read_b128 v[156:159], v2 offset:47616
    v_mfma_f32_16x16x32_bf16 v[52:55], v[84:87], v[108:111], v[52:55]
    ds_read_b128 v[160:163], v2 offset:47872
    s_waitcnt lgkmcnt(6)
    v_mfma_f32_16x16x32_bf16 v[56:59], v[80:83], v[112:115], v[56:59]
    ds_read_b128 v[164:167], v2 offset:48128
    v_mfma_f32_16x16x32_bf16 v[60:63], v[84:87], v[112:115], v[60:63]
    v_mfma_f32_16x16x32_bf16 v[64:67], v[80:83], v[116:119], v[64:67]
    v_mfma_f32_16x16x32_bf16 v[68:71], v[84:87], v[116:119], v[68:71]
    v_mfma_f32_16x16x32_bf16 v[72:75], v[80:83], v[120:123], v[72:75]
    v_mfma_f32_16x16x32_bf16 v[76:79], v[84:87], v[120:123], v[76:79]
    s_barrier
    s_waitcnt lgkmcnt(1)
    v_mfma_f32_16x16x32_bf16 v[8:11], v[124:127], v[132:135], v[8:11]
    ds_read_b64_tr_b16 v[80:81], v4 offset:49152
    v_mfma_f32_16x16x32_bf16 v[12:15], v[128:131], v[132:135], v[12:15]
    ds_read_b64_tr_b16 v[82:83], v4 offset:50176
    v_mfma_f32_16x16x32_bf16 v[16:19], v[124:127], v[136:139], v[16:19]
    ds_read_b64_tr_b16 v[84:85], v5 offset:49152
    v_mfma_f32_16x16x32_bf16 v[20:23], v[128:131], v[136:139], v[20:23]
    ds_read_b64_tr_b16 v[86:87], v5 offset:50176
    v_mfma_f32_16x16x32_bf16 v[24:27], v[124:127], v[140:143], v[24:27]
    ds_read_b128 v[88:91], v3 offset:0
    v_mfma_f32_16x16x32_bf16 v[28:31], v[128:131], v[140:143], v[28:31]
    ds_read_b128 v[92:95], v3 offset:256
    v_mfma_f32_16x16x32_bf16 v[32:35], v[124:127], v[144:147], v[32:35]
    ds_read_b128 v[96:99], v3 offset:512
    v_mfma_f32_16x16x32_bf16 v[36:39], v[128:131], v[144:147], v[36:39]
    ds_read_b128 v[100:103], v3 offset:768
    v_mfma_f32_16x16x32_bf16 v[40:43], v[124:127], v[148:151], v[40:43]
    ds_read_b128 v[104:107], v3 offset:1024
    v_mfma_f32_16x16x32_bf16 v[44:47], v[128:131], v[148:151], v[44:47]
    ds_read_b128 v[108:111], v3 offset:1280
    v_mfma_f32_16x16x32_bf16 v[48:51], v[124:127], v[152:155], v[48:51]
    ds_read_b128 v[112:115], v3 offset:1536
    v_mfma_f32_16x16x32_bf16 v[52:55], v[128:131], v[152:155], v[52:55]
    ds_read_b128 v[116:119], v3 offset:1792
    v_mfma_f32_16x16x32_bf16 v[56:59], v[124:127], v[156:159], v[56:59]
    ds_read_b128 v[120:123], v3 offset:2048
    v_mfma_f32_16x16x32_bf16 v[60:63], v[128:131], v[156:159], v[60:63]
    v_mfma_f32_16x16x32_bf16 v[64:67], v[124:127], v[160:163], v[64:67]
    v_mfma_f32_16x16x32_bf16 v[68:71], v[128:131], v[160:163], v[68:71]
    s_waitcnt lgkmcnt(3)
    v_mfma_f32_16x16x32_bf16 v[72:75], v[124:127], v[164:167], v[72:75]
    v_mfma_f32_16x16x32_bf16 v[76:79], v[128:131], v[164:167], v[76:79]
    v_mfma_f32_16x16x32_bf16 v[8:11], v[80:83], v[88:91], v[8:11]
    ds_read_b64_tr_b16 v[124:125], v4 offset:57344
    v_mfma_f32_16x16x32_bf16 v[12:15], v[84:87], v[88:91], v[12:15]
    ds_read_b64_tr_b16 v[126:127], v4 offset:58368
    v_mfma_f32_16x16x32_bf16 v[16:19], v[80:83], v[92:95], v[16:19]
    ds_read_b64_tr_b16 v[128:129], v5 offset:57344
    v_mfma_f32_16x16x32_bf16 v[20:23], v[84:87], v[92:95], v[20:23]
    ds_read_b64_tr_b16 v[130:131], v5 offset:58368
    v_mfma_f32_16x16x32_bf16 v[24:27], v[80:83], v[96:99], v[24:27]
    ds_read_b128 v[132:135], v3 offset:9216
    v_mfma_f32_16x16x32_bf16 v[28:31], v[84:87], v[96:99], v[28:31]
    ds_read_b128 v[136:139], v3 offset:9472
    v_mfma_f32_16x16x32_bf16 v[32:35], v[80:83], v[100:103], v[32:35]
    ds_read_b128 v[140:143], v3 offset:9728
    v_mfma_f32_16x16x32_bf16 v[36:39], v[84:87], v[100:103], v[36:39]
    ds_read_b128 v[144:147], v3 offset:9984
    v_mfma_f32_16x16x32_bf16 v[40:43], v[80:83], v[104:107], v[40:43]
    ds_read_b128 v[148:151], v3 offset:10240
    v_mfma_f32_16x16x32_bf16 v[44:47], v[84:87], v[104:107], v[44:47]
    ds_read_b128 v[152:155], v3 offset:10496
    v_mfma_f32_16x16x32_bf16 v[48:51], v[80:83], v[108:111], v[48:51]
    ds_read_b128 v[156:159], v3 offset:10752
    v_mfma_f32_16x16x32_bf16 v[52:55], v[84:87], v[108:111], v[52:55]
    ds_read_b128 v[160:163], v3 offset:11008
    s_waitcnt lgkmcnt(6)
    v_mfma_f32_16x16x32_bf16 v[56:59], v[80:83], v[112:115], v[56:59]
    ds_read_b128 v[164:167], v3 offset:11264
    v_mfma_f32_16x16x32_bf16 v[60:63], v[84:87], v[112:115], v[60:63]
    v_mfma_f32_16x16x32_bf16 v[64:67], v[80:83], v[116:119], v[64:67]
    v_mfma_f32_16x16x32_bf16 v[68:71], v[84:87], v[116:119], v[68:71]
    v_mfma_f32_16x16x32_bf16 v[72:75], v[80:83], v[120:123], v[72:75]
    v_mfma_f32_16x16x32_bf16 v[76:79], v[84:87], v[120:123], v[76:79]
    s_add_u32 s26, s26, 1
    s_cmp_eq_u32 s26, 8
    s_cbranch_scc1 g1c_done
    s_branch g1c_loop
g1c_done:
    s_waitcnt lgkmcnt(1)
    v_mfma_f32_16x16x32_bf16 v[8:11], v[124:127], v[132:135], v[8:11]
    v_mfma_f32_16x16x32_bf16 v[12:15], v[128:131], v[132:135], v[12:15]
    v_mfma_f32_16x16x32_bf16 v[16:19], v[124:127], v[136:139], v[16:19]
    v_mfma_f32_16x16x32_bf16 v[20:23], v[128:131], v[136:139], v[20:23]
    v_mfma_f32_16x16x32_bf16 v[24:27], v[124:127], v[140:143], v[24:27]
    v_mfma_f32_16x16x32_bf16 v[28:31], v[128:131], v[140:143], v[28:31]
    v_mfma_f32_16x16x32_bf16 v[32:35], v[124:127], v[144:147], v[32:35]
    v_mfma_f32_16x16x32_bf16 v[36:39], v[128:131], v[144:147], v[36:39]
    v_mfma_f32_16x16x32_bf16 v[40:43], v[124:127], v[148:151], v[40:43]
    v_mfma_f32_16x16x32_bf16 v[44:47], v[128:131], v[148:151], v[44:47]
    v_mfma_f32_16x16x32_bf16 v[48:51], v[124:127], v[152:155], v[48:51]
    v_mfma_f32_16x16x32_bf16 v[52:55], v[128:131], v[152:155], v[52:55]
    v_mfma_f32_16x16x32_bf16 v[56:59], v[124:127], v[156:159], v[56:59]
    v_mfma_f32_16x16x32_bf16 v[60:63], v[128:131], v[156:159], v[60:63]
    v_mfma_f32_16x16x32_bf16 v[64:67], v[124:127], v[160:163], v[64:67]
    v_mfma_f32_16x16x32_bf16 v[68:71], v[128:131], v[160:163], v[68:71]
    s_waitcnt lgkmcnt(0)
    v_mfma_f32_16x16x32_bf16 v[72:75], v[124:127], v[164:167], v[72:75]
    v_mfma_f32_16x16x32_bf16 v[76:79], v[128:131], v[164:167], v[76:79]
    s_barrier
    s_mul_i32 s25, s10, 9216
    v_add_u32 v3, s25, v2
    v_mov_b32 v4, 0xc0135761
    v_mov_b32 v5, 0xc0135761
    v_mov_b32 v6, 0xbdd2d3e8
    v_mov_b32 v7, 0xbdd2d3e8
    v_mov_b32 v186, 1.0
    v_mov_b32 v187, 1.0
    v_pk_mul_f32 v[188:189], v[8:9], v[8:9]
    v_pk_mul_f32 v[190:191], v[10:11], v[10:11]
    v_pk_mul_f32 v[192:193], v[12:13], v[12:13]
    v_pk_mul_f32 v[194:195], v[14:15], v[14:15]
    v_pk_fma_f32 v[188:189], v[188:189], v[6:7], v[4:5]
    v_pk_fma_f32 v[190:191], v[190:191], v[6:7], v[4:5]
    v_pk_fma_f32 v[192:193], v[192:193], v[6:7], v[4:5]
    v_pk_fma_f32 v[194:195], v[194:195], v[6:7], v[4:5]
    v_pk_mul_f32 v[188:189], v[188:189], v[8:9]
    v_pk_mul_f32 v[190:191], v[190:191], v[10:11]
    v_pk_mul_f32 v[192:193], v[192:193], v[12:13]
    v_pk_mul_f32 v[194:195], v[194:195], v[14:15]
    v_exp_f32 v188, v188
    v_exp_f32 v189, v189
    v_exp_f32 v190, v190
    v_exp_f32 v191, v191
    v_exp_f32 v192, v192
    v_exp_f32 v193, v193
    v_exp_f32 v194, v194
    v_exp_f32 v195, v195
    v_pk_add_f32 v[188:189], v[188:189], v[186:187]
    v_pk_add_f32 v[190:191], v[190:191], v[186:187]
    v_pk_add_f32 v[192:193], v[192:193], v[186:187]
    v_pk_add_f32 v[194:195], v[194:195], v[186:187]
    v_rcp_f32 v188, v188
    v_rcp_f32 v189, v189
    v_rcp_f32 v190, v190
    v_rcp_f32 v191, v191
    v_rcp_f32 v192, v192
    v_rcp_f32 v193, v193
    v_rcp_f32 v194, v194
    v_rcp_f32 v195, v195
    v_pk_mul_f32 v[188:189], v[188:189], v[8:9]
    v_pk_mul_f32 v[190:191], v[190:191], v[10:11]
    v_pk_mul_f32 v[192:193], v[192:193], v[12:13]
    v_pk_mul_f32 v[194:195], v[194:195], v[14:15]
    v_cvt_pk_bf16_f32 v124, v188, v189
    v_cvt_pk_bf16_f32 v125, v190, v191
    v_cvt_pk_bf16_f32 v126, v192, v193
    v_cvt_pk_bf16_f32 v127, v194, v195
    buffer_store_dwordx4 v[124:127], v2, s[16:19], s32 offen offset:0 sc1
    ds_write_b128 v3, v[124:127] offset:0
    v_pk_mul_f32 v[196:197], v[16:17], v[16:17]
    v_pk_mul_f32 v[198:199], v[18:19], v[18:19]
    v_pk_mul_f32 v[200:201], v[20:21], v[20:21]
    v_pk_mul_f32 v[202:203], v[22:23], v[22:23]
    v_pk_fma_f32 v[196:197], v[196:197], v[6:7], v[4:5]
    v_pk_fma_f32 v[198:199], v[198:199], v[6:7], v[4:5]
    v_pk_fma_f32 v[200:201], v[200:201], v[6:7], v[4:5]
    v_pk_fma_f32 v[202:203], v[202:203], v[6:7], v[4:5]
    v_pk_mul_f32 v[196:197], v[196:197], v[16:17]
    v_pk_mul_f32 v[198:199], v[198:199], v[18:19]
    v_pk_mul_f32 v[200:201], v[200:201], v[20:21]
    v_pk_mul_f32 v[202:203], v[202:203], v[22:23]
    v_exp_f32 v196, v196
    v_exp_f32 v197, v197
    v_exp_f32 v198, v198
    v_exp_f32 v199, v199
    v_exp_f32 v200, v200
    v_exp_f32 v201, v201
    v_exp_f32 v202, v202
    v_exp_f32 v203, v203
    v_pk_add_f32 v[196:197], v[196:197], v[186:187]
    v_pk_add_f32 v[198:199], v[198:199], v[186:187]
    v_pk_add_f32 v[200:201], v[200:201], v[186:187]
    v_pk_add_f32 v[202:203], v[202:203], v[186:187]
    v_rcp_f32 v196, v196
    v_rcp_f32 v197, v197
    v_rcp_f32 v198, v198
    v_rcp_f32 v199, v199
    v_rcp_f32 v200, v200
    v_rcp_f32 v201, v201
    v_rcp_f32 v202, v202
    v_rcp_f32 v203, v203
    v_pk_mul_f32 v[196:197], v[196:197], v[16:17]
    v_pk_mul_f32 v[198:199], v[198:199], v[18:19]
    v_pk_mul_f32 v[200:201], v[200:201], v[20:21]
    v_pk_mul_f32 v[202:203], v[202:203], v[22:23]
    v_cvt_pk_bf16_f32 v128, v196, v197
    v_cvt_pk_bf16_f32 v129, v198, v199
    v_cvt_pk_bf16_f32 v130, v200, v201
    v_cvt_pk_bf16_f32 v131, v202, v203
    buffer_store_dwordx4 v[128:131], v2, s[16:19], s32 offen offset:256 sc1
    ds_write_b128 v3, v[128:131] offset:256
    v_pk_mul_f32 v[188:189], v[24:25], v[24:25]
    v_pk_mul_f32 v[190:191], v[26:27], v[26:27]
    v_pk_mul_f32 v[192:193], v[28:29], v[28:29]
    v_pk_mul_f32 v[194:195], v[30:31], v[30:31]
    v_pk_fma_f32 v[188:189], v[188:189], v[6:7], v[4:5]
    v_pk_fma_f32 v[190:191], v[190:191], v[6:7], v[4:5]
    v_pk_fma_f32 v[192:193], v[192:193], v[6:7], v[4:5]
    v_pk_fma_f32 v[194:195], v[194:195], v[6:7], v[4:5]
    v_pk_mul_f32 v[188:189], v[188:189], v[24:25]
    v_pk_mul_f32 v[190:191], v[190:191], v[26:27]
    v_pk_mul_f32 v[192:193], v[192:193], v[28:29]
    v_pk_mul_f32 v[194:195], v[194:195], v[30:31]
    v_exp_f32 v188, v188
    v_exp_f32 v189, v189
    v_exp_f32 v190, v190
    v_exp_f32 v191, v191
    v_exp_f32 v192, v192
    v_exp_f32 v193, v193
    v_exp_f32 v194, v194
    v_exp_f32 v195, v195
    v_pk_add_f32 v[188:189], v[188:189], v[186:187]
    v_pk_add_f32 v[190:191], v[190:191], v[186:187]
    v_pk_add_f32 v[192:193], v[192:193], v[186:187]
    v_pk_add_f32 v[194:195], v[194:195], v[186:187]
    v_rcp_f32 v188, v188
    v_rcp_f32 v189, v189
    v_rcp_f32 v190, v190
    v_rcp_f32 v191, v191
    v_rcp_f32 v192, v192
    v_rcp_f32 v193, v193
    v_rcp_f32 v194, v194
    v_rcp_f32 v195, v195
    v_pk_mul_f32 v[188:189], v[188:189], v[24:25]
    v_pk_mul_f32 v[190:191], v[190:191], v[26:27]
    v_pk_mul_f32 v[192:193], v[192:193], v[28:29]
    v_pk_mul_f32 v[194:195], v[194:195], v[30:31]
    v_cvt_pk_bf16_f32 v132, v188, v189
    v_cvt_pk_bf16_f32 v133, v190, v191
    v_cvt_pk_bf16_f32 v134, v192, v193
    v_cvt_pk_bf16_f32 v135, v194, v195
    buffer_store_dwordx4 v[132:135], v2, s[16:19], s32 offen offset:512 sc1
    ds_write_b128 v3, v[132:135] offset:512
    v_pk_mul_f32 v[196:197], v[32:33], v[32:33]
    v_pk_mul_f32 v[198:199], v[34:35], v[34:35]
    v_pk_mul_f32 v[200:201], v[36:37], v[36:37]
    v_pk_mul_f32 v[202:203], v[38:39], v[38:39]
    v_pk_fma_f32 v[196:197], v[196:197], v[6:7], v[4:5]
    v_pk_fma_f32 v[198:199], v[198:199], v[6:7], v[4:5]
    v_pk_fma_f32 v[200:201], v[200:201], v[6:7], v[4:5]
    v_pk_fma_f32 v[202:203], v[202:203], v[6:7], v[4:5]
    v_pk_mul_f32 v[196:197], v[196:197], v[32:33]
    v_pk_mul_f32 v[198:199], v[198:199], v[34:35]
    v_pk_mul_f32 v[200:201], v[200:201], v[36:37]
    v_pk_mul_f32 v[202:203], v[202:203], v[38:39]
    v_exp_f32 v196, v196
    v_exp_f32 v197, v197
    v_exp_f32 v198, v198
    v_exp_f32 v199, v199
    v_exp_f32 v200, v200
    v_exp_f32 v201, v201
    v_exp_f32 v202, v202
    v_exp_f32 v203, v203
    v_pk_add_f32 v[196:197], v[196:197], v[186:187]
    v_pk_add_f32 v[198:199], v[198:199], v[186:187]
    v_pk_add_f32 v[200:201], v[200:201], v[186:187]
    v_pk_add_f32 v[202:203], v[202:203], v[186:187]
    v_rcp_f32 v196, v196
    v_rcp_f32 v197, v197
    v_rcp_f32 v198, v198
    v_rcp_f32 v199, v199
    v_rcp_f32 v200, v200
    v_rcp_f32 v201, v201
    v_rcp_f32 v202, v202
    v_rcp_f32 v203, v203
    v_pk_mul_f32 v[196:197], v[196:197], v[32:33]
    v_pk_mul_f32 v[198:199], v[198:199], v[34:35]
    v_pk_mul_f32 v[200:201], v[200:201], v[36:37]
    v_pk_mul_f32 v[202:203], v[202:203], v[38:39]
    v_cvt_pk_bf16_f32 v136, v196, v197
    v_cvt_pk_bf16_f32 v137, v198, v199
    v_cvt_pk_bf16_f32 v138, v200, v201
    v_cvt_pk_bf16_f32 v139, v202, v203
    buffer_store_dwordx4 v[136:139], v2, s[16:19], s32 offen offset:768 sc1
    ds_write_b128 v3, v[136:139] offset:768
    v_pk_mul_f32 v[188:189], v[40:41], v[40:41]
    v_pk_mul_f32 v[190:191], v[42:43], v[42:43]
    v_pk_mul_f32 v[192:193], v[44:45], v[44:45]
    v_pk_mul_f32 v[194:195], v[46:47], v[46:47]
    v_pk_fma_f32 v[188:189], v[188:189], v[6:7], v[4:5]
    v_pk_fma_f32 v[190:191], v[190:191], v[6:7], v[4:5]
    v_pk_fma_f32 v[192:193], v[192:193], v[6:7], v[4:5]
    v_pk_fma_f32 v[194:195], v[194:195], v[6:7], v[4:5]
    v_pk_mul_f32 v[188:189], v[188:189], v[40:41]
    v_pk_mul_f32 v[190:191], v[190:191], v[42:43]
    v_pk_mul_f32 v[192:193], v[192:193], v[44:45]
    v_pk_mul_f32 v[194:195], v[194:195], v[46:47]
    v_exp_f32 v188, v188
    v_exp_f32 v189, v189
    v_exp_f32 v190, v190
    v_exp_f32 v191, v191
    v_exp_f32 v192, v192
    v_exp_f32 v193, v193
    v_exp_f32 v194, v194
    v_exp_f32 v195, v195
    v_pk_add_f32 v[188:189], v[188:189], v[186:187]
    v_pk_add_f32 v[190:191], v[190:191], v[186:187]
    v_pk_add_f32 v[192:193], v[192:193], v[186:187]
    v_pk_add_f32 v[194:195], v[194:195], v[186:187]
    v_rcp_f32 v188, v188
    v_rcp_f32 v189, v189
    v_rcp_f32 v190, v190
    v_rcp_f32 v191, v191
    v_rcp_f32 v192, v192
    v_rcp_f32 v193, v193
    v_rcp_f32 v194, v194
    v_rcp_f32 v195, v195
    v_pk_mul_f32 v[188:189], v[188:189], v[40:41]
    v_pk_mul_f32 v[190:191], v[190:191], v[42:43]
    v_pk_mul_f32 v[192:193], v[192:193], v[44:45]
    v_pk_mul_f32 v[194:195], v[194:195], v[46:47]
    v_cvt_pk_bf16_f32 v140, v188, v189
    v_cvt_pk_bf16_f32 v141, v190, v191
    v_cvt_pk_bf16_f32 v142, v192, v193
    v_cvt_pk_bf16_f32 v143, v194, v195
    buffer_store_dwordx4 v[140:143], v2, s[16:19], s32 offen offset:1024 sc1
    ds_write_b128 v3, v[140:143] offset:1024
    v_pk_mul_f32 v[196:197], v[48:49], v[48:49]
    v_pk_mul_f32 v[198:199], v[50:51], v[50:51]
    v_pk_mul_f32 v[200:201], v[52:53], v[52:53]
    v_pk_mul_f32 v[202:203], v[54:55], v[54:55]
    v_pk_fma_f32 v[196:197], v[196:197], v[6:7], v[4:5]
    v_pk_fma_f32 v[198:199], v[198:199], v[6:7], v[4:5]
    v_pk_fma_f32 v[200:201], v[200:201], v[6:7], v[4:5]
    v_pk_fma_f32 v[202:203], v[202:203], v[6:7], v[4:5]
    v_pk_mul_f32 v[196:197], v[196:197], v[48:49]
    v_pk_mul_f32 v[198:199], v[198:199], v[50:51]
    v_pk_mul_f32 v[200:201], v[200:201], v[52:53]
    v_pk_mul_f32 v[202:203], v[202:203], v[54:55]
    v_exp_f32 v196, v196
    v_exp_f32 v197, v197
    v_exp_f32 v198, v198
    v_exp_f32 v199, v199
    v_exp_f32 v200, v200
    v_exp_f32 v201, v201
    v_exp_f32 v202, v202
    v_exp_f32 v203, v203
    v_pk_add_f32 v[196:197], v[196:197], v[186:187]
    v_pk_add_f32 v[198:199], v[198:199], v[186:187]
    v_pk_add_f32 v[200:201], v[200:201], v[186:187]
    v_pk_add_f32 v[202:203], v[202:203], v[186:187]
    v_rcp_f32 v196, v196
    v_rcp_f32 v197, v197
    v_rcp_f32 v198, v198
    v_rcp_f32 v199, v199
    v_rcp_f32 v200, v200
    v_rcp_f32 v201, v201
    v_rcp_f32 v202, v202
    v_rcp_f32 v203, v203
    v_pk_mul_f32 v[196:197], v[196:197], v[48:49]
    v_pk_mul_f32 v[198:199], v[198:199], v[50:51]
    v_pk_mul_f32 v[200:201], v[200:201], v[52:53]
    v_pk_mul_f32 v[202:203], v[202:203], v[54:55]
    v_cvt_pk_bf16_f32 v144, v196, v197
    v_cvt_pk_bf16_f32 v145, v198, v199
    v_cvt_pk_bf16_f32 v146, v200, v201
    v_cvt_pk_bf16_f32 v147, v202, v203
    buffer_store_dwordx4 v[144:147], v2, s[16:19], s32 offen offset:1280 sc1
    ds_write_b128 v3, v[144:147] offset:1280
    v_pk_mul_f32 v[188:189], v[56:57], v[56:57]
    v_pk_mul_f32 v[190:191], v[58:59], v[58:59]
    v_pk_mul_f32 v[192:193], v[60:61], v[60:61]
    v_pk_mul_f32 v[194:195], v[62:63], v[62:63]
    v_pk_fma_f32 v[188:189], v[188:189], v[6:7], v[4:5]
    v_pk_fma_f32 v[190:191], v[190:191], v[6:7], v[4:5]
    v_pk_fma_f32 v[192:193], v[192:193], v[6:7], v[4:5]
    v_pk_fma_f32 v[194:195], v[194:195], v[6:7], v[4:5]
    v_pk_mul_f32 v[188:189], v[188:189], v[56:57]
    v_pk_mul_f32 v[190:191], v[190:191], v[58:59]
    v_pk_mul_f32 v[192:193], v[192:193], v[60:61]
    v_pk_mul_f32 v[194:195], v[194:195], v[62:63]
    v_exp_f32 v188, v188
    v_exp_f32 v189, v189
    v_exp_f32 v190, v190
    v_exp_f32 v191, v191
    v_exp_f32 v192, v192
    v_exp_f32 v193, v193
    v_exp_f32 v194, v194
    v_exp_f32 v195, v195
    v_pk_add_f32 v[188:189], v[188:189], v[186:187]
    v_pk_add_f32 v[190:191], v[190:191], v[186:187]
    v_pk_add_f32 v[192:193], v[192:193], v[186:187]
    v_pk_add_f32 v[194:195], v[194:195], v[186:187]
    v_rcp_f32 v188, v188
    v_rcp_f32 v189, v189
    v_rcp_f32 v190, v190
    v_rcp_f32 v191, v191
    v_rcp_f32 v192, v192
    v_rcp_f32 v193, v193
    v_rcp_f32 v194, v194
    v_rcp_f32 v195, v195
    v_pk_mul_f32 v[188:189], v[188:189], v[56:57]
    v_pk_mul_f32 v[190:191], v[190:191], v[58:59]
    v_pk_mul_f32 v[192:193], v[192:193], v[60:61]
    v_pk_mul_f32 v[194:195], v[194:195], v[62:63]
    v_cvt_pk_bf16_f32 v148, v188, v189
    v_cvt_pk_bf16_f32 v149, v190, v191
    v_cvt_pk_bf16_f32 v150, v192, v193
    v_cvt_pk_bf16_f32 v151, v194, v195
    buffer_store_dwordx4 v[148:151], v2, s[16:19], s32 offen offset:1536 sc1
    ds_write_b128 v3, v[148:151] offset:1536
    v_pk_mul_f32 v[196:197], v[64:65], v[64:65]
    v_pk_mul_f32 v[198:199], v[66:67], v[66:67]
    v_pk_mul_f32 v[200:201], v[68:69], v[68:69]
    v_pk_mul_f32 v[202:203], v[70:71], v[70:71]
    v_pk_fma_f32 v[196:197], v[196:197], v[6:7], v[4:5]
    v_pk_fma_f32 v[198:199], v[198:199], v[6:7], v[4:5]
    v_pk_fma_f32 v[200:201], v[200:201], v[6:7], v[4:5]
    v_pk_fma_f32 v[202:203], v[202:203], v[6:7], v[4:5]
    v_pk_mul_f32 v[196:197], v[196:197], v[64:65]
    v_pk_mul_f32 v[198:199], v[198:199], v[66:67]
    v_pk_mul_f32 v[200:201], v[200:201], v[68:69]
    v_pk_mul_f32 v[202:203], v[202:203], v[70:71]
    v_exp_f32 v196, v196
    v_exp_f32 v197, v197
    v_exp_f32 v198, v198
    v_exp_f32 v199, v199
    v_exp_f32 v200, v200
    v_exp_f32 v201, v201
    v_exp_f32 v202, v202
    v_exp_f32 v203, v203
    v_pk_add_f32 v[196:197], v[196:197], v[186:187]
    v_pk_add_f32 v[198:199], v[198:199], v[186:187]
    v_pk_add_f32 v[200:201], v[200:201], v[186:187]
    v_pk_add_f32 v[202:203], v[202:203], v[186:187]
    v_rcp_f32 v196, v196
    v_rcp_f32 v197, v197
    v_rcp_f32 v198, v198
    v_rcp_f32 v199, v199
    v_rcp_f32 v200, v200
    v_rcp_f32 v201, v201
    v_rcp_f32 v202, v202
    v_rcp_f32 v203, v203
    v_pk_mul_f32 v[196:197], v[196:197], v[64:65]
    v_pk_mul_f32 v[198:199], v[198:199], v[66:67]
    v_pk_mul_f32 v[200:201], v[200:201], v[68:69]
    v_pk_mul_f32 v[202:203], v[202:203], v[70:71]
    v_cvt_pk_bf16_f32 v152, v196, v197
    v_cvt_pk_bf16_f32 v153, v198, v199
    v_cvt_pk_bf16_f32 v154, v200, v201
    v_cvt_pk_bf16_f32 v155, v202, v203
    buffer_store_dwordx4 v[152:155], v2, s[16:19], s32 offen offset:1792 sc1
    ds_write_b128 v3, v[152:155] offset:1792
    v_pk_mul_f32 v[188:189], v[72:73], v[72:73]
    v_pk_mul_f32 v[190:191], v[74:75], v[74:75]
    v_pk_mul_f32 v[192:193], v[76:77], v[76:77]
    v_pk_mul_f32 v[194:195], v[78:79], v[78:79]
    v_pk_fma_f32 v[188:189], v[188:189], v[6:7], v[4:5]
    v_pk_fma_f32 v[190:191], v[190:191], v[6:7], v[4:5]
    v_pk_fma_f32 v[192:193], v[192:193], v[6:7], v[4:5]
    v_pk_fma_f32 v[194:195], v[194:195], v[6:7], v[4:5]
    v_pk_mul_f32 v[188:189], v[188:189], v[72:73]
    v_pk_mul_f32 v[190:191], v[190:191], v[74:75]
    v_pk_mul_f32 v[192:193], v[192:193], v[76:77]
    v_pk_mul_f32 v[194:195], v[194:195], v[78:79]
    v_exp_f32 v188, v188
    v_exp_f32 v189, v189
    v_exp_f32 v190, v190
    v_exp_f32 v191, v191
    v_exp_f32 v192, v192
    v_exp_f32 v193, v193
    v_exp_f32 v194, v194
    v_exp_f32 v195, v195
    v_pk_add_f32 v[188:189], v[188:189], v[186:187]
    v_pk_add_f32 v[190:191], v[190:191], v[186:187]
    v_pk_add_f32 v[192:193], v[192:193], v[186:187]
    v_pk_add_f32 v[194:195], v[194:195], v[186:187]
    v_rcp_f32 v188, v188
    v_rcp_f32 v189, v189
    v_rcp_f32 v190, v190
    v_rcp_f32 v191, v191
    v_rcp_f32 v192, v192
    v_rcp_f32 v193, v193
    v_rcp_f32 v194, v194
    v_rcp_f32 v195, v195
    v_pk_mul_f32 v[188:189], v[188:189], v[72:73]
    v_pk_mul_f32 v[190:191], v[190:191], v[74:75]
    v_pk_mul_f32 v[192:193], v[192:193], v[76:77]
    v_pk_mul_f32 v[194:195], v[194:195], v[78:79]
    v_cvt_pk_bf16_f32 v156, v188, v189
    v_cvt_pk_bf16_f32 v157, v190, v191
    v_cvt_pk_bf16_f32 v158, v192, v193
    v_cvt_pk_bf16_f32 v159, v194, v195
    buffer_store_dwordx4 v[156:159], v2, s[16:19], s32 offen offset:2048 sc1
    ds_write_b128 v3, v[156:159] offset:2048
    s_branch g2_cons
k2_cv:
    s_lshl_b32 s22, s3, 3
    s_add_u32 s22, s22, s11
    s_sub_u32 s22, s22, 24
    s_mov_b32 s23, 0
    v_mov_b32 v190, 136960
    v_mov_b32 v192, 0
    v_mov_b32 v193, 0
    ds_write_b64 v190, v[192:193]
    s_waitcnt lgkmcnt(0)
    s_mov_b64 s[84:85], s[6:7]
    s_barrier
    s_cmp_eq_u32 s10, 7
    s_cbranch_scc1 cv_agent
    s_load_dwordx8 s[52:59], s[0:1], 8
    s_load_dwordx2 s[60:61], s[0:1], 40
    s_lshl_b32 s42, s22, 3
    s_add_u32 s42, s42, s10
    s_mul_i32 s43, s10, 4352
    s_add_u32 s43, s43, 36864
    s_mov_b32 s46, s22
    s_lshr_b32 s25, s10, 1
    s_cmp_eq_u32 s25, 1
    s_cselect_b32 s41, 2, 1
    s_mov_b32 s40, 0
    s_cbranch_scc0 cv_p
    s_setprio 1
cv_p:
    s_waitcnt lgkmcnt(0)
    s_mov_b32 s20, s52
    s_mov_b32 s21, s53
    s_mov_b32 s22, 147456
    s_mov_b32 s23, 0x20000
    s_mov_b32 s24, s54
    s_mov_b32 s25, s55
    s_mov_b32 s26, 147456
    s_mov_b32 s27, 0x20000
    s_mov_b32 s28, s56
    s_mov_b32 s29, s57
    s_mov_b32 s30, 147456
    s_mov_b32 s31, 0x20000
    s_mov_b32 s32, s58
    s_mov_b32 s33, s59
    s_mov_b32 s34, 147456
    s_mov_b32 s35, 0x20000
    s_mov_b32 s36, s60
    s_mov_b32 s37, s61
    s_mov_b32 s38, 1152
    s_mov_b32 s39, 0x20000
    s_mov_b32 s16, s8
    s_mov_b32 s17, s9
    s_mov_b32 s18, 1152
    s_mov_b32 s19, 0x20000
    s_add_u32 s47, s42, 5
    s_add_u32 s45, s46, 512
    s_cmp_eq_u32 s10, 3
    s_cselect_b32 s47, s45, s47
    s_lshl_b32 s3, s42, 8
    v_lshlrev_b32 v2, 1, v1
    v_add_u32 v2, s3, v2
    s_lshl_b32 s3, s42, 1
    v_mov_b32 v3, s3
    buffer_load_ushort v180, v3, s[36:39], 0 offen
    buffer_load_ushort v176, v2, s[20:23], 0 offen
    buffer_load_ushort v177, v2, s[24:27], 0 offen
    buffer_load_ushort v178, v2, s[28:31], 0 offen
    buffer_load_ushort v179, v2, s[32:35], 0 offen
    v_add_u32 v2, 128, v2
    s_lshl_b32 s3, s42, 1
    v_mov_b32 v3, s3
    buffer_load_ushort v185, v3, s[36:39], 0 offen
    buffer_load_ushort v181, v2, s[20:23], 0 offen
    buffer_load_ushort v182, v2, s[24:27], 0 offen
    buffer_load_ushort v183, v2, s[28:31], 0 offen
    buffer_load_ushort v184, v2, s[32:35], 0 offen
    buffer_load_ushort v186, v3, s[16:19], 0 offen
    s_cmp_eq_u32 s41, 1
    s_cbranch_scc1 cv_k
    s_lshl_b32 s3, s47, 8
    v_lshlrev_b32 v2, 1, v1
    v_add_u32 v2, s3, v2
    s_lshl_b32 s3, s47, 1
    v_mov_b32 v3, s3
    buffer_load_ushort v196, v3, s[36:39], 0 offen
    buffer_load_ushort v192, v2, s[20:23], 0 offen
    buffer_load_ushort v193, v2, s[24:27], 0 offen
    buffer_load_ushort v194, v2, s[28:31], 0 offen
    buffer_load_ushort v195, v2, s[32:35], 0 offen
    v_add_u32 v2, 128, v2
    s_lshl_b32 s3, s47, 1
    v_mov_b32 v3, s3
    buffer_load_ushort v201, v3, s[36:39], 0 offen
    buffer_load_ushort v197, v2, s[20:23], 0 offen
    buffer_load_ushort v198, v2, s[24:27], 0 offen
    buffer_load_ushort v199, v2, s[28:31], 0 offen
    buffer_load_ushort v200, v2, s[32:35], 0 offen
    buffer_load_ushort v202, v3, s[16:19], 0 offen
cv_k:
    v_mov_b32 v12, 0
    v_mov_b32 v13, 0
    v_and_b32 v10, 7, v1
    v_lshlrev_b32 v10, 3, v10
    v_add_u32 v10, s43, v10
    ds_write_b64 v10, v[12:13]
    s_mul_i32 s3, s10, 8704
    s_add_u32 s3, s3, 76032
    v_lshlrev_b32 v2, 2, v1
    v_add_u32 v2, s3, v2
    v_and_b32 v3, 31, v1
    v_mul_u32_u24 v3, 272, v3
    v_lshrrev_b32 v9, 5, v1
    v_lshl_add_u32 v3, v9, 4, v3
    v_add_u32 v3, s3, v3
    v_min_u32 v10, 23, v1
    v_lshlrev_b32 v10, 3, v10
    v_add_u32 v10, s43, v10
    ds_write_b64 v10, v[12:13] offset:4160
    v_mov_b32 v10, s43
    s_waitcnt vmcnt(0)
    ds_write_b16 v10, v186 offset:4224
    v_mov_b32 v4, v176
    v_mov_b32 v5, v177
    v_mov_b32 v6, v178
    v_mov_b32 v7, v179
    v_mov_b32 v8, v180
    v_lshlrev_b32 v8, 16, v8
    v_lshlrev_b32 v4, 16, v4
    v_mul_f32 v8, 0x3fb8aa3b, v8
    v_mul_f32 v4, 0x3fb8aa3b, v4
    v_exp_f32 v8, v8
    v_exp_f32 v4, v4
    v_lshlrev_b32 v5, 16, v5
    v_lshlrev_b32 v6, 16, v6
    v_lshlrev_b32 v7, 16, v7
    v_cvt_pk_bf16_f32 v8, v8, v8
    v_and_b32 v8, 0xffff0000, v8
    v_cvt_pk_bf16_f32 v4, v4, v4
    v_and_b32 v4, 0xffff0000, v4
    v_mul_f32 v4, v4, v8
    v_mul_f32 v5, v5, v8
    v_mul_f32 v4, 0xbfb8aa3b, v4
    v_mul_f32 v5, 0x3e22f983, v5
    v_add_f32 v8, v8, v8
    v_mul_f32 v10, v6, v8
    v_mul_f32 v11, v7, v8
    v_mul_f32 v60, 0x3f800000, v4
    v_mul_f32 v61, 0x3f800000, v5
    v_mul_f32 v62, 0x41000000, v4
    v_mul_f32 v63, 0x41000000, v5
    v_mul_f32 v64, 0x42800000, v4
    v_mul_f32 v65, 0x42800000, v5
    v_mul_f32 v66, 0x43800000, v4
    v_mul_f32 v67, 0x43800000, v5
    v_mul_f32 v68, 0x44800000, v4
    v_mul_f32 v69, 0x44800000, v5
    v_fract_f32 v61, v61
    v_fract_f32 v63, v63
    v_fract_f32 v65, v65
    v_fract_f32 v67, v67
    v_fract_f32 v69, v69
    v_exp_f32 v60, v60
    v_cos_f32 v12, v61
    v_sin_f32 v13, v61
    v_exp_f32 v62, v62
    v_cos_f32 v14, v63
    v_sin_f32 v15, v63
    v_exp_f32 v64, v64
    v_cos_f32 v16, v65
    v_sin_f32 v17, v65
    v_exp_f32 v66, v66
    v_cos_f32 v18, v67
    v_sin_f32 v19, v67
    v_exp_f32 v68, v68
    v_cos_f32 v20, v69
    v_sin_f32 v21, v69
    v_pk_mul_f32 v[12:13], v[12:13], v[60:61] op_sel:[0,0] op_sel_hi:[1,0]
    v_pk_mul_f32 v[14:15], v[14:15], v[62:63] op_sel:[0,0] op_sel_hi:[1,0]
    v_pk_mul_f32 v[16:17], v[16:17], v[64:65] op_sel:[0,0] op_sel_hi:[1,0]
    v_pk_mul_f32 v[18:19], v[18:19], v[66:67] op_sel:[0,0] op_sel_hi:[1,0]
    v_pk_mul_f32 v[20:21], v[20:21], v[68:69] op_sel:[0,0] op_sel_hi:[1,0]
    v_pk_mul_f32 v[128:129], v[12:13], v[12:13] op_sel:[0,0] op_sel_hi:[0,1]
    v_pk_mul_f32 v[130:131], v[14:15], v[14:15] op_sel:[0,0] op_sel_hi:[0,1]
    v_pk_mul_f32 v[132:133], v[16:17], v[16:17] op_sel:[0,0] op_sel_hi:[0,1]
    v_pk_mul_f32 v[134:135], v[18:19], v[18:19] op_sel:[0,0] op_sel_hi:[0,1]
    v_pk_mul_f32 v[136:137], v[10:11], v[12:13] op_sel:[0,0] op_sel_hi:[0,1]
    v_pk_mul_f32 v[138:139], v[10:11], v[18:19] op_sel:[0,0] op_sel_hi:[0,1]
    v_pk_mul_f32 v[140:141], v[10:11], v[20:21] op_sel:[0,0] op_sel_hi:[0,1]
    v_pk_fma_f32 v[22:23], v[12:13], v[12:13], v[128:129] op_sel:[1,1,0] op_sel_hi:[1,0,1] neg_lo:[0,1,0]
    v_pk_fma_f32 v[24:25], v[14:15], v[14:15], v[130:131] op_sel:[1,1,0] op_sel_hi:[1,0,1] neg_lo:[0,1,0]
    v_pk_fma_f32 v[26:27], v[16:17], v[16:17], v[132:133] op_sel:[1,1,0] op_sel_hi:[1,0,1] neg_lo:[0,1,0]
    v_pk_fma_f32 v[28:29], v[18:19], v[18:19], v[134:135] op_sel:[1,1,0] op_sel_hi:[1,0,1] neg_lo:[0,1,0]
    v_pk_fma_f32 v[44:45], v[10:11], v[12:13], v[136:137] op_sel:[1,1,0] op_sel_hi:[1,0,1] neg_lo:[0,1,0]
    v_pk_fma_f32 v[54:55], v[10:11], v[18:19], v[138:139] op_sel:[1,1,0] op_sel_hi:[1,0,1] neg_lo:[0,1,0]
    v_pk_fma_f32 v[60:61], v[10:11], v[20:21], v[140:141] op_sel:[1,1,0] op_sel_hi:[1,0,1] neg_lo:[0,1,0]
    v_mov_b32 v8, 0x3f80
    ds_write_b32 v2, v8
    v_pk_mul_f32 v[128:129], v[22:23], v[22:23] op_sel:[0,0] op_sel_hi:[0,1]
    v_pk_mul_f32 v[130:131], v[24:25], v[24:25] op_sel:[0,0] op_sel_hi:[0,1]
    v_pk_mul_f32 v[132:133], v[16:17], v[26:27] op_sel:[0,0] op_sel_hi:[0,1]
    v_pk_mul_f32 v[134:135], v[14:15], v[24:25] op_sel:[0,0] op_sel_hi:[0,1]
    v_pk_mul_f32 v[136:137], v[10:11], v[22:23] op_sel:[0,0] op_sel_hi:[0,1]
    v_pk_mul_f32 v[138:139], v[44:45], v[22:23] op_sel:[0,0] op_sel_hi:[0,1]
    v_pk_mul_f32 v[140:141], v[10:11], v[28:29] op_sel:[0,0] op_sel_hi:[0,1]
    v_pk_fma_f32 v[30:31], v[22:23], v[22:23], v[128:129] op_sel:[1,1,0] op_sel_hi:[1,0,1] neg_lo:[0,1,0]
    v_pk_fma_f32 v[32:33], v[24:25], v[24:25], v[130:131] op_sel:[1,1,0] op_sel_hi:[1,0,1] neg_lo:[0,1,0]
    v_pk_fma_f32 v[34:35], v[16:17], v[26:27], v[132:133] op_sel:[1,1,0] op_sel_hi:[1,0,1] neg_lo:[0,1,0]
    v_pk_fma_f32 v[36:37], v[14:15], v[24:25], v[134:135] op_sel:[1,1,0] op_sel_hi:[1,0,1] neg_lo:[0,1,0]
    v_pk_fma_f32 v[46:47], v[10:11], v[22:23], v[136:137] op_sel:[1,1,0] op_sel_hi:[1,0,1] neg_lo:[0,1,0]
    v_pk_fma_f32 v[48:49], v[44:45], v[22:23], v[138:139] op_sel:[1,1,0] op_sel_hi:[1,0,1] neg_lo:[0,1,0]
    v_pk_fma_f32 v[56:57], v[10:11], v[28:29], v[140:141] op_sel:[1,1,0] op_sel_hi:[1,0,1] neg_lo:[0,1,0]
    v_pk_mul_f32 v[128:129], v[14:15], v[32:33] op_sel:[0,0] op_sel_hi:[0,1]
    v_pk_mul_f32 v[130:131], v[24:25], v[32:33] op_sel:[0,0] op_sel_hi:[0,1]
    v_pk_mul_f32 v[132:133], v[36:37], v[32:33] op_sel:[0,0] op_sel_hi:[0,1]
    v_pk_mul_f32 v[134:135], v[10:11], v[30:31] op_sel:[0,0] op_sel_hi:[0,1]
    v_pk_mul_f32 v[136:137], v[46:47], v[30:31] op_sel:[0,0] op_sel_hi:[0,1]
    v_pk_fma_f32 v[38:39], v[14:15], v[32:33], v[128:129] op_sel:[1,1,0] op_sel_hi:[1,0,1] neg_lo:[0,1,0]
    v_pk_fma_f32 v[40:41], v[24:25], v[32:33], v[130:131] op_sel:[1,1,0] op_sel_hi:[1,0,1] neg_lo:[0,1,0]
    v_pk_fma_f32 v[42:43], v[36:37], v[32:33], v[132:133] op_sel:[1,1,0] op_sel_hi:[1,0,1] neg_lo:[0,1,0]
    v_pk_fma_f32 v[50:51], v[10:11], v[30:31], v[134:135] op_sel:[1,1,0] op_sel_hi:[1,0,1] neg_lo:[0,1,0]
    v_pk_fma_f32 v[52:53], v[46:47], v[30:31], v[136:137] op_sel:[1,1,0] op_sel_hi:[1,0,1] neg_lo:[0,1,0]
    v_cvt_pk_bf16_f32 v144, v14, v15
    v_cvt_pk_bf16_f32 v145, v24, v25
    v_cvt_pk_bf16_f32 v146, v36, v37
    v_cvt_pk_bf16_f32 v147, v32, v33
    v_cvt_pk_bf16_f32 v148, v38, v39
    v_cvt_pk_bf16_f32 v149, v40, v41
    v_cvt_pk_bf16_f32 v150, v42, v43
    v_cvt_pk_bf16_f32 v151, v16, v17
    v_cvt_pk_bf16_f32 v152, v26, v27
    v_cvt_pk_bf16_f32 v153, v34, v35
    ds_write_b32 v2, v144 offset:272
    ds_write_b32 v2, v145 offset:544
    ds_write_b32 v2, v146 offset:816
    ds_write_b32 v2, v147 offset:1088
    ds_write_b32 v2, v148 offset:1360
    ds_write_b32 v2, v149 offset:1632
    ds_write_b32 v2, v150 offset:1904
    ds_write_b32 v2, v151 offset:2176
    ds_write_b32 v2, v152 offset:4352
    ds_write_b32 v2, v153 offset:6528
    v_pk_mul_f32 v[128:129], v[14:15], v[16:17] op_sel:[0,0] op_sel_hi:[0,1]
    v_pk_mul_f32 v[130:131], v[24:25], v[16:17] op_sel:[0,0] op_sel_hi:[0,1]
    v_pk_mul_f32 v[132:133], v[36:37], v[16:17] op_sel:[0,0] op_sel_hi:[0,1]
    v_pk_mul_f32 v[134:135], v[32:33], v[16:17] op_sel:[0,0] op_sel_hi:[0,1]
    v_pk_mul_f32 v[136:137], v[38:39], v[16:17] op_sel:[0,0] op_sel_hi:[0,1]
    v_pk_mul_f32 v[138:139], v[40:41], v[16:17] op_sel:[0,0] op_sel_hi:[0,1]
    v_pk_mul_f32 v[140:141], v[42:43], v[16:17] op_sel:[0,0] op_sel_hi:[0,1]
    v_pk_fma_f32 v[98:99], v[14:15], v[16:17], v[128:129] op_sel:[1,1,0] op_sel_hi:[1,0,1] neg_lo:[0,1,0]
    v_pk_fma_f32 v[100:101], v[24:25], v[16:17], v[130:131] op_sel:[1,1,0] op_sel_hi:[1,0,1] neg_lo:[0,1,0]
    v_pk_fma_f32 v[102:103], v[36:37], v[16:17], v[132:133] op_sel:[1,1,0] op_sel_hi:[1,0,1] neg_lo:[0,1,0]
    v_pk_fma_f32 v[104:105], v[32:33], v[16:17], v[134:135] op_sel:[1,1,0] op_sel_hi:[1,0,1] neg_lo:[0,1,0]
    v_pk_fma_f32 v[106:107], v[38:39], v[16:17], v[136:137] op_sel:[1,1,0] op_sel_hi:[1,0,1] neg_lo:[0,1,0]
    v_pk_fma_f32 v[108:109], v[40:41], v[16:17], v[138:139] op_sel:[1,1,0] op_sel_hi:[1,0,1] neg_lo:[0,1,0]
    v_pk_fma_f32 v[110:111], v[42:43], v[16:17], v[140:141] op_sel:[1,1,0] op_sel_hi:[1,0,1] neg_lo:[0,1,0]
    v_cvt_pk_bf16_f32 v144, v98, v99
    v_cvt_pk_bf16_f32 v145, v100, v101
    v_cvt_pk_bf16_f32 v146, v102, v103
    v_cvt_pk_bf16_f32 v147, v104, v105
    v_cvt_pk_bf16_f32 v148, v106, v107
    v_cvt_pk_bf16_f32 v149, v108, v109
    v_cvt_pk_bf16_f32 v150, v110, v111
    ds_write_b32 v2, v144 offset:2448
    ds_write_b32 v2, v145 offset:2720
    ds_write_b32 v2, v146 offset:2992
    ds_write_b32 v2, v147 offset:3264
    ds_write_b32 v2, v148 offset:3536
    ds_write_b32 v2, v149 offset:3808
    ds_write_b32 v2, v150 offset:4080
    v_pk_mul_f32 v[128:129], v[14:15], v[26:27] op_sel:[0,0] op_sel_hi:[0,1]
    v_pk_mul_f32 v[130:131], v[24:25], v[26:27] op_sel:[0,0] op_sel_hi:[0,1]
    v_pk_mul_f32 v[132:133], v[36:37], v[26:27] op_sel:[0,0] op_sel_hi:[0,1]
    v_pk_mul_f32 v[134:135], v[32:33], v[26:27] op_sel:[0,0] op_sel_hi:[0,1]
    v_pk_mul_f32 v[136:137], v[38:39], v[26:27] op_sel:[0,0] op_sel_hi:[0,1]
    v_pk_mul_f32 v[138:139], v[40:41], v[26:27] op_sel:[0,0] op_sel_hi:[0,1]
    v_pk_mul_f32 v[140:141], v[42:43], v[26:27] op_sel:[0,0] op_sel_hi:[0,1]
    v_pk_fma_f32 v[98:99], v[14:15], v[26:27], v[128:129] op_sel:[1,1,0] op_sel_hi:[1,0,1] neg_lo:[0,1,0]
    v_pk_fma_f32 v[100:101], v[24:25], v[26:27], v[130:131] op_sel:[1,1,0] op_sel_hi:[1,0,1] neg_lo:[0,1,0]
    v_pk_fma_f32 v[102:103], v[36:37], v[26:27], v[132:133] op_sel:[1,1,0] op_sel_hi:[1,0,1] neg_lo:[0,1,0]
    v_pk_fma_f32 v[104:105], v[32:33], v[26:27], v[134:135] op_sel:[1,1,0] op_sel_hi:[1,0,1] neg_lo:[0,1,0]
    v_pk_fma_f32 v[106:107], v[38:39], v[26:27], v[136:137] op_sel:[1,1,0] op_sel_hi:[1,0,1] neg_lo:[0,1,0]
    v_pk_fma_f32 v[108:109], v[40:41], v[26:27], v[138:139] op_sel:[1,1,0] op_sel_hi:[1,0,1] neg_lo:[0,1,0]
    v_pk_fma_f32 v[110:111], v[42:43], v[26:27], v[140:141] op_sel:[1,1,0] op_sel_hi:[1,0,1] neg_lo:[0,1,0]
    v_cvt_pk_bf16_f32 v144, v98, v99
    v_cvt_pk_bf16_f32 v145, v100, v101
    v_cvt_pk_bf16_f32 v146, v102, v103
    v_cvt_pk_bf16_f32 v147, v104, v105
    v_cvt_pk_bf16_f32 v148, v106, v107
    v_cvt_pk_bf16_f32 v149, v108, v109
    v_cvt_pk_bf16_f32 v150, v110, v111
    ds_write_b32 v2, v144 offset:4624
    ds_write_b32 v2, v145 offset:4896
    ds_write_b32 v2, v146 offset:5168
    ds_write_b32 v2, v147 offset:5440
    ds_write_b32 v2, v148 offset:5712
    ds_write_b32 v2, v149 offset:5984
    ds_write_b32 v2, v150 offset:6256
    v_pk_mul_f32 v[128:129], v[14:15], v[34:35] op_sel:[0,0] op_sel_hi:[0,1]
    v_pk_mul_f32 v[130:131], v[24:25], v[34:35] op_sel:[0,0] op_sel_hi:[0,1]
    v_pk_mul_f32 v[132:133], v[36:37], v[34:35] op_sel:[0,0] op_sel_hi:[0,1]
    v_pk_mul_f32 v[134:135], v[32:33], v[34:35] op_sel:[0,0] op_sel_hi:[0,1]
    v_pk_mul_f32 v[136:137], v[38:39], v[34:35] op_sel:[0,0] op_sel_hi:[0,1]
    v_pk_mul_f32 v[138:139], v[40:41], v[34:35] op_sel:[0,0] op_sel_hi:[0,1]
    v_pk_mul_f32 v[140:141], v[42:43], v[34:35] op_sel:[0,0] op_sel_hi:[0,1]
    v_pk_fma_f32 v[98:99], v[14:15], v[34:35], v[128:129] op_sel:[1,1,0] op_sel_hi:[1,0,1] neg_lo:[0,1,0]
    v_pk_fma_f32 v[100:101], v[24:25], v[34:35], v[130:131] op_sel:[1,1,0] op_sel_hi:[1,0,1] neg_lo:[0,1,0]
    v_pk_fma_f32 v[102:103], v[36:37], v[34:35], v[132:133] op_sel:[1,1,0] op_sel_hi:[1,0,1] neg_lo:[0,1,0]
    v_pk_fma_f32 v[104:105], v[32:33], v[34:35], v[134:135] op_sel:[1,1,0] op_sel_hi:[1,0,1] neg_lo:[0,1,0]
    v_pk_fma_f32 v[106:107], v[38:39], v[34:35], v[136:137] op_sel:[1,1,0] op_sel_hi:[1,0,1] neg_lo:[0,1,0]
    v_pk_fma_f32 v[108:109], v[40:41], v[34:35], v[138:139] op_sel:[1,1,0] op_sel_hi:[1,0,1] neg_lo:[0,1,0]
    v_pk_fma_f32 v[110:111], v[42:43], v[34:35], v[140:141] op_sel:[1,1,0] op_sel_hi:[1,0,1] neg_lo:[0,1,0]
    v_cvt_pk_bf16_f32 v144, v98, v99
    v_cvt_pk_bf16_f32 v145, v100, v101
    v_cvt_pk_bf16_f32 v146, v102, v103
    v_cvt_pk_bf16_f32 v147, v104, v105
    v_cvt_pk_bf16_f32 v148, v106, v107
    v_cvt_pk_bf16_f32 v149, v108, v109
    v_cvt_pk_bf16_f32 v150, v110, v111
    ds_write_b32 v2, v144 offset:6800
    ds_write_b32 v2, v145 offset:7072
    ds_write_b32 v2, v146 offset:7344
    ds_write_b32 v2, v147 offset:7616
    ds_write_b32 v2, v148 offset:7888
    ds_write_b32 v2, v149 offset:8160
    ds_write_b32 v2, v150 offset:8432
    v_pk_mul_f32 v[128:129], v[50:51], v[28:29] op_sel:[0,0] op_sel_hi:[0,1]
    v_pk_mul_f32 v[130:131], v[56:57], v[18:19] op_sel:[0,0] op_sel_hi:[0,1]
    v_pk_mul_f32 v[132:133], v[60:61], v[18:19] op_sel:[0,0] op_sel_hi:[0,1]
    v_pk_mul_f32 v[134:135], v[60:61], v[28:29] op_sel:[0,0] op_sel_hi:[0,1]
    v_pk_fma_f32 v[58:59], v[50:51], v[28:29], v[128:129] op_sel:[1,1,0] op_sel_hi:[1,0,1] neg_lo:[0,1,0]
    v_pk_fma_f32 v[62:63], v[56:57], v[18:19], v[130:131] op_sel:[1,1,0] op_sel_hi:[1,0,1] neg_lo:[0,1,0]
    v_pk_fma_f32 v[64:65], v[60:61], v[18:19], v[132:133] op_sel:[1,1,0] op_sel_hi:[1,0,1] neg_lo:[0,1,0]
    v_pk_fma_f32 v[66:67], v[60:61], v[28:29], v[134:135] op_sel:[1,1,0] op_sel_hi:[1,0,1] neg_lo:[0,1,0]
    ds_read_b128 v[96:99], v3 offset:0
    ds_read_b128 v[100:103], v3 offset:32
    ds_read_b128 v[104:107], v3 offset:64
    ds_read_b128 v[108:111], v3 offset:96
    ds_read_b128 v[112:115], v3 offset:128
    ds_read_b128 v[116:119], v3 offset:160
    ds_read_b128 v[120:123], v3 offset:192
    ds_read_b128 v[124:127], v3 offset:224
    v_pk_mul_f32 v[128:129], v[66:67], v[18:19] op_sel:[0,0] op_sel_hi:[0,1]
    v_pk_mul_f32 v[130:131], v[44:45], v[30:31] op_sel:[0,0] op_sel_hi:[0,1]
    v_pk_mul_f32 v[132:133], v[48:49], v[30:31] op_sel:[0,0] op_sel_hi:[0,1]
    v_pk_mul_f32 v[134:135], v[46:47], v[18:19] op_sel:[0,0] op_sel_hi:[0,1]
    v_pk_mul_f32 v[136:137], v[50:51], v[18:19] op_sel:[0,0] op_sel_hi:[0,1]
    v_pk_mul_f32 v[138:139], v[52:53], v[18:19] op_sel:[0,0] op_sel_hi:[0,1]
    v_pk_mul_f32 v[140:141], v[58:59], v[18:19] op_sel:[0,0] op_sel_hi:[0,1]
    v_pk_fma_f32 v[68:69], v[66:67], v[18:19], v[128:129] op_sel:[1,1,0] op_sel_hi:[1,0,1] neg_lo:[0,1,0]
    v_pk_fma_f32 v[160:161], v[44:45], v[30:31], v[130:131] op_sel:[1,1,0] op_sel_hi:[1,0,1] neg_lo:[0,1,0]
    v_pk_fma_f32 v[162:163], v[48:49], v[30:31], v[132:133] op_sel:[1,1,0] op_sel_hi:[1,0,1] neg_lo:[0,1,0]
    v_pk_fma_f32 v[164:165], v[46:47], v[18:19], v[134:135] op_sel:[1,1,0] op_sel_hi:[1,0,1] neg_lo:[0,1,0]
    v_pk_fma_f32 v[166:167], v[50:51], v[18:19], v[136:137] op_sel:[1,1,0] op_sel_hi:[1,0,1] neg_lo:[0,1,0]
    v_pk_fma_f32 v[168:169], v[52:53], v[18:19], v[138:139] op_sel:[1,1,0] op_sel_hi:[1,0,1] neg_lo:[0,1,0]
    v_pk_fma_f32 v[170:171], v[58:59], v[18:19], v[140:141] op_sel:[1,1,0] op_sel_hi:[1,0,1] neg_lo:[0,1,0]
    v_cvt_pk_bf16_f32 v144, v10, -v11
    v_cvt_pk_bf16_f32 v145, v44, -v45
    v_cvt_pk_bf16_f32 v146, v46, -v47
    v_cvt_pk_bf16_f32 v147, v48, -v49
    v_cvt_pk_bf16_f32 v148, v50, -v51
    v_cvt_pk_bf16_f32 v149, v52, -v53
    v_cvt_pk_bf16_f32 v150, v54, -v55
    v_cvt_pk_bf16_f32 v151, v56, -v57
    v_cvt_pk_bf16_f32 v152, v58, -v59
    v_cvt_pk_bf16_f32 v153, v60, -v61
    v_cvt_pk_bf16_f32 v154, v62, -v63
    v_cvt_pk_bf16_f32 v155, v64, -v65
    v_cvt_pk_bf16_f32 v156, v66, -v67
    v_cvt_pk_bf16_f32 v157, v68, -v69
    ds_write_b32 v2, v144 offset:0
    ds_write_b32 v2, v145 offset:272
    ds_write_b32 v2, v146 offset:544
    ds_write_b32 v2, v147 offset:816
    ds_write_b32 v2, v148 offset:1088
    ds_write_b32 v2, v149 offset:1632
    ds_write_b32 v2, v150 offset:2176
    ds_write_b32 v2, v151 offset:4624
    ds_write_b32 v2, v152 offset:4896
    ds_write_b32 v2, v153 offset:3264
    ds_write_b32 v2, v154 offset:6528
    ds_write_b32 v2, v155 offset:3808
    ds_write_b32 v2, v156 offset:5440
    ds_write_b32 v2, v157 offset:5984
    v_cvt_pk_bf16_f32 v144, v160, -v161
    v_cvt_pk_bf16_f32 v145, v162, -v163
    v_cvt_pk_bf16_f32 v146, v164, -v165
    v_cvt_pk_bf16_f32 v147, v166, -v167
    v_cvt_pk_bf16_f32 v148, v168, -v169
    v_cvt_pk_bf16_f32 v149, v170, -v171
    ds_write_b32 v2, v144 offset:1360
    ds_write_b32 v2, v145 offset:1904
    ds_write_b32 v2, v146 offset:2448
    ds_write_b32 v2, v147 offset:2720
    ds_write_b32 v2, v148 offset:2992
    ds_write_b32 v2, v149 offset:6800
    v_pk_mul_f32 v[128:129], v[54:55], v[14:15] op_sel:[0,0] op_sel_hi:[0,1]
    v_pk_mul_f32 v[130:131], v[56:57], v[14:15] op_sel:[0,0] op_sel_hi:[0,1]
    v_pk_mul_f32 v[132:133], v[62:63], v[14:15] op_sel:[0,0] op_sel_hi:[0,1]
    v_pk_mul_f32 v[134:135], v[60:61], v[14:15] op_sel:[0,0] op_sel_hi:[0,1]
    v_pk_mul_f32 v[136:137], v[64:65], v[14:15] op_sel:[0,0] op_sel_hi:[0,1]
    v_pk_mul_f32 v[138:139], v[66:67], v[14:15] op_sel:[0,0] op_sel_hi:[0,1]
    v_pk_mul_f32 v[140:141], v[68:69], v[14:15] op_sel:[0,0] op_sel_hi:[0,1]
    v_pk_fma_f32 v[160:161], v[54:55], v[14:15], v[128:129] op_sel:[1,1,0] op_sel_hi:[1,0,1] neg_lo:[0,1,0]
    v_pk_fma_f32 v[162:163], v[56:57], v[14:15], v[130:131] op_sel:[1,1,0] op_sel_hi:[1,0,1] neg_lo:[0,1,0]
    v_pk_fma_f32 v[164:165], v[62:63], v[14:15], v[132:133] op_sel:[1,1,0] op_sel_hi:[1,0,1] neg_lo:[0,1,0]
    v_pk_fma_f32 v[166:167], v[60:61], v[14:15], v[134:135] op_sel:[1,1,0] op_sel_hi:[1,0,1] neg_lo:[0,1,0]
    v_pk_fma_f32 v[168:169], v[64:65], v[14:15], v[136:137] op_sel:[1,1,0] op_sel_hi:[1,0,1] neg_lo:[0,1,0]
    v_pk_fma_f32 v[170:171], v[66:67], v[14:15], v[138:139] op_sel:[1,1,0] op_sel_hi:[1,0,1] neg_lo:[0,1,0]
    v_pk_fma_f32 v[172:173], v[68:69], v[14:15], v[140:141] op_sel:[1,1,0] op_sel_hi:[1,0,1] neg_lo:[0,1,0]
    v_cvt_pk_bf16_f32 v144, v160, -v161
    v_cvt_pk_bf16_f32 v145, v162, -v163
    v_cvt_pk_bf16_f32 v146, v164, -v165
    v_cvt_pk_bf16_f32 v147, v166, -v167
    v_cvt_pk_bf16_f32 v148, v168, -v169
    v_cvt_pk_bf16_f32 v149, v170, -v171
    v_cvt_pk_bf16_f32 v150, v172, -v173
    ds_write_b32 v2, v144 offset:4352
    ds_write_b32 v2, v145 offset:5168
    ds_write_b32 v2, v146 offset:7072
    ds_write_b32 v2, v147 offset:3536
    ds_write_b32 v2, v148 offset:4080
    ds_write_b32 v2, v149 offset:5712
    ds_write_b32 v2, v150 offset:6256
    ds_read_b128 v[128:131], v3 offset:0
    ds_read_b128 v[132:135], v3 offset:32
    ds_read_b128 v[136:139], v3 offset:64
    ds_read_b128 v[140:143], v3 offset:96
    ds_read_b128 v[144:147], v3 offset:128
    ds_read_b128 v[148:151], v3 offset:160
    ds_read_b128 v[152:155], v3 offset:192
    ds_read_b128 v[156:159], v3 offset:224
    s_waitcnt lgkmcnt(7)
    v_mfma_f32_32x32x16_bf16 v[80:95], v[128:131], v[96:99], 0
    s_waitcnt lgkmcnt(6)
    v_mfma_f32_32x32x16_bf16 v[80:95], v[132:135], v[100:103], v[80:95]
    s_waitcnt lgkmcnt(5)
    v_mfma_f32_32x32x16_bf16 v[80:95], v[136:139], v[104:107], v[80:95]
    s_waitcnt lgkmcnt(4)
    v_mfma_f32_32x32x16_bf16 v[80:95], v[140:143], v[108:111], v[80:95]
    s_waitcnt lgkmcnt(3)
    v_mfma_f32_32x32x16_bf16 v[80:95], v[144:147], v[112:115], v[80:95]
    s_waitcnt lgkmcnt(2)
    v_mfma_f32_32x32x16_bf16 v[80:95], v[148:151], v[116:119], v[80:95]
    s_waitcnt lgkmcnt(1)
    v_mfma_f32_32x32x16_bf16 v[80:95], v[152:155], v[120:123], v[80:95]
    s_waitcnt lgkmcnt(0)
    v_mfma_f32_32x32x16_bf16 v[80:95], v[156:159], v[124:127], v[80:95]
    v_mov_b32 v4, v181
    v_mov_b32 v5, v182
    v_mov_b32 v6, v183
    v_mov_b32 v7, v184
    v_mov_b32 v8, v185
    v_lshlrev_b32 v8, 16, v8
    v_lshlrev_b32 v4, 16, v4
    v_mul_f32 v8, 0x3fb8aa3b, v8
    v_mul_f32 v4, 0x3fb8aa3b, v4
    v_exp_f32 v8, v8
    v_exp_f32 v4, v4
    v_lshlrev_b32 v5, 16, v5
    v_lshlrev_b32 v6, 16, v6
    v_lshlrev_b32 v7, 16, v7
    v_cvt_pk_bf16_f32 v8, v8, v8
    v_and_b32 v8, 0xffff0000, v8
    v_cvt_pk_bf16_f32 v4, v4, v4
    v_and_b32 v4, 0xffff0000, v4
    v_mul_f32 v4, v4, v8
    v_mul_f32 v5, v5, v8
    v_mul_f32 v4, 0xbfb8aa3b, v4
    v_mul_f32 v5, 0x3e22f983, v5
    v_add_f32 v8, v8, v8
    v_mul_f32 v10, v6, v8
    v_mul_f32 v11, v7, v8
    v_mul_f32 v60, 0x3f800000, v4
    v_mul_f32 v61, 0x3f800000, v5
    v_mul_f32 v62, 0x41000000, v4
    v_mul_f32 v63, 0x41000000, v5
    v_mul_f32 v64, 0x42800000, v4
    v_mul_f32 v65, 0x42800000, v5
    v_mul_f32 v66, 0x43800000, v4
    v_mul_f32 v67, 0x43800000, v5
    v_mul_f32 v68, 0x44800000, v4
    v_mul_f32 v69, 0x44800000, v5
    v_fract_f32 v61, v61
    v_fract_f32 v63, v63
    v_fract_f32 v65, v65
    v_fract_f32 v67, v67
    v_fract_f32 v69, v69
    v_exp_f32 v60, v60
    v_cos_f32 v12, v61
    v_sin_f32 v13, v61
    v_exp_f32 v62, v62
    v_cos_f32 v14, v63
    v_sin_f32 v15, v63
    v_exp_f32 v64, v64
    v_cos_f32 v16, v65
    v_sin_f32 v17, v65
    v_exp_f32 v66, v66
    v_cos_f32 v18, v67
    v_sin_f32 v19, v67
    v_exp_f32 v68, v68
    v_cos_f32 v20, v69
    v_sin_f32 v21, v69
    v_pk_mul_f32 v[12:13], v[12:13], v[60:61] op_sel:[0,0] op_sel_hi:[1,0]
    v_pk_mul_f32 v[14:15], v[14:15], v[62:63] op_sel:[0,0] op_sel_hi:[1,0]
    v_pk_mul_f32 v[16:17], v[16:17], v[64:65] op_sel:[0,0] op_sel_hi:[1,0]
    v_pk_mul_f32 v[18:19], v[18:19], v[66:67] op_sel:[0,0] op_sel_hi:[1,0]
    v_pk_mul_f32 v[20:21], v[20:21], v[68:69] op_sel:[0,0] op_sel_hi:[1,0]
    v_pk_mul_f32 v[128:129], v[12:13], v[12:13] op_sel:[0,0] op_sel_hi:[0,1]
    v_pk_mul_f32 v[130:131], v[14:15], v[14:15] op_sel:[0,0] op_sel_hi:[0,1]
    v_pk_mul_f32 v[132:133], v[16:17], v[16:17] op_sel:[0,0] op_sel_hi:[0,1]
    v_pk_mul_f32 v[134:135], v[18:19], v[18:19] op_sel:[0,0] op_sel_hi:[0,1]
    v_pk_mul_f32 v[136:137], v[10:11], v[12:13] op_sel:[0,0] op_sel_hi:[0,1]
    v_pk_mul_f32 v[138:139], v[10:11], v[18:19] op_sel:[0,0] op_sel_hi:[0,1]
    v_pk_mul_f32 v[140:141], v[10:11], v[20:21] op_sel:[0,0] op_sel_hi:[0,1]
    v_pk_fma_f32 v[22:23], v[12:13], v[12:13], v[128:129] op_sel:[1,1,0] op_sel_hi:[1,0,1] neg_lo:[0,1,0]
    v_pk_fma_f32 v[24:25], v[14:15], v[14:15], v[130:131] op_sel:[1,1,0] op_sel_hi:[1,0,1] neg_lo:[0,1,0]
    v_pk_fma_f32 v[26:27], v[16:17], v[16:17], v[132:133] op_sel:[1,1,0] op_sel_hi:[1,0,1] neg_lo:[0,1,0]
    v_pk_fma_f32 v[28:29], v[18:19], v[18:19], v[134:135] op_sel:[1,1,0] op_sel_hi:[1,0,1] neg_lo:[0,1,0]
    v_pk_fma_f32 v[44:45], v[10:11], v[12:13], v[136:137] op_sel:[1,1,0] op_sel_hi:[1,0,1] neg_lo:[0,1,0]
    v_pk_fma_f32 v[54:55], v[10:11], v[18:19], v[138:139] op_sel:[1,1,0] op_sel_hi:[1,0,1] neg_lo:[0,1,0]
    v_pk_fma_f32 v[60:61], v[10:11], v[20:21], v[140:141] op_sel:[1,1,0] op_sel_hi:[1,0,1] neg_lo:[0,1,0]
    v_mov_b32 v8, 0x3f80
    ds_write_b32 v2, v8
    v_pk_mul_f32 v[128:129], v[22:23], v[22:23] op_sel:[0,0] op_sel_hi:[0,1]
    v_pk_mul_f32 v[130:131], v[24:25], v[24:25] op_sel:[0,0] op_sel_hi:[0,1]
    v_pk_mul_f32 v[132:133], v[16:17], v[26:27] op_sel:[0,0] op_sel_hi:[0,1]
    v_pk_mul_f32 v[134:135], v[14:15], v[24:25] op_sel:[0,0] op_sel_hi:[0,1]
    v_pk_mul_f32 v[136:137], v[10:11], v[22:23] op_sel:[0,0] op_sel_hi:[0,1]
    v_pk_mul_f32 v[138:139], v[44:45], v[22:23] op_sel:[0,0] op_sel_hi:[0,1]
    v_pk_mul_f32 v[140:141], v[10:11], v[28:29] op_sel:[0,0] op_sel_hi:[0,1]
    v_pk_fma_f32 v[30:31], v[22:23], v[22:23], v[128:129] op_sel:[1,1,0] op_sel_hi:[1,0,1] neg_lo:[0,1,0]
    v_pk_fma_f32 v[32:33], v[24:25], v[24:25], v[130:131] op_sel:[1,1,0] op_sel_hi:[1,0,1] neg_lo:[0,1,0]
    v_pk_fma_f32 v[34:35], v[16:17], v[26:27], v[132:133] op_sel:[1,1,0] op_sel_hi:[1,0,1] neg_lo:[0,1,0]
    v_pk_fma_f32 v[36:37], v[14:15], v[24:25], v[134:135] op_sel:[1,1,0] op_sel_hi:[1,0,1] neg_lo:[0,1,0]
    v_pk_fma_f32 v[46:47], v[10:11], v[22:23], v[136:137] op_sel:[1,1,0] op_sel_hi:[1,0,1] neg_lo:[0,1,0]
    v_pk_fma_f32 v[48:49], v[44:45], v[22:23], v[138:139] op_sel:[1,1,0] op_sel_hi:[1,0,1] neg_lo:[0,1,0]
    v_pk_fma_f32 v[56:57], v[10:11], v[28:29], v[140:141] op_sel:[1,1,0] op_sel_hi:[1,0,1] neg_lo:[0,1,0]
    v_pk_mul_f32 v[128:129], v[14:15], v[32:33] op_sel:[0,0] op_sel_hi:[0,1]
    v_pk_mul_f32 v[130:131], v[24:25], v[32:33] op_sel:[0,0] op_sel_hi:[0,1]
    v_pk_mul_f32 v[132:133], v[36:37], v[32:33] op_sel:[0,0] op_sel_hi:[0,1]
    v_pk_mul_f32 v[134:135], v[10:11], v[30:31] op_sel:[0,0] op_sel_hi:[0,1]
    v_pk_mul_f32 v[136:137], v[46:47], v[30:31] op_sel:[0,0] op_sel_hi:[0,1]
    v_pk_fma_f32 v[38:39], v[14:15], v[32:33], v[128:129] op_sel:[1,1,0] op_sel_hi:[1,0,1] neg_lo:[0,1,0]
    v_pk_fma_f32 v[40:41], v[24:25], v[32:33], v[130:131] op_sel:[1,1,0] op_sel_hi:[1,0,1] neg_lo:[0,1,0]
    v_pk_fma_f32 v[42:43], v[36:37], v[32:33], v[132:133] op_sel:[1,1,0] op_sel_hi:[1,0,1] neg_lo:[0,1,0]
    v_pk_fma_f32 v[50:51], v[10:11], v[30:31], v[134:135] op_sel:[1,1,0] op_sel_hi:[1,0,1] neg_lo:[0,1,0]
    v_pk_fma_f32 v[52:53], v[46:47], v[30:31], v[136:137] op_sel:[1,1,0] op_sel_hi:[1,0,1] neg_lo:[0,1,0]
    v_cvt_pk_bf16_f32 v144, v14, v15
    v_cvt_pk_bf16_f32 v145, v24, v25
    v_cvt_pk_bf16_f32 v146, v36, v37
    v_cvt_pk_bf16_f32 v147, v32, v33
    v_cvt_pk_bf16_f32 v148, v38, v39
    v_cvt_pk_bf16_f32 v149, v40, v41
    v_cvt_pk_bf16_f32 v150, v42, v43
    v_cvt_pk_bf16_f32 v151, v16, v17
    v_cvt_pk_bf16_f32 v152, v26, v27
    v_cvt_pk_bf16_f32 v153, v34, v35
    ds_write_b32 v2, v144 offset:272
    ds_write_b32 v2, v145 offset:544
    ds_write_b32 v2, v146 offset:816
    ds_write_b32 v2, v147 offset:1088
    ds_write_b32 v2, v148 offset:1360
    ds_write_b32 v2, v149 offset:1632
    ds_write_b32 v2, v150 offset:1904
    ds_write_b32 v2, v151 offset:2176
    ds_write_b32 v2, v152 offset:4352
    ds_write_b32 v2, v153 offset:6528
    v_pk_mul_f32 v[128:129], v[14:15], v[16:17] op_sel:[0,0] op_sel_hi:[0,1]
    v_pk_mul_f32 v[130:131], v[24:25], v[16:17] op_sel:[0,0] op_sel_hi:[0,1]
    v_pk_mul_f32 v[132:133], v[36:37], v[16:17] op_sel:[0,0] op_sel_hi:[0,1]
    v_pk_mul_f32 v[134:135], v[32:33], v[16:17] op_sel:[0,0] op_sel_hi:[0,1]
    v_pk_mul_f32 v[136:137], v[38:39], v[16:17] op_sel:[0,0] op_sel_hi:[0,1]
    v_pk_mul_f32 v[138:139], v[40:41], v[16:17] op_sel:[0,0] op_sel_hi:[0,1]
    v_pk_mul_f32 v[140:141], v[42:43], v[16:17] op_sel:[0,0] op_sel_hi:[0,1]
    v_pk_fma_f32 v[98:99], v[14:15], v[16:17], v[128:129] op_sel:[1,1,0] op_sel_hi:[1,0,1] neg_lo:[0,1,0]
    v_pk_fma_f32 v[100:101], v[24:25], v[16:17], v[130:131] op_sel:[1,1,0] op_sel_hi:[1,0,1] neg_lo:[0,1,0]
    v_pk_fma_f32 v[102:103], v[36:37], v[16:17], v[132:133] op_sel:[1,1,0] op_sel_hi:[1,0,1] neg_lo:[0,1,0]
    v_pk_fma_f32 v[104:105], v[32:33], v[16:17], v[134:135] op_sel:[1,1,0] op_sel_hi:[1,0,1] neg_lo:[0,1,0]
    v_pk_fma_f32 v[106:107], v[38:39], v[16:17], v[136:137] op_sel:[1,1,0] op_sel_hi:[1,0,1] neg_lo:[0,1,0]
    v_pk_fma_f32 v[108:109], v[40:41], v[16:17], v[138:139] op_sel:[1,1,0] op_sel_hi:[1,0,1] neg_lo:[0,1,0]
    v_pk_fma_f32 v[110:111], v[42:43], v[16:17], v[140:141] op_sel:[1,1,0] op_sel_hi:[1,0,1] neg_lo:[0,1,0]
    v_cvt_pk_bf16_f32 v144, v98, v99
    v_cvt_pk_bf16_f32 v145, v100, v101
    v_cvt_pk_bf16_f32 v146, v102, v103
    v_cvt_pk_bf16_f32 v147, v104, v105
    v_cvt_pk_bf16_f32 v148, v106, v107
    v_cvt_pk_bf16_f32 v149, v108, v109
    v_cvt_pk_bf16_f32 v150, v110, v111
    ds_write_b32 v2, v144 offset:2448
    ds_write_b32 v2, v145 offset:2720
    ds_write_b32 v2, v146 offset:2992
    ds_write_b32 v2, v147 offset:3264
    ds_write_b32 v2, v148 offset:3536
    ds_write_b32 v2, v149 offset:3808
    ds_write_b32 v2, v150 offset:4080
    v_pk_mul_f32 v[128:129], v[14:15], v[26:27] op_sel:[0,0] op_sel_hi:[0,1]
    v_pk_mul_f32 v[130:131], v[24:25], v[26:27] op_sel:[0,0] op_sel_hi:[0,1]
    v_pk_mul_f32 v[132:133], v[36:37], v[26:27] op_sel:[0,0] op_sel_hi:[0,1]
    v_pk_mul_f32 v[134:135], v[32:33], v[26:27] op_sel:[0,0] op_sel_hi:[0,1]
    v_pk_mul_f32 v[136:137], v[38:39], v[26:27] op_sel:[0,0] op_sel_hi:[0,1]
    v_pk_mul_f32 v[138:139], v[40:41], v[26:27] op_sel:[0,0] op_sel_hi:[0,1]
    v_pk_mul_f32 v[140:141], v[42:43], v[26:27] op_sel:[0,0] op_sel_hi:[0,1]
    v_pk_fma_f32 v[98:99], v[14:15], v[26:27], v[128:129] op_sel:[1,1,0] op_sel_hi:[1,0,1] neg_lo:[0,1,0]
    v_pk_fma_f32 v[100:101], v[24:25], v[26:27], v[130:131] op_sel:[1,1,0] op_sel_hi:[1,0,1] neg_lo:[0,1,0]
    v_pk_fma_f32 v[102:103], v[36:37], v[26:27], v[132:133] op_sel:[1,1,0] op_sel_hi:[1,0,1] neg_lo:[0,1,0]
    v_pk_fma_f32 v[104:105], v[32:33], v[26:27], v[134:135] op_sel:[1,1,0] op_sel_hi:[1,0,1] neg_lo:[0,1,0]
    v_pk_fma_f32 v[106:107], v[38:39], v[26:27], v[136:137] op_sel:[1,1,0] op_sel_hi:[1,0,1] neg_lo:[0,1,0]
    v_pk_fma_f32 v[108:109], v[40:41], v[26:27], v[138:139] op_sel:[1,1,0] op_sel_hi:[1,0,1] neg_lo:[0,1,0]
    v_pk_fma_f32 v[110:111], v[42:43], v[26:27], v[140:141] op_sel:[1,1,0] op_sel_hi:[1,0,1] neg_lo:[0,1,0]
    v_cvt_pk_bf16_f32 v144, v98, v99
    v_cvt_pk_bf16_f32 v145, v100, v101
    v_cvt_pk_bf16_f32 v146, v102, v103
    v_cvt_pk_bf16_f32 v147, v104, v105
    v_cvt_pk_bf16_f32 v148, v106, v107
    v_cvt_pk_bf16_f32 v149, v108, v109
    v_cvt_pk_bf16_f32 v150, v110, v111
    ds_write_b32 v2, v144 offset:4624
    ds_write_b32 v2, v145 offset:4896
    ds_write_b32 v2, v146 offset:5168
    ds_write_b32 v2, v147 offset:5440
    ds_write_b32 v2, v148 offset:5712
    ds_write_b32 v2, v149 offset:5984
    ds_write_b32 v2, v150 offset:6256
    v_pk_mul_f32 v[128:129], v[14:15], v[34:35] op_sel:[0,0] op_sel_hi:[0,1]
    v_pk_mul_f32 v[130:131], v[24:25], v[34:35] op_sel:[0,0] op_sel_hi:[0,1]
    v_pk_mul_f32 v[132:133], v[36:37], v[34:35] op_sel:[0,0] op_sel_hi:[0,1]
    v_pk_mul_f32 v[134:135], v[32:33], v[34:35] op_sel:[0,0] op_sel_hi:[0,1]
    v_pk_mul_f32 v[136:137], v[38:39], v[34:35] op_sel:[0,0] op_sel_hi:[0,1]
    v_pk_mul_f32 v[138:139], v[40:41], v[34:35] op_sel:[0,0] op_sel_hi:[0,1]
    v_pk_mul_f32 v[140:141], v[42:43], v[34:35] op_sel:[0,0] op_sel_hi:[0,1]
    v_pk_fma_f32 v[98:99], v[14:15], v[34:35], v[128:129] op_sel:[1,1,0] op_sel_hi:[1,0,1] neg_lo:[0,1,0]
    v_pk_fma_f32 v[100:101], v[24:25], v[34:35], v[130:131] op_sel:[1,1,0] op_sel_hi:[1,0,1] neg_lo:[0,1,0]
    v_pk_fma_f32 v[102:103], v[36:37], v[34:35], v[132:133] op_sel:[1,1,0] op_sel_hi:[1,0,1] neg_lo:[0,1,0]
    v_pk_fma_f32 v[104:105], v[32:33], v[34:35], v[134:135] op_sel:[1,1,0] op_sel_hi:[1,0,1] neg_lo:[0,1,0]
    v_pk_fma_f32 v[106:107], v[38:39], v[34:35], v[136:137] op_sel:[1,1,0] op_sel_hi:[1,0,1] neg_lo:[0,1,0]
    v_pk_fma_f32 v[108:109], v[40:41], v[34:35], v[138:139] op_sel:[1,1,0] op_sel_hi:[1,0,1] neg_lo:[0,1,0]
    v_pk_fma_f32 v[110:111], v[42:43], v[34:35], v[140:141] op_sel:[1,1,0] op_sel_hi:[1,0,1] neg_lo:[0,1,0]
    v_cvt_pk_bf16_f32 v144, v98, v99
    v_cvt_pk_bf16_f32 v145, v100, v101
    v_cvt_pk_bf16_f32 v146, v102, v103
    v_cvt_pk_bf16_f32 v147, v104, v105
    v_cvt_pk_bf16_f32 v148, v106, v107
    v_cvt_pk_bf16_f32 v149, v108, v109
    v_cvt_pk_bf16_f32 v150, v110, v111
    ds_write_b32 v2, v144 offset:6800
    ds_write_b32 v2, v145 offset:7072
    ds_write_b32 v2, v146 offset:7344
    ds_write_b32 v2, v147 offset:7616
    ds_write_b32 v2, v148 offset:7888
    ds_write_b32 v2, v149 offset:8160
    ds_write_b32 v2, v150 offset:8432
    v_pk_mul_f32 v[128:129], v[50:51], v[28:29] op_sel:[0,0] op_sel_hi:[0,1]
    v_pk_mul_f32 v[130:131], v[56:57], v[18:19] op_sel:[0,0] op_sel_hi:[0,1]
    v_pk_mul_f32 v[132:133], v[60:61], v[18:19] op_sel:[0,0] op_sel_hi:[0,1]
    v_pk_mul_f32 v[134:135], v[60:61], v[28:29] op_sel:[0,0] op_sel_hi:[0,1]
    v_pk_fma_f32 v[58:59], v[50:51], v[28:29], v[128:129] op_sel:[1,1,0] op_sel_hi:[1,0,1] neg_lo:[0,1,0]
    v_pk_fma_f32 v[62:63], v[56:57], v[18:19], v[130:131] op_sel:[1,1,0] op_sel_hi:[1,0,1] neg_lo:[0,1,0]
    v_pk_fma_f32 v[64:65], v[60:61], v[18:19], v[132:133] op_sel:[1,1,0] op_sel_hi:[1,0,1] neg_lo:[0,1,0]
    v_pk_fma_f32 v[66:67], v[60:61], v[28:29], v[134:135] op_sel:[1,1,0] op_sel_hi:[1,0,1] neg_lo:[0,1,0]
    ds_read_b128 v[96:99], v3 offset:0
    ds_read_b128 v[100:103], v3 offset:32
    ds_read_b128 v[104:107], v3 offset:64
    ds_read_b128 v[108:111], v3 offset:96
    ds_read_b128 v[112:115], v3 offset:128
    ds_read_b128 v[116:119], v3 offset:160
    ds_read_b128 v[120:123], v3 offset:192
    ds_read_b128 v[124:127], v3 offset:224
    v_pk_mul_f32 v[128:129], v[66:67], v[18:19] op_sel:[0,0] op_sel_hi:[0,1]
    v_pk_mul_f32 v[130:131], v[44:45], v[30:31] op_sel:[0,0] op_sel_hi:[0,1]
    v_pk_mul_f32 v[132:133], v[48:49], v[30:31] op_sel:[0,0] op_sel_hi:[0,1]
    v_pk_mul_f32 v[134:135], v[46:47], v[18:19] op_sel:[0,0] op_sel_hi:[0,1]
    v_pk_mul_f32 v[136:137], v[50:51], v[18:19] op_sel:[0,0] op_sel_hi:[0,1]
    v_pk_mul_f32 v[138:139], v[52:53], v[18:19] op_sel:[0,0] op_sel_hi:[0,1]
    v_pk_mul_f32 v[140:141], v[58:59], v[18:19] op_sel:[0,0] op_sel_hi:[0,1]
    v_pk_fma_f32 v[68:69], v[66:67], v[18:19], v[128:129] op_sel:[1,1,0] op_sel_hi:[1,0,1] neg_lo:[0,1,0]
    v_pk_fma_f32 v[160:161], v[44:45], v[30:31], v[130:131] op_sel:[1,1,0] op_sel_hi:[1,0,1] neg_lo:[0,1,0]
    v_pk_fma_f32 v[162:163], v[48:49], v[30:31], v[132:133] op_sel:[1,1,0] op_sel_hi:[1,0,1] neg_lo:[0,1,0]
    v_pk_fma_f32 v[164:165], v[46:47], v[18:19], v[134:135] op_sel:[1,1,0] op_sel_hi:[1,0,1] neg_lo:[0,1,0]
    v_pk_fma_f32 v[166:167], v[50:51], v[18:19], v[136:137] op_sel:[1,1,0] op_sel_hi:[1,0,1] neg_lo:[0,1,0]
    v_pk_fma_f32 v[168:169], v[52:53], v[18:19], v[138:139] op_sel:[1,1,0] op_sel_hi:[1,0,1] neg_lo:[0,1,0]
    v_pk_fma_f32 v[170:171], v[58:59], v[18:19], v[140:141] op_sel:[1,1,0] op_sel_hi:[1,0,1] neg_lo:[0,1,0]
    v_cvt_pk_bf16_f32 v144, v10, -v11
    v_cvt_pk_bf16_f32 v145, v44, -v45
    v_cvt_pk_bf16_f32 v146, v46, -v47
    v_cvt_pk_bf16_f32 v147, v48, -v49
    v_cvt_pk_bf16_f32 v148, v50, -v51
    v_cvt_pk_bf16_f32 v149, v52, -v53
    v_cvt_pk_bf16_f32 v150, v54, -v55
    v_cvt_pk_bf16_f32 v151, v56, -v57
    v_cvt_pk_bf16_f32 v152, v58, -v59
    v_cvt_pk_bf16_f32 v153, v60, -v61
    v_cvt_pk_bf16_f32 v154, v62, -v63
    v_cvt_pk_bf16_f32 v155, v64, -v65
    v_cvt_pk_bf16_f32 v156, v66, -v67
    v_cvt_pk_bf16_f32 v157, v68, -v69
    ds_write_b32 v2, v144 offset:0
    ds_write_b32 v2, v145 offset:272
    ds_write_b32 v2, v146 offset:544
    ds_write_b32 v2, v147 offset:816
    ds_write_b32 v2, v148 offset:1088
    ds_write_b32 v2, v149 offset:1632
    ds_write_b32 v2, v150 offset:2176
    ds_write_b32 v2, v151 offset:4624
    ds_write_b32 v2, v152 offset:4896
    ds_write_b32 v2, v153 offset:3264
    ds_write_b32 v2, v154 offset:6528
    ds_write_b32 v2, v155 offset:3808
    ds_write_b32 v2, v156 offset:5440
    ds_write_b32 v2, v157 offset:5984
    v_cvt_pk_bf16_f32 v144, v160, -v161
    v_cvt_pk_bf16_f32 v145, v162, -v163
    v_cvt_pk_bf16_f32 v146, v164, -v165
    v_cvt_pk_bf16_f32 v147, v166, -v167
    v_cvt_pk_bf16_f32 v148, v168, -v169
    v_cvt_pk_bf16_f32 v149, v170, -v171
    ds_write_b32 v2, v144 offset:1360
    ds_write_b32 v2, v145 offset:1904
    ds_write_b32 v2, v146 offset:2448
    ds_write_b32 v2, v147 offset:2720
    ds_write_b32 v2, v148 offset:2992
    ds_write_b32 v2, v149 offset:6800
    v_pk_mul_f32 v[128:129], v[54:55], v[14:15] op_sel:[0,0] op_sel_hi:[0,1]
    v_pk_mul_f32 v[130:131], v[56:57], v[14:15] op_sel:[0,0] op_sel_hi:[0,1]
    v_pk_mul_f32 v[132:133], v[62:63], v[14:15] op_sel:[0,0] op_sel_hi:[0,1]
    v_pk_mul_f32 v[134:135], v[60:61], v[14:15] op_sel:[0,0] op_sel_hi:[0,1]
    v_pk_mul_f32 v[136:137], v[64:65], v[14:15] op_sel:[0,0] op_sel_hi:[0,1]
    v_pk_mul_f32 v[138:139], v[66:67], v[14:15] op_sel:[0,0] op_sel_hi:[0,1]
    v_pk_mul_f32 v[140:141], v[68:69], v[14:15] op_sel:[0,0] op_sel_hi:[0,1]
    v_pk_fma_f32 v[160:161], v[54:55], v[14:15], v[128:129] op_sel:[1,1,0] op_sel_hi:[1,0,1] neg_lo:[0,1,0]
    v_pk_fma_f32 v[162:163], v[56:57], v[14:15], v[130:131] op_sel:[1,1,0] op_sel_hi:[1,0,1] neg_lo:[0,1,0]
    v_pk_fma_f32 v[164:165], v[62:63], v[14:15], v[132:133] op_sel:[1,1,0] op_sel_hi:[1,0,1] neg_lo:[0,1,0]
    v_pk_fma_f32 v[166:167], v[60:61], v[14:15], v[134:135] op_sel:[1,1,0] op_sel_hi:[1,0,1] neg_lo:[0,1,0]
    v_pk_fma_f32 v[168:169], v[64:65], v[14:15], v[136:137] op_sel:[1,1,0] op_sel_hi:[1,0,1] neg_lo:[0,1,0]
    v_pk_fma_f32 v[170:171], v[66:67], v[14:15], v[138:139] op_sel:[1,1,0] op_sel_hi:[1,0,1] neg_lo:[0,1,0]
    v_pk_fma_f32 v[172:173], v[68:69], v[14:15], v[140:141] op_sel:[1,1,0] op_sel_hi:[1,0,1] neg_lo:[0,1,0]
    v_cvt_pk_bf16_f32 v144, v160, -v161
    v_cvt_pk_bf16_f32 v145, v162, -v163
    v_cvt_pk_bf16_f32 v146, v164, -v165
    v_cvt_pk_bf16_f32 v147, v166, -v167
    v_cvt_pk_bf16_f32 v148, v168, -v169
    v_cvt_pk_bf16_f32 v149, v170, -v171
    v_cvt_pk_bf16_f32 v150, v172, -v173
    ds_write_b32 v2, v144 offset:4352
    ds_write_b32 v2, v145 offset:5168
    ds_write_b32 v2, v146 offset:7072
    ds_write_b32 v2, v147 offset:3536
    ds_write_b32 v2, v148 offset:4080
    ds_write_b32 v2, v149 offset:5712
    ds_write_b32 v2, v150 offset:6256
    ds_read_b128 v[128:131], v3 offset:0
    ds_read_b128 v[132:135], v3 offset:32
    ds_read_b128 v[136:139], v3 offset:64
    ds_read_b128 v[140:143], v3 offset:96
    ds_read_b128 v[144:147], v3 offset:128
    ds_read_b128 v[148:151], v3 offset:160
    ds_read_b128 v[152:155], v3 offset:192
    ds_read_b128 v[156:159], v3 offset:224
    s_waitcnt lgkmcnt(7)
    v_mfma_f32_32x32x16_bf16 v[80:95], v[128:131], v[96:99], v[80:95]
    s_waitcnt lgkmcnt(6)
    v_mfma_f32_32x32x16_bf16 v[80:95], v[132:135], v[100:103], v[80:95]
    s_waitcnt lgkmcnt(5)
    v_mfma_f32_32x32x16_bf16 v[80:95], v[136:139], v[104:107], v[80:95]
    s_waitcnt lgkmcnt(4)
    v_mfma_f32_32x32x16_bf16 v[80:95], v[140:143], v[108:111], v[80:95]
    s_waitcnt lgkmcnt(3)
    v_mfma_f32_32x32x16_bf16 v[80:95], v[144:147], v[112:115], v[80:95]
    s_waitcnt lgkmcnt(2)
    v_mfma_f32_32x32x16_bf16 v[80:95], v[148:151], v[116:119], v[80:95]
    s_waitcnt lgkmcnt(1)
    v_mfma_f32_32x32x16_bf16 v[80:95], v[152:155], v[120:123], v[80:95]
    s_waitcnt lgkmcnt(0)
    v_mfma_f32_32x32x16_bf16 v[80:95], v[156:159], v[124:127], v[80:95]
    s_add_u32 s3, s43, 64
    v_and_b32 v3, 31, v1
    v_lshlrev_b32 v3, 4, v3
    v_add_u32 v3, s3, v3
    v_lshrrev_b32 v4, 5, v1
    v_lshl_add_u32 v4, v4, 3, v3
    v_and_b32 v5, 1, v1
    v_cmp_eq_u32 s[44:45], 1, v5
    s_nop 3
    v_cvt_pk_bf16_f32 v12, v80, v81
    v_cvt_pk_bf16_f32 v13, v82, v83
    ds_write_b64 v4, v[12:13] offset:0
    s_mov_b32 exec_lo, -1
    s_mov_b32 exec_hi, 0
    v_cvt_pk_bf16_f32 v16, v84, v84
    v_cvt_pk_bf16_f32 v17, v85, v86
    v_cvt_pk_bf16_f32 v18, v86, v86
    v_cvt_pk_bf16_f32 v19, v87, v88
    ds_write_b128 v3, v[16:19] offset:512
    v_cvt_pk_bf16_f32 v20, v89, v89
    v_cvt_pk_bf16_f32 v21, v89, v90
    v_cvt_pk_bf16_f32 v22, v90, v90
    v_cvt_pk_bf16_f32 v23, v91, v91
    ds_write_b128 v3, v[20:23] offset:1024
    v_cvt_pk_bf16_f32 v24, v92, v92
    v_cvt_pk_bf16_f32 v25, v92, v93
    v_cvt_pk_bf16_f32 v26, v93, v93
    v_cvt_pk_bf16_f32 v27, v94, v94
    ds_write_b128 v3, v[24:27] offset:1536
    s_mov_b32 exec_lo, 0
    s_mov_b32 exec_hi, -1
    v_cndmask_b32 v8, v84, v85, s[44:45]
    v_cvt_pk_bf16_f32 v28, v84, v84
    v_cvt_pk_bf16_f32 v29, v84, v84
    v_cvt_pk_bf16_f32 v30, v8, v85
    v_cvt_pk_bf16_f32 v31, v85, v85
    ds_write_b128 v3, v[28:31] offset:2048
    v_cndmask_b32 v8, v86, v87, s[44:45]
    v_cvt_pk_bf16_f32 v32, v86, v86
    v_cvt_pk_bf16_f32 v33, v86, v86
    v_cvt_pk_bf16_f32 v34, v8, v87
    v_cvt_pk_bf16_f32 v35, v87, v87
    ds_write_b128 v3, v[32:35] offset:2560
    v_cndmask_b32 v8, v88, v89, s[44:45]
    v_cvt_pk_bf16_f32 v36, v88, v88
    v_cvt_pk_bf16_f32 v37, v88, v88
    v_cvt_pk_bf16_f32 v38, v8, v89
    v_cvt_pk_bf16_f32 v39, v89, v89
    ds_write_b128 v3, v[36:39] offset:3072
    v_cndmask_b32 v8, v90, v91, s[44:45]
    v_cvt_pk_bf16_f32 v40, v90, v90
    v_cvt_pk_bf16_f32 v41, v90, v90
    v_cvt_pk_bf16_f32 v42, v8, v91
    v_cvt_pk_bf16_f32 v43, v91, v91
    ds_write_b128 v3, v[40:43] offset:3584
    s_mov_b64 exec, -1
    s_add_u32 s40, s40, 1
    s_cmp_eq_u32 s40, s41
    s_cbranch_scc1 cv_kd
    v_mov_b32 v176, v192
    v_mov_b32 v177, v193
    v_mov_b32 v178, v194
    v_mov_b32 v179, v195
    v_mov_b32 v180, v196
    v_mov_b32 v181, v197
    v_mov_b32 v182, v198
    v_mov_b32 v183, v199
    v_mov_b32 v184, v200
    v_mov_b32 v185, v201
    v_mov_b32 v186, v202
    s_add_u32 s43, s43, 21760
    s_branch cv_k
cv_kd:
    v_mov_b32 v191, 1
    s_mov_b64 exec, 1
    ds_add_u32 v190, v191 offset:4
    s_mov_b64 exec, -1
    s_mov_b32 s28, s42
    s_mul_i32 s29, s10, 4352
    s_add_u32 s29, s29, 36864
    s_mov_b32 s30, 0
    s_mov_b32 s31, s10
    s_mov_b32 s23, 0
    s_add_u32 s12, s98, 2359296
    s_addc_u32 s13, s99, 0
    s_mov_b32 s14, 2359296
    s_mov_b32 s15, 0x20000
    s_add_u32 s48, s98, 9437184
    s_addc_u32 s49, s99, 0
    s_mov_b32 s50, 2359296
    s_mov_b32 s51, 0x20000
    v_mov_b32 v2, 136960
    s_mov_b32 s24, 0
cv_w:
    ds_read_b32 v3, v2
    s_add_u32 s24, s24, 1
    s_waitcnt lgkmcnt(0)
    v_readfirstlane_b32 s25, v3
    s_cmp_ge_u32 s24, 0x400000
    s_cbranch_scc1 cv_w_d
    s_cmp_ge_u32 s25, 1
    s_cbranch_scc1 cv_w_d
    s_sleep 2
    s_branch cv_w
cv_w_d:
cv_ch:
    s_mov_b32 s34, 0
    s_mov_b32 s35, 0x80000000
    v_lshrrev_b32 v13, 4, v1
    v_and_b32 v14, 3, v1
    v_bfe_u32 v15, v1, 2, 2
    v_and_b32 v16, 1, v13
    v_lshrrev_b32 v17, 1, v13
    v_lshlrev_b32 v18, 5, v16
    v_lshl_add_u32 v18, v14, 3, v18
    v_lshl_add_u32 v18, v17, 6, v18
    v_lshl_add_u32 v18, v15, 3, v18
    v_add_u32 v18, 8, v18
    v_add_u32 v12, s29, v18
    v_lshl_add_u32 v18, v16, 2, v14
    v_sub_u32 v18, v18, v17
    v_lshlrev_b32 v18, 3, v18
    v_sub_u32 v18, v18, v15
    v_add_u32 v20, 71, v18
    v_bfe_u32 v21, v20, 3, 3
    v_xor_b32 v21, s31, v21
    v_lshlrev_b32 v21, 4, v21
    v_and_b32 v19, 1, v20
    v_lshl_add_u32 v21, v19, 3, v21
    v_lshrrev_b32 v20, 1, v20
    v_lshl_add_u32 v21, v20, 7, v21
    v_add_u32 v4, s30, v21
    v_add_u32 v20, 67, v18
    v_bfe_u32 v21, v20, 3, 3
    v_xor_b32 v21, s31, v21
    v_lshlrev_b32 v21, 4, v21
    v_and_b32 v19, 1, v20
    v_lshl_add_u32 v21, v19, 3, v21
    v_lshrrev_b32 v20, 1, v20
    v_lshl_add_u32 v21, v20, 7, v21
    v_add_u32 v5, s30, v21
    v_add_u32 v20, 55, v18
    v_bfe_u32 v21, v20, 3, 3
    v_xor_b32 v21, s31, v21
    v_lshlrev_b32 v21, 4, v21
    v_and_b32 v19, 1, v20
    v_lshl_add_u32 v21, v19, 3, v21
    v_lshrrev_b32 v20, 1, v20
    v_lshl_add_u32 v21, v20, 7, v21
    v_add_u32 v6, s30, v21
    v_add_u32 v20, 51, v18
    v_bfe_u32 v21, v20, 3, 3
    v_xor_b32 v21, s31, v21
    v_lshlrev_b32 v21, 4, v21
    v_and_b32 v19, 1, v20
    v_lshl_add_u32 v21, v19, 3, v21
    v_lshrrev_b32 v20, 1, v20
    v_lshl_add_u32 v21, v20, 7, v21
    v_add_u32 v7, s30, v21
    v_add_u32 v20, 39, v18
    v_bfe_u32 v21, v20, 3, 3
    v_xor_b32 v21, s31, v21
    v_lshlrev_b32 v21, 4, v21
    v_and_b32 v19, 1, v20
    v_lshl_add_u32 v21, v19, 3, v21
    v_lshrrev_b32 v20, 1, v20
    v_lshl_add_u32 v21, v20, 7, v21
    v_add_u32 v8, s30, v21
    v_add_u32 v20, 35, v18
    v_bfe_u32 v21, v20, 3, 3
    v_xor_b32 v21, s31, v21
    v_lshlrev_b32 v21, 4, v21
    v_and_b32 v19, 1, v20
    v_lshl_add_u32 v21, v19, 3, v21
    v_lshrrev_b32 v20, 1, v20
    v_lshl_add_u32 v21, v20, 7, v21
    v_add_u32 v9, s30, v21
    v_add_u32 v20, 23, v18
    v_bfe_u32 v21, v20, 3, 3
    v_xor_b32 v21, s31, v21
    v_lshlrev_b32 v21, 4, v21
    v_and_b32 v19, 1, v20
    v_lshl_add_u32 v21, v19, 3, v21
    v_lshrrev_b32 v20, 1, v20
    v_lshl_add_u32 v21, v20, 7, v21
    v_add_u32 v10, s30, v21
    v_add_u32 v20, 19, v18
    v_bfe_u32 v21, v20, 3, 3
    v_xor_b32 v21, s31, v21
    v_lshlrev_b32 v21, 4, v21
    v_and_b32 v19, 1, v20
    v_lshl_add_u32 v21, v19, 3, v21
    v_lshrrev_b32 v20, 1, v20
    v_lshl_add_u32 v21, v20, 7, v21
    v_add_u32 v11, s30, v21
    s_waitcnt vmcnt(0) lgkmcnt(0)
    v_mov_b32 v15, v1
    ds_read_b64_tr_b16 v[76:77], v12 offset:3584
    ds_read_b64_tr_b16 v[78:79], v12 offset:3616
    ds_read_b64_tr_b16 v[16:17], v4 offset:0
    ds_read_b64_tr_b16 v[18:19], v5 offset:0
    ds_read_b64_tr_b16 v[72:73], v12 offset:3072
    ds_read_b64_tr_b16 v[74:75], v12 offset:3104
    ds_read_b64_tr_b16 v[20:21], v4 offset:4096
    ds_read_b64_tr_b16 v[22:23], v5 offset:4096
    ds_read_b64_tr_b16 v[68:69], v12 offset:2560
    ds_read_b64_tr_b16 v[70:71], v12 offset:2592
    ds_read_b64_tr_b16 v[24:25], v4 offset:8192
    ds_read_b64_tr_b16 v[26:27], v5 offset:8192
    ds_read_b64_tr_b16 v[64:65], v12 offset:2048
    ds_read_b64_tr_b16 v[66:67], v12 offset:2080
    ds_read_b64_tr_b16 v[28:29], v4 offset:12288
    ds_read_b64_tr_b16 v[30:31], v5 offset:12288
    ds_read_b64_tr_b16 v[60:61], v12 offset:1536
    ds_read_b64_tr_b16 v[62:63], v12 offset:1568
    ds_read_b64_tr_b16 v[32:33], v4 offset:16384
    ds_read_b64_tr_b16 v[34:35], v5 offset:16384
    ds_read_b64_tr_b16 v[56:57], v12 offset:1024
    ds_read_b64_tr_b16 v[58:59], v12 offset:1056
    ds_read_b64_tr_b16 v[36:37], v4 offset:20480
    ds_read_b64_tr_b16 v[38:39], v5 offset:20480
    ds_read_b64_tr_b16 v[52:53], v12 offset:512
    ds_read_b64_tr_b16 v[54:55], v12 offset:544
    ds_read_b64_tr_b16 v[40:41], v4 offset:24576
    ds_read_b64_tr_b16 v[42:43], v5 offset:24576
    ds_read_b64_tr_b16 v[48:49], v12 offset:0
    ds_read_b64_tr_b16 v[50:51], v12 offset:32
    ds_read_b64_tr_b16 v[44:45], v4 offset:28672
    ds_read_b64_tr_b16 v[46:47], v5 offset:28672
    ds_read_b64_tr_b16 v[0:1], v12 offset:4160
    ds_read_b64_tr_b16 v[2:3], v12 offset:4192
    s_waitcnt lgkmcnt(15)
    v_mfma_f32_32x32x16_bf16 v[192:207], v[16:19], v[76:79], 0
    ds_read_b64_tr_b16 v[76:77], v12 offset:3712
    ds_read_b64_tr_b16 v[78:79], v12 offset:3744
    v_mfma_f32_32x32x16_bf16 v[176:191], v[16:19], v[72:75], 0
    v_mfma_f32_32x32x16_bf16 v[192:207], v[20:23], v[72:75], v[192:207]
    ds_read_b64_tr_b16 v[72:73], v12 offset:3200
    ds_read_b64_tr_b16 v[74:75], v12 offset:3232
    v_mfma_f32_32x32x16_bf16 v[160:175], v[16:19], v[68:71], 0
    v_mfma_f32_32x32x16_bf16 v[176:191], v[20:23], v[68:71], v[176:191]
    v_mfma_f32_32x32x16_bf16 v[192:207], v[24:27], v[68:71], v[192:207]
    ds_read_b64_tr_b16 v[68:69], v12 offset:2688
    ds_read_b64_tr_b16 v[70:71], v12 offset:2720
    v_mfma_f32_32x32x16_bf16 v[144:159], v[16:19], v[64:67], 0
    v_mfma_f32_32x32x16_bf16 v[160:175], v[20:23], v[64:67], v[160:175]
    v_mfma_f32_32x32x16_bf16 v[176:191], v[24:27], v[64:67], v[176:191]
    v_mfma_f32_32x32x16_bf16 v[192:207], v[28:31], v[64:67], v[192:207]
    ds_read_b64_tr_b16 v[64:65], v12 offset:2176
    ds_read_b64_tr_b16 v[66:67], v12 offset:2208
    v_mfma_f32_32x32x16_bf16 v[128:143], v[16:19], v[60:63], 0
    v_mfma_f32_32x32x16_bf16 v[144:159], v[20:23], v[60:63], v[144:159]
    v_mfma_f32_32x32x16_bf16 v[160:175], v[24:27], v[60:63], v[160:175]
    v_mfma_f32_32x32x16_bf16 v[176:191], v[28:31], v[60:63], v[176:191]
    s_waitcnt lgkmcnt(15)
    v_mfma_f32_32x32x16_bf16 v[192:207], v[32:35], v[60:63], v[192:207]
    ds_read_b64_tr_b16 v[60:61], v12 offset:1664
    ds_read_b64_tr_b16 v[62:63], v12 offset:1696
    v_mfma_f32_32x32x16_bf16 v[112:127], v[16:19], v[56:59], 0
    v_mfma_f32_32x32x16_bf16 v[128:143], v[20:23], v[56:59], v[128:143]
    v_mfma_f32_32x32x16_bf16 v[144:159], v[24:27], v[56:59], v[144:159]
    v_mfma_f32_32x32x16_bf16 v[160:175], v[28:31], v[56:59], v[160:175]
    v_mfma_f32_32x32x16_bf16 v[176:191], v[32:35], v[56:59], v[176:191]
    v_mfma_f32_32x32x16_bf16 v[192:207], v[36:39], v[56:59], v[192:207]
    ds_read_b64_tr_b16 v[56:57], v12 offset:1152
    ds_read_b64_tr_b16 v[58:59], v12 offset:1184
    v_mfma_f32_32x32x16_bf16 v[96:111], v[16:19], v[52:55], 0
    v_mfma_f32_32x32x16_bf16 v[112:127], v[20:23], v[52:55], v[112:127]
    v_mfma_f32_32x32x16_bf16 v[128:143], v[24:27], v[52:55], v[128:143]
    v_mfma_f32_32x32x16_bf16 v[144:159], v[28:31], v[52:55], v[144:159]
    v_mfma_f32_32x32x16_bf16 v[160:175], v[32:35], v[52:55], v[160:175]
    v_mfma_f32_32x32x16_bf16 v[176:191], v[36:39], v[52:55], v[176:191]
    s_waitcnt lgkmcnt(15)
    v_mfma_f32_32x32x16_bf16 v[192:207], v[40:43], v[52:55], v[192:207]
    ds_read_b64_tr_b16 v[52:53], v12 offset:640
    ds_read_b64_tr_b16 v[54:55], v12 offset:672
    v_mfma_f32_32x32x16_bf16 v[80:95], v[16:19], v[48:51], 0
    s_waitcnt lgkmcnt(14)
    v_mfma_f32_32x32x16_bf16 v[80:95], v[16:19], v[0:3], v[80:95]
    ds_read_b64_tr_b16 v[16:17], v6 offset:0
    ds_read_b64_tr_b16 v[18:19], v7 offset:0
    v_mfma_f32_32x32x16_bf16 v[96:111], v[20:23], v[48:51], v[96:111]
    v_mfma_f32_32x32x16_bf16 v[96:111], v[20:23], v[0:3], v[96:111]
    ds_read_b64_tr_b16 v[20:21], v6 offset:4096
    ds_read_b64_tr_b16 v[22:23], v7 offset:4096
    v_mfma_f32_32x32x16_bf16 v[112:127], v[24:27], v[48:51], v[112:127]
    v_mfma_f32_32x32x16_bf16 v[112:127], v[24:27], v[0:3], v[112:127]
    ds_read_b64_tr_b16 v[24:25], v6 offset:8192
    ds_read_b64_tr_b16 v[26:27], v7 offset:8192
    v_mfma_f32_32x32x16_bf16 v[128:143], v[28:31], v[48:51], v[128:143]
    v_mfma_f32_32x32x16_bf16 v[128:143], v[28:31], v[0:3], v[128:143]
    ds_read_b64_tr_b16 v[28:29], v6 offset:12288
    ds_read_b64_tr_b16 v[30:31], v7 offset:12288
    v_mfma_f32_32x32x16_bf16 v[144:159], v[32:35], v[48:51], v[144:159]
    v_mfma_f32_32x32x16_bf16 v[144:159], v[32:35], v[0:3], v[144:159]
    ds_read_b64_tr_b16 v[32:33], v6 offset:16384
    ds_read_b64_tr_b16 v[34:35], v7 offset:16384
    v_mfma_f32_32x32x16_bf16 v[160:175], v[36:39], v[48:51], v[160:175]
    v_mfma_f32_32x32x16_bf16 v[160:175], v[36:39], v[0:3], v[160:175]
    ds_read_b64_tr_b16 v[36:37], v6 offset:20480
    ds_read_b64_tr_b16 v[38:39], v7 offset:20480
    v_mfma_f32_32x32x16_bf16 v[176:191], v[40:43], v[48:51], v[176:191]
    v_mfma_f32_32x32x16_bf16 v[176:191], v[40:43], v[0:3], v[176:191]
    ds_read_b64_tr_b16 v[40:41], v6 offset:24576
    ds_read_b64_tr_b16 v[42:43], v7 offset:24576
    v_mfma_f32_32x32x16_bf16 v[192:207], v[44:47], v[48:51], v[192:207]
    v_mfma_f32_32x32x16_bf16 v[192:207], v[44:47], v[0:3], v[192:207]
    ds_read_b64_tr_b16 v[44:45], v6 offset:28672
    ds_read_b64_tr_b16 v[46:47], v7 offset:28672
    ds_read_b64_tr_b16 v[48:49], v12 offset:128
    ds_read_b64_tr_b16 v[50:51], v12 offset:160
    s_waitcnt lgkmcnt(15)
    v_mfma_f32_32x32x16_bf16 v[192:207], v[16:19], v[76:79], v[192:207]
    ds_read_b64_tr_b16 v[76:77], v12 offset:3840
    ds_read_b64_tr_b16 v[78:79], v12 offset:3872
    v_mfma_f32_32x32x16_bf16 v[176:191], v[16:19], v[72:75], v[176:191]
    s_waitcnt lgkmcnt(15)
    v_mfma_f32_32x32x16_bf16 v[192:207], v[20:23], v[72:75], v[192:207]
    ds_read_b64_tr_b16 v[72:73], v12 offset:3328
    ds_read_b64_tr_b16 v[74:75], v12 offset:3360
    v_mfma_f32_32x32x16_bf16 v[160:175], v[16:19], v[68:71], v[160:175]
    v_mfma_f32_32x32x16_bf16 v[176:191], v[20:23], v[68:71], v[176:191]
    s_waitcnt lgkmcnt(15)
    v_mfma_f32_32x32x16_bf16 v[192:207], v[24:27], v[68:71], v[192:207]
    ds_read_b64_tr_b16 v[68:69], v12 offset:2816
    ds_read_b64_tr_b16 v[70:71], v12 offset:2848
    v_mfma_f32_32x32x16_bf16 v[144:159], v[16:19], v[64:67], v[144:159]
    v_mfma_f32_32x32x16_bf16 v[160:175], v[20:23], v[64:67], v[160:175]
    v_mfma_f32_32x32x16_bf16 v[176:191], v[24:27], v[64:67], v[176:191]
    s_waitcnt lgkmcnt(15)
    v_mfma_f32_32x32x16_bf16 v[192:207], v[28:31], v[64:67], v[192:207]
    ds_read_b64_tr_b16 v[64:65], v12 offset:2304
    ds_read_b64_tr_b16 v[66:67], v12 offset:2336
    v_mfma_f32_32x32x16_bf16 v[128:143], v[16:19], v[60:63], v[128:143]
    v_mfma_f32_32x32x16_bf16 v[144:159], v[20:23], v[60:63], v[144:159]
    v_mfma_f32_32x32x16_bf16 v[160:175], v[24:27], v[60:63], v[160:175]
    v_mfma_f32_32x32x16_bf16 v[176:191], v[28:31], v[60:63], v[176:191]
    s_waitcnt lgkmcnt(15)
    v_mfma_f32_32x32x16_bf16 v[192:207], v[32:35], v[60:63], v[192:207]
    ds_read_b64_tr_b16 v[60:61], v12 offset:1792
    ds_read_b64_tr_b16 v[62:63], v12 offset:1824
    v_mfma_f32_32x32x16_bf16 v[112:127], v[16:19], v[56:59], v[112:127]
    v_mfma_f32_32x32x16_bf16 v[128:143], v[20:23], v[56:59], v[128:143]
    v_mfma_f32_32x32x16_bf16 v[144:159], v[24:27], v[56:59], v[144:159]
    v_mfma_f32_32x32x16_bf16 v[160:175], v[28:31], v[56:59], v[160:175]
    v_mfma_f32_32x32x16_bf16 v[176:191], v[32:35], v[56:59], v[176:191]
    s_waitcnt lgkmcnt(15)
    v_mfma_f32_32x32x16_bf16 v[192:207], v[36:39], v[56:59], v[192:207]
    ds_read_b64_tr_b16 v[56:57], v12 offset:1280
    ds_read_b64_tr_b16 v[58:59], v12 offset:1312
    v_mfma_f32_32x32x16_bf16 v[96:111], v[16:19], v[52:55], v[96:111]
    v_mfma_f32_32x32x16_bf16 v[112:127], v[20:23], v[52:55], v[112:127]
    v_mfma_f32_32x32x16_bf16 v[128:143], v[24:27], v[52:55], v[128:143]
    v_mfma_f32_32x32x16_bf16 v[144:159], v[28:31], v[52:55], v[144:159]
    v_mfma_f32_32x32x16_bf16 v[160:175], v[32:35], v[52:55], v[160:175]
    v_mfma_f32_32x32x16_bf16 v[176:191], v[36:39], v[52:55], v[176:191]
    s_waitcnt lgkmcnt(15)
    v_mfma_f32_32x32x16_bf16 v[192:207], v[40:43], v[52:55], v[192:207]
    ds_read_b64_tr_b16 v[52:53], v12 offset:768
    ds_read_b64_tr_b16 v[54:55], v12 offset:800
    s_waitcnt lgkmcnt(14)
    v_mfma_f32_32x32x16_bf16 v[80:95], v[16:19], v[48:51], v[80:95]
    ds_read_b64_tr_b16 v[16:17], v8 offset:0
    ds_read_b64_tr_b16 v[18:19], v9 offset:0
    v_mfma_f32_32x32x16_bf16 v[96:111], v[20:23], v[48:51], v[96:111]
    ds_read_b64_tr_b16 v[20:21], v8 offset:4096
    ds_read_b64_tr_b16 v[22:23], v9 offset:4096
    v_mfma_f32_32x32x16_bf16 v[112:127], v[24:27], v[48:51], v[112:127]
    ds_read_b64_tr_b16 v[24:25], v8 offset:8192
    ds_read_b64_tr_b16 v[26:27], v9 offset:8192
    v_mfma_f32_32x32x16_bf16 v[128:143], v[28:31], v[48:51], v[128:143]
    ds_read_b64_tr_b16 v[28:29], v8 offset:12288
    ds_read_b64_tr_b16 v[30:31], v9 offset:12288
    v_mfma_f32_32x32x16_bf16 v[144:159], v[32:35], v[48:51], v[144:159]
    ds_read_b64_tr_b16 v[32:33], v8 offset:16384
    ds_read_b64_tr_b16 v[34:35], v9 offset:16384
    v_mfma_f32_32x32x16_bf16 v[160:175], v[36:39], v[48:51], v[160:175]
    ds_read_b64_tr_b16 v[36:37], v8 offset:20480
    ds_read_b64_tr_b16 v[38:39], v9 offset:20480
    v_mfma_f32_32x32x16_bf16 v[176:191], v[40:43], v[48:51], v[176:191]
    ds_read_b64_tr_b16 v[40:41], v8 offset:24576
    ds_read_b64_tr_b16 v[42:43], v9 offset:24576
    v_mfma_f32_32x32x16_bf16 v[192:207], v[44:47], v[48:51], v[192:207]
    ds_read_b64_tr_b16 v[44:45], v8 offset:28672
    ds_read_b64_tr_b16 v[46:47], v9 offset:28672
    ds_read_b64_tr_b16 v[48:49], v12 offset:256
    ds_read_b64_tr_b16 v[50:51], v12 offset:288
    s_waitcnt lgkmcnt(15)
    v_mfma_f32_32x32x16_bf16 v[192:207], v[16:19], v[76:79], v[192:207]
    ds_read_b64_tr_b16 v[76:77], v12 offset:3968
    ds_read_b64_tr_b16 v[78:79], v12 offset:4000
    v_mfma_f32_32x32x16_bf16 v[176:191], v[16:19], v[72:75], v[176:191]
    s_waitcnt lgkmcnt(15)
    v_mfma_f32_32x32x16_bf16 v[192:207], v[20:23], v[72:75], v[192:207]
    ds_read_b64_tr_b16 v[72:73], v12 offset:3456
    ds_read_b64_tr_b16 v[74:75], v12 offset:3488
    v_mfma_f32_32x32x16_bf16 v[160:175], v[16:19], v[68:71], v[160:175]
    v_mfma_f32_32x32x16_bf16 v[176:191], v[20:23], v[68:71], v[176:191]
    s_waitcnt lgkmcnt(15)
    v_mfma_f32_32x32x16_bf16 v[192:207], v[24:27], v[68:71], v[192:207]
    ds_read_b64_tr_b16 v[68:69], v12 offset:2944
    ds_read_b64_tr_b16 v[70:71], v12 offset:2976
    v_mfma_f32_32x32x16_bf16 v[144:159], v[16:19], v[64:67], v[144:159]
    v_mfma_f32_32x32x16_bf16 v[160:175], v[20:23], v[64:67], v[160:175]
    v_mfma_f32_32x32x16_bf16 v[176:191], v[24:27], v[64:67], v[176:191]
    s_waitcnt lgkmcnt(15)
    v_mfma_f32_32x32x16_bf16 v[192:207], v[28:31], v[64:67], v[192:207]
    ds_read_b64_tr_b16 v[64:65], v12 offset:2432
    ds_read_b64_tr_b16 v[66:67], v12 offset:2464
    v_mfma_f32_32x32x16_bf16 v[128:143], v[16:19], v[60:63], v[128:143]
    v_mfma_f32_32x32x16_bf16 v[144:159], v[20:23], v[60:63], v[144:159]
    v_mfma_f32_32x32x16_bf16 v[160:175], v[24:27], v[60:63], v[160:175]
    v_mfma_f32_32x32x16_bf16 v[176:191], v[28:31], v[60:63], v[176:191]
    s_waitcnt lgkmcnt(15)
    v_mfma_f32_32x32x16_bf16 v[192:207], v[32:35], v[60:63], v[192:207]
    ds_read_b64_tr_b16 v[60:61], v12 offset:1920
    ds_read_b64_tr_b16 v[62:63], v12 offset:1952
    v_mfma_f32_32x32x16_bf16 v[112:127], v[16:19], v[56:59], v[112:127]
    v_mfma_f32_32x32x16_bf16 v[128:143], v[20:23], v[56:59], v[128:143]
    v_mfma_f32_32x32x16_bf16 v[144:159], v[24:27], v[56:59], v[144:159]
    v_mfma_f32_32x32x16_bf16 v[160:175], v[28:31], v[56:59], v[160:175]
    v_mfma_f32_32x32x16_bf16 v[176:191], v[32:35], v[56:59], v[176:191]
    s_waitcnt lgkmcnt(15)
    v_mfma_f32_32x32x16_bf16 v[192:207], v[36:39], v[56:59], v[192:207]
    ds_read_b64_tr_b16 v[56:57], v12 offset:1408
    ds_read_b64_tr_b16 v[58:59], v12 offset:1440
    v_mfma_f32_32x32x16_bf16 v[96:111], v[16:19], v[52:55], v[96:111]
    v_mfma_f32_32x32x16_bf16 v[112:127], v[20:23], v[52:55], v[112:127]
    v_mfma_f32_32x32x16_bf16 v[128:143], v[24:27], v[52:55], v[128:143]
    v_mfma_f32_32x32x16_bf16 v[144:159], v[28:31], v[52:55], v[144:159]
    v_mfma_f32_32x32x16_bf16 v[160:175], v[32:35], v[52:55], v[160:175]
    v_mfma_f32_32x32x16_bf16 v[176:191], v[36:39], v[52:55], v[176:191]
    s_waitcnt lgkmcnt(15)
    v_mfma_f32_32x32x16_bf16 v[192:207], v[40:43], v[52:55], v[192:207]
    ds_read_b64_tr_b16 v[52:53], v12 offset:896
    ds_read_b64_tr_b16 v[54:55], v12 offset:928
    s_waitcnt lgkmcnt(14)
    v_mfma_f32_32x32x16_bf16 v[80:95], v[16:19], v[48:51], v[80:95]
    ds_read_b64_tr_b16 v[16:17], v10 offset:0
    ds_read_b64_tr_b16 v[18:19], v11 offset:0
    v_mfma_f32_32x32x16_bf16 v[96:111], v[20:23], v[48:51], v[96:111]
    ds_read_b64_tr_b16 v[20:21], v10 offset:4096
    ds_read_b64_tr_b16 v[22:23], v11 offset:4096
    v_mfma_f32_32x32x16_bf16 v[112:127], v[24:27], v[48:51], v[112:127]
    ds_read_b64_tr_b16 v[24:25], v10 offset:8192
    ds_read_b64_tr_b16 v[26:27], v11 offset:8192
    v_mfma_f32_32x32x16_bf16 v[128:143], v[28:31], v[48:51], v[128:143]
    ds_read_b64_tr_b16 v[28:29], v10 offset:12288
    ds_read_b64_tr_b16 v[30:31], v11 offset:12288
    v_mfma_f32_32x32x16_bf16 v[144:159], v[32:35], v[48:51], v[144:159]
    ds_read_b64_tr_b16 v[32:33], v10 offset:16384
    ds_read_b64_tr_b16 v[34:35], v11 offset:16384
    v_mfma_f32_32x32x16_bf16 v[160:175], v[36:39], v[48:51], v[160:175]
    ds_read_b64_tr_b16 v[36:37], v10 offset:20480
    ds_read_b64_tr_b16 v[38:39], v11 offset:20480
    v_mfma_f32_32x32x16_bf16 v[176:191], v[40:43], v[48:51], v[176:191]
    ds_read_b64_tr_b16 v[40:41], v10 offset:24576
    ds_read_b64_tr_b16 v[42:43], v11 offset:24576
    v_mfma_f32_32x32x16_bf16 v[192:207], v[44:47], v[48:51], v[192:207]
    ds_read_b64_tr_b16 v[44:45], v10 offset:28672
    ds_read_b64_tr_b16 v[46:47], v11 offset:28672
    ds_read_b64_tr_b16 v[48:49], v12 offset:384
    ds_read_b64_tr_b16 v[50:51], v12 offset:416
    s_waitcnt lgkmcnt(15)
    v_mfma_f32_32x32x16_bf16 v[192:207], v[16:19], v[76:79], v[192:207]
    v_mfma_f32_32x32x16_bf16 v[176:191], v[16:19], v[72:75], v[176:191]
    s_waitcnt lgkmcnt(14)
    v_mfma_f32_32x32x16_bf16 v[192:207], v[20:23], v[72:75], v[192:207]
    v_mfma_f32_32x32x16_bf16 v[160:175], v[16:19], v[68:71], v[160:175]
    v_mfma_f32_32x32x16_bf16 v[176:191], v[20:23], v[68:71], v[176:191]
    s_waitcnt lgkmcnt(12)
    v_mfma_f32_32x32x16_bf16 v[192:207], v[24:27], v[68:71], v[192:207]
    v_mfma_f32_32x32x16_bf16 v[144:159], v[16:19], v[64:67], v[144:159]
    v_mfma_f32_32x32x16_bf16 v[160:175], v[20:23], v[64:67], v[160:175]
    v_mfma_f32_32x32x16_bf16 v[176:191], v[24:27], v[64:67], v[176:191]
    s_waitcnt lgkmcnt(10)
    v_mfma_f32_32x32x16_bf16 v[192:207], v[28:31], v[64:67], v[192:207]
    v_mfma_f32_32x32x16_bf16 v[128:143], v[16:19], v[60:63], v[128:143]
    v_mfma_f32_32x32x16_bf16 v[144:159], v[20:23], v[60:63], v[144:159]
    v_mfma_f32_32x32x16_bf16 v[160:175], v[24:27], v[60:63], v[160:175]
    v_mfma_f32_32x32x16_bf16 v[176:191], v[28:31], v[60:63], v[176:191]
    s_waitcnt lgkmcnt(8)
    v_mfma_f32_32x32x16_bf16 v[192:207], v[32:35], v[60:63], v[192:207]
    v_mfma_f32_32x32x16_bf16 v[112:127], v[16:19], v[56:59], v[112:127]
    v_mfma_f32_32x32x16_bf16 v[128:143], v[20:23], v[56:59], v[128:143]
    v_mfma_f32_32x32x16_bf16 v[144:159], v[24:27], v[56:59], v[144:159]
    v_mfma_f32_32x32x16_bf16 v[160:175], v[28:31], v[56:59], v[160:175]
    v_mfma_f32_32x32x16_bf16 v[176:191], v[32:35], v[56:59], v[176:191]
    s_waitcnt lgkmcnt(6)
    v_mfma_f32_32x32x16_bf16 v[192:207], v[36:39], v[56:59], v[192:207]
    v_mfma_f32_32x32x16_bf16 v[96:111], v[16:19], v[52:55], v[96:111]
    v_mfma_f32_32x32x16_bf16 v[112:127], v[20:23], v[52:55], v[112:127]
    v_mfma_f32_32x32x16_bf16 v[128:143], v[24:27], v[52:55], v[128:143]
    v_mfma_f32_32x32x16_bf16 v[144:159], v[28:31], v[52:55], v[144:159]
    v_mfma_f32_32x32x16_bf16 v[160:175], v[32:35], v[52:55], v[160:175]
    v_mfma_f32_32x32x16_bf16 v[176:191], v[36:39], v[52:55], v[176:191]
    s_waitcnt lgkmcnt(4)
    v_mfma_f32_32x32x16_bf16 v[192:207], v[40:43], v[52:55], v[192:207]
    s_waitcnt lgkmcnt(0)
    v_mfma_f32_32x32x16_bf16 v[80:95], v[16:19], v[48:51], v[80:95]
    v_mfma_f32_32x32x16_bf16 v[96:111], v[20:23], v[48:51], v[96:111]
    v_mfma_f32_32x32x16_bf16 v[112:127], v[24:27], v[48:51], v[112:127]
    v_mfma_f32_32x32x16_bf16 v[128:143], v[28:31], v[48:51], v[128:143]
    v_mfma_f32_32x32x16_bf16 v[144:159], v[32:35], v[48:51], v[144:159]
    v_mfma_f32_32x32x16_bf16 v[160:175], v[36:39], v[48:51], v[160:175]
    v_mfma_f32_32x32x16_bf16 v[176:191], v[40:43], v[48:51], v[176:191]
    v_mfma_f32_32x32x16_bf16 v[192:207], v[44:47], v[48:51], v[192:207]
    v_mov_b32 v16, 0
    v_mov_b32 v1, v15
    s_nop 9
    v_cndmask_b32 v207, v207, v203, s[34:35]
    v_cndmask_b32 v203, v203, v199, s[34:35]
    v_cndmask_b32 v199, v199, v195, s[34:35]
    v_cndmask_b32 v195, v195, v191, s[34:35]
    v_cndmask_b32 v191, v191, v187, s[34:35]
    v_cndmask_b32 v187, v187, v183, s[34:35]
    v_cndmask_b32 v183, v183, v179, s[34:35]
    v_cndmask_b32 v179, v179, v175, s[34:35]
    v_cndmask_b32 v175, v175, v171, s[34:35]
    v_cndmask_b32 v171, v171, v167, s[34:35]
    v_cndmask_b32 v167, v167, v163, s[34:35]
    v_cndmask_b32 v163, v163, v159, s[34:35]
    v_cndmask_b32 v159, v159, v155, s[34:35]
    v_cndmask_b32 v155, v155, v151, s[34:35]
    v_cndmask_b32 v151, v151, v147, s[34:35]
    v_cndmask_b32 v147, v147, v143, s[34:35]
    v_cndmask_b32 v143, v143, v139, s[34:35]
    v_cndmask_b32 v139, v139, v135, s[34:35]
    v_cndmask_b32 v135, v135, v131, s[34:35]
    v_cndmask_b32 v131, v131, v127, s[34:35]
    v_cndmask_b32 v127, v127, v123, s[34:35]
    v_cndmask_b32 v123, v123, v119, s[34:35]
    v_cndmask_b32 v119, v119, v115, s[34:35]
    v_cndmask_b32 v115, v115, v111, s[34:35]
    v_cndmask_b32 v111, v111, v107, s[34:35]
    v_cndmask_b32 v107, v107, v103, s[34:35]
    v_cndmask_b32 v103, v103, v99, s[34:35]
    v_cndmask_b32 v99, v99, v95, s[34:35]
    v_cndmask_b32 v95, v95, v91, s[34:35]
    v_cndmask_b32 v91, v91, v87, s[34:35]
    v_cndmask_b32 v87, v87, v83, s[34:35]
    v_cndmask_b32 v83, v83, v16, s[34:35]
    v_add_f32_dpp v206, v207, v206 wave_ror:1 row_mask:0xf bank_mask:0xf
    v_add_f32_dpp v202, v203, v202 wave_ror:1 row_mask:0xf bank_mask:0xf
    v_add_f32_dpp v198, v199, v198 wave_ror:1 row_mask:0xf bank_mask:0xf
    v_add_f32_dpp v194, v195, v194 wave_ror:1 row_mask:0xf bank_mask:0xf
    v_add_f32_dpp v190, v191, v190 wave_ror:1 row_mask:0xf bank_mask:0xf
    v_add_f32_dpp v186, v187, v186 wave_ror:1 row_mask:0xf bank_mask:0xf
    v_add_f32_dpp v182, v183, v182 wave_ror:1 row_mask:0xf bank_mask:0xf
    v_add_f32_dpp v178, v179, v178 wave_ror:1 row_mask:0xf bank_mask:0xf
    v_add_f32_dpp v174, v175, v174 wave_ror:1 row_mask:0xf bank_mask:0xf
    v_add_f32_dpp v170, v171, v170 wave_ror:1 row_mask:0xf bank_mask:0xf
    v_add_f32_dpp v166, v167, v166 wave_ror:1 row_mask:0xf bank_mask:0xf
    v_add_f32_dpp v162, v163, v162 wave_ror:1 row_mask:0xf bank_mask:0xf
    v_add_f32_dpp v158, v159, v158 wave_ror:1 row_mask:0xf bank_mask:0xf
    v_add_f32_dpp v154, v155, v154 wave_ror:1 row_mask:0xf bank_mask:0xf
    v_add_f32_dpp v150, v151, v150 wave_ror:1 row_mask:0xf bank_mask:0xf
    v_add_f32_dpp v146, v147, v146 wave_ror:1 row_mask:0xf bank_mask:0xf
    v_add_f32_dpp v142, v143, v142 wave_ror:1 row_mask:0xf bank_mask:0xf
    v_add_f32_dpp v138, v139, v138 wave_ror:1 row_mask:0xf bank_mask:0xf
    v_add_f32_dpp v134, v135, v134 wave_ror:1 row_mask:0xf bank_mask:0xf
    v_add_f32_dpp v130, v131, v130 wave_ror:1 row_mask:0xf bank_mask:0xf
    v_add_f32_dpp v126, v127, v126 wave_ror:1 row_mask:0xf bank_mask:0xf
    v_add_f32_dpp v122, v123, v122 wave_ror:1 row_mask:0xf bank_mask:0xf
    v_add_f32_dpp v118, v119, v118 wave_ror:1 row_mask:0xf bank_mask:0xf
    v_add_f32_dpp v114, v115, v114 wave_ror:1 row_mask:0xf bank_mask:0xf
    v_add_f32_dpp v110, v111, v110 wave_ror:1 row_mask:0xf bank_mask:0xf
    v_add_f32_dpp v106, v107, v106 wave_ror:1 row_mask:0xf bank_mask:0xf
    v_add_f32_dpp v102, v103, v102 wave_ror:1 row_mask:0xf bank_mask:0xf
    v_add_f32_dpp v98, v99, v98 wave_ror:1 row_mask:0xf bank_mask:0xf
    v_add_f32_dpp v94, v95, v94 wave_ror:1 row_mask:0xf bank_mask:0xf
    v_add_f32_dpp v90, v91, v90 wave_ror:1 row_mask:0xf bank_mask:0xf
    v_add_f32_dpp v86, v87, v86 wave_ror:1 row_mask:0xf bank_mask:0xf
    v_add_f32_dpp v82, v83, v82 wave_ror:1 row_mask:0xf bank_mask:0xf
    v_cndmask_b32 v206, v206, v202, s[34:35]
    v_cndmask_b32 v202, v202, v198, s[34:35]
    v_cndmask_b32 v198, v198, v194, s[34:35]
    v_cndmask_b32 v194, v194, v190, s[34:35]
    v_cndmask_b32 v190, v190, v186, s[34:35]
    v_cndmask_b32 v186, v186, v182, s[34:35]
    v_cndmask_b32 v182, v182, v178, s[34:35]
    v_cndmask_b32 v178, v178, v174, s[34:35]
    v_cndmask_b32 v174, v174, v170, s[34:35]
    v_cndmask_b32 v170, v170, v166, s[34:35]
    v_cndmask_b32 v166, v166, v162, s[34:35]
    v_cndmask_b32 v162, v162, v158, s[34:35]
    v_cndmask_b32 v158, v158, v154, s[34:35]
    v_cndmask_b32 v154, v154, v150, s[34:35]
    v_cndmask_b32 v150, v150, v146, s[34:35]
    v_cndmask_b32 v146, v146, v142, s[34:35]
    v_cndmask_b32 v142, v142, v138, s[34:35]
    v_cndmask_b32 v138, v138, v134, s[34:35]
    v_cndmask_b32 v134, v134, v130, s[34:35]
    v_cndmask_b32 v130, v130, v126, s[34:35]
    v_cndmask_b32 v126, v126, v122, s[34:35]
    v_cndmask_b32 v122, v122, v118, s[34:35]
    v_cndmask_b32 v118, v118, v114, s[34:35]
    v_cndmask_b32 v114, v114, v110, s[34:35]
    v_cndmask_b32 v110, v110, v106, s[34:35]
    v_cndmask_b32 v106, v106, v102, s[34:35]
    v_cndmask_b32 v102, v102, v98, s[34:35]
    v_cndmask_b32 v98, v98, v94, s[34:35]
    v_cndmask_b32 v94, v94, v90, s[34:35]
    v_cndmask_b32 v90, v90, v86, s[34:35]
    v_cndmask_b32 v86, v86, v82, s[34:35]
    v_cndmask_b32 v82, v82, v16, s[34:35]
    v_add_f32_dpp v205, v206, v205 wave_ror:1 row_mask:0xf bank_mask:0xf
    v_add_f32_dpp v201, v202, v201 wave_ror:1 row_mask:0xf bank_mask:0xf
    v_add_f32_dpp v197, v198, v197 wave_ror:1 row_mask:0xf bank_mask:0xf
    v_add_f32_dpp v193, v194, v193 wave_ror:1 row_mask:0xf bank_mask:0xf
    v_add_f32_dpp v189, v190, v189 wave_ror:1 row_mask:0xf bank_mask:0xf
    v_add_f32_dpp v185, v186, v185 wave_ror:1 row_mask:0xf bank_mask:0xf
    v_add_f32_dpp v181, v182, v181 wave_ror:1 row_mask:0xf bank_mask:0xf
    v_add_f32_dpp v177, v178, v177 wave_ror:1 row_mask:0xf bank_mask:0xf
    v_add_f32_dpp v173, v174, v173 wave_ror:1 row_mask:0xf bank_mask:0xf
    v_add_f32_dpp v169, v170, v169 wave_ror:1 row_mask:0xf bank_mask:0xf
    v_add_f32_dpp v165, v166, v165 wave_ror:1 row_mask:0xf bank_mask:0xf
    v_add_f32_dpp v161, v162, v161 wave_ror:1 row_mask:0xf bank_mask:0xf
    v_add_f32_dpp v157, v158, v157 wave_ror:1 row_mask:0xf bank_mask:0xf
    v_add_f32_dpp v153, v154, v153 wave_ror:1 row_mask:0xf bank_mask:0xf
    v_add_f32_dpp v149, v150, v149 wave_ror:1 row_mask:0xf bank_mask:0xf
    v_add_f32_dpp v145, v146, v145 wave_ror:1 row_mask:0xf bank_mask:0xf
    v_add_f32_dpp v141, v142, v141 wave_ror:1 row_mask:0xf bank_mask:0xf
    v_add_f32_dpp v137, v138, v137 wave_ror:1 row_mask:0xf bank_mask:0xf
    v_add_f32_dpp v133, v134, v133 wave_ror:1 row_mask:0xf bank_mask:0xf
    v_add_f32_dpp v129, v130, v129 wave_ror:1 row_mask:0xf bank_mask:0xf
    v_add_f32_dpp v125, v126, v125 wave_ror:1 row_mask:0xf bank_mask:0xf
    v_add_f32_dpp v121, v122, v121 wave_ror:1 row_mask:0xf bank_mask:0xf
    v_add_f32_dpp v117, v118, v117 wave_ror:1 row_mask:0xf bank_mask:0xf
    v_add_f32_dpp v113, v114, v113 wave_ror:1 row_mask:0xf bank_mask:0xf
    v_add_f32_dpp v109, v110, v109 wave_ror:1 row_mask:0xf bank_mask:0xf
    v_add_f32_dpp v105, v106, v105 wave_ror:1 row_mask:0xf bank_mask:0xf
    v_add_f32_dpp v101, v102, v101 wave_ror:1 row_mask:0xf bank_mask:0xf
    v_add_f32_dpp v97, v98, v97 wave_ror:1 row_mask:0xf bank_mask:0xf
    v_add_f32_dpp v93, v94, v93 wave_ror:1 row_mask:0xf bank_mask:0xf
    v_add_f32_dpp v89, v90, v89 wave_ror:1 row_mask:0xf bank_mask:0xf
    v_add_f32_dpp v85, v86, v85 wave_ror:1 row_mask:0xf bank_mask:0xf
    v_add_f32_dpp v81, v82, v81 wave_ror:1 row_mask:0xf bank_mask:0xf
    v_cndmask_b32 v205, v205, v201, s[34:35]
    v_cndmask_b32 v201, v201, v197, s[34:35]
    v_cndmask_b32 v197, v197, v193, s[34:35]
    v_cndmask_b32 v193, v193, v189, s[34:35]
    v_cndmask_b32 v189, v189, v185, s[34:35]
    v_cndmask_b32 v185, v185, v181, s[34:35]
    v_cndmask_b32 v181, v181, v177, s[34:35]
    v_cndmask_b32 v177, v177, v173, s[34:35]
    v_cndmask_b32 v173, v173, v169, s[34:35]
    v_cndmask_b32 v169, v169, v165, s[34:35]
    v_cndmask_b32 v165, v165, v161, s[34:35]
    v_cndmask_b32 v161, v161, v157, s[34:35]
    v_cndmask_b32 v157, v157, v153, s[34:35]
    v_cndmask_b32 v153, v153, v149, s[34:35]
    v_cndmask_b32 v149, v149, v145, s[34:35]
    v_cndmask_b32 v145, v145, v141, s[34:35]
    v_cndmask_b32 v141, v141, v137, s[34:35]
    v_cndmask_b32 v137, v137, v133, s[34:35]
    v_cndmask_b32 v133, v133, v129, s[34:35]
    v_cndmask_b32 v129, v129, v125, s[34:35]
    v_cndmask_b32 v125, v125, v121, s[34:35]
    v_cndmask_b32 v121, v121, v117, s[34:35]
    v_cndmask_b32 v117, v117, v113, s[34:35]
    v_cndmask_b32 v113, v113, v109, s[34:35]
    v_cndmask_b32 v109, v109, v105, s[34:35]
    v_cndmask_b32 v105, v105, v101, s[34:35]
    v_cndmask_b32 v101, v101, v97, s[34:35]
    v_cndmask_b32 v97, v97, v93, s[34:35]
    v_cndmask_b32 v93, v93, v89, s[34:35]
    v_cndmask_b32 v89, v89, v85, s[34:35]
    v_cndmask_b32 v85, v85, v81, s[34:35]
    v_cndmask_b32 v81, v81, v16, s[34:35]
    v_add_f32_dpp v204, v205, v204 wave_ror:1 row_mask:0xf bank_mask:0xf
    v_add_f32_dpp v200, v201, v200 wave_ror:1 row_mask:0xf bank_mask:0xf
    v_add_f32_dpp v196, v197, v196 wave_ror:1 row_mask:0xf bank_mask:0xf
    v_add_f32_dpp v192, v193, v192 wave_ror:1 row_mask:0xf bank_mask:0xf
    v_add_f32_dpp v188, v189, v188 wave_ror:1 row_mask:0xf bank_mask:0xf
    v_add_f32_dpp v184, v185, v184 wave_ror:1 row_mask:0xf bank_mask:0xf
    v_add_f32_dpp v180, v181, v180 wave_ror:1 row_mask:0xf bank_mask:0xf
    v_add_f32_dpp v176, v177, v176 wave_ror:1 row_mask:0xf bank_mask:0xf
    v_add_f32_dpp v172, v173, v172 wave_ror:1 row_mask:0xf bank_mask:0xf
    v_add_f32_dpp v168, v169, v168 wave_ror:1 row_mask:0xf bank_mask:0xf
    v_add_f32_dpp v164, v165, v164 wave_ror:1 row_mask:0xf bank_mask:0xf
    v_add_f32_dpp v160, v161, v160 wave_ror:1 row_mask:0xf bank_mask:0xf
    v_add_f32_dpp v156, v157, v156 wave_ror:1 row_mask:0xf bank_mask:0xf
    v_add_f32_dpp v152, v153, v152 wave_ror:1 row_mask:0xf bank_mask:0xf
    v_add_f32_dpp v148, v149, v148 wave_ror:1 row_mask:0xf bank_mask:0xf
    v_add_f32_dpp v144, v145, v144 wave_ror:1 row_mask:0xf bank_mask:0xf
    v_add_f32_dpp v140, v141, v140 wave_ror:1 row_mask:0xf bank_mask:0xf
    v_add_f32_dpp v136, v137, v136 wave_ror:1 row_mask:0xf bank_mask:0xf
    v_add_f32_dpp v132, v133, v132 wave_ror:1 row_mask:0xf bank_mask:0xf
    v_add_f32_dpp v128, v129, v128 wave_ror:1 row_mask:0xf bank_mask:0xf
    v_add_f32_dpp v124, v125, v124 wave_ror:1 row_mask:0xf bank_mask:0xf
    v_add_f32_dpp v120, v121, v120 wave_ror:1 row_mask:0xf bank_mask:0xf
    v_add_f32_dpp v116, v117, v116 wave_ror:1 row_mask:0xf bank_mask:0xf
    v_add_f32_dpp v112, v113, v112 wave_ror:1 row_mask:0xf bank_mask:0xf
    v_add_f32_dpp v108, v109, v108 wave_ror:1 row_mask:0xf bank_mask:0xf
    v_add_f32_dpp v104, v105, v104 wave_ror:1 row_mask:0xf bank_mask:0xf
    v_add_f32_dpp v100, v101, v100 wave_ror:1 row_mask:0xf bank_mask:0xf
    v_add_f32_dpp v96, v97, v96 wave_ror:1 row_mask:0xf bank_mask:0xf
    v_add_f32_dpp v92, v93, v92 wave_ror:1 row_mask:0xf bank_mask:0xf
    v_add_f32_dpp v88, v89, v88 wave_ror:1 row_mask:0xf bank_mask:0xf
    v_add_f32_dpp v84, v85, v84 wave_ror:1 row_mask:0xf bank_mask:0xf
    v_add_f32_dpp v80, v81, v80 wave_ror:1 row_mask:0xf bank_mask:0xf
    v_lshlrev_b32 v17, 2, v1
    s_lshl_b32 s25, s28, 12
    v_cvt_pk_bf16_f32 v35, v200, v204
    buffer_store_dword v35, v17, s[48:51], s25 offen offset:3840 sc1
    v_cvt_pk_bf16_f32 v34, v192, v196
    buffer_store_dword v34, v17, s[48:51], s25 offen offset:3584 sc1
    v_cvt_pk_bf16_f32 v33, v184, v188
    buffer_store_dword v33, v17, s[48:51], s25 offen offset:3328 sc1
    v_cvt_pk_bf16_f32 v32, v176, v180
    buffer_store_dword v32, v17, s[48:51], s25 offen offset:3072 sc1
    v_cvt_pk_bf16_f32 v31, v168, v172
    buffer_store_dword v31, v17, s[48:51], s25 offen offset:2816 sc1
    v_cvt_pk_bf16_f32 v30, v160, v164
    buffer_store_dword v30, v17, s[48:51], s25 offen offset:2560 sc1
    v_cvt_pk_bf16_f32 v29, v152, v156
    buffer_store_dword v29, v17, s[48:51], s25 offen offset:2304 sc1
    v_cvt_pk_bf16_f32 v28, v144, v148
    buffer_store_dword v28, v17, s[48:51], s25 offen offset:2048 sc1
    v_cvt_pk_bf16_f32 v27, v136, v140
    buffer_store_dword v27, v17, s[48:51], s25 offen offset:1792 sc1
    v_cvt_pk_bf16_f32 v26, v128, v132
    buffer_store_dword v26, v17, s[48:51], s25 offen offset:1536 sc1
    v_cvt_pk_bf16_f32 v25, v120, v124
    buffer_store_dword v25, v17, s[48:51], s25 offen offset:1280 sc1
    v_cvt_pk_bf16_f32 v24, v112, v116
    buffer_store_dword v24, v17, s[48:51], s25 offen offset:1024 sc1
    v_cvt_pk_bf16_f32 v23, v104, v108
    buffer_store_dword v23, v17, s[48:51], s25 offen offset:768 sc1
    v_cvt_pk_bf16_f32 v22, v96, v100
    buffer_store_dword v22, v17, s[48:51], s25 offen offset:512 sc1
    v_cvt_pk_bf16_f32 v21, v88, v92
    buffer_store_dword v21, v17, s[48:51], s25 offen offset:256 sc1
    v_cvt_pk_bf16_f32 v20, v80, v84
    buffer_store_dword v20, v17, s[48:51], s25 offen offset:0 sc1
    s_sub_u32 s41, s41, 1
    s_cmp_eq_u32 s41, 0
    s_cbranch_scc1 cv_done
    s_mov_b32 s28, s47
    s_add_u32 s29, s29, 21760
    s_mov_b32 s31, 7
    s_cmp_eq_u32 s10, 2
    s_cbranch_scc1 cv_ch
    v_mov_b32 v2, 136964
    s_mov_b32 s24, 0
cv_w9:
    ds_read_b32 v3, v2
    s_add_u32 s24, s24, 1
    s_waitcnt lgkmcnt(0)
    v_readfirstlane_b32 s25, v3
    s_cmp_ge_u32 s24, 0x400000
    s_cbranch_scc1 cv_w9_d
    s_cmp_ge_u32 s25, 7
    s_cbranch_scc1 cv_w9_d
    s_sleep 2
    s_branch cv_w9
cv_w9_d:
    s_lshr_b32 s30, s46, 3
    s_add_u32 s30, s30, 64
    s_and_b32 s31, s46, 7
    v_lshlrev_b32 v2, 4, v1
    v_add_u32 v2, 76032, v2
    v_mov_b32 v4, 0
    v_mov_b32 v5, 0
    v_mov_b32 v6, 0
    v_mov_b32 v7, 0
    ds_write_b128 v2, v[4:7] offset:0
    ds_write_b128 v2, v[4:7] offset:1024
    ds_write_b128 v2, v[4:7] offset:2048
    ds_write_b128 v2, v[4:7] offset:3072
    v_lshrrev_b32 v2, 3, v1
    v_lshlrev_b32 v2, 7, v2
    v_and_b32 v3, 7, v1
    v_lshrrev_b32 v14, 5, v1
    v_xor_b32 v3, v3, v14
    s_waitcnt lgkmcnt(0)
    v_xor_b32 v7, 0, v3
    v_lshl_add_u32 v10, v7, 4, v2
    v_xor_b32 v7, 2, v3
    v_lshl_add_u32 v11, v7, 4, v2
    v_xor_b32 v7, 4, v3
    v_lshl_add_u32 v12, v7, 4, v2
    v_xor_b32 v7, 6, v3
    v_lshl_add_u32 v13, v7, 4, v2
    s_lshl_b32 s25, s30, 15
    s_mov_b32 m0, 80128
    s_nop 0
    buffer_load_dwordx4 v10, s[12:15], s25 offen offset:0 sc1 lds
    buffer_load_dwordx4 v11, s[12:15], s25 offen offset:1024 sc1 lds
    buffer_load_dwordx4 v12, s[12:15], s25 offen offset:2048 sc1 lds
    buffer_load_dwordx4 v13, s[12:15], s25 offen offset:3072 sc1 lds
    s_add_u32 s25, s25, 4096
    s_mov_b32 m0, 84224
    s_nop 0
    buffer_load_dwordx4 v10, s[12:15], s25 offen offset:0 sc1 lds
    buffer_load_dwordx4 v11, s[12:15], s25 offen offset:1024 sc1 lds
    buffer_load_dwordx4 v12, s[12:15], s25 offen offset:2048 sc1 lds
    buffer_load_dwordx4 v13, s[12:15], s25 offen offset:3072 sc1 lds
    s_add_u32 s25, s25, 4096
    s_mov_b32 m0, 88320
    s_nop 0
    buffer_load_dwordx4 v10, s[12:15], s25 offen offset:0 sc1 lds
    buffer_load_dwordx4 v11, s[12:15], s25 offen offset:1024 sc1 lds
    buffer_load_dwordx4 v12, s[12:15], s25 offen offset:2048 sc1 lds
    buffer_load_dwordx4 v13, s[12:15], s25 offen offset:3072 sc1 lds
    s_add_u32 s25, s25, 4096
    s_mov_b32 m0, 92416
    s_nop 0
    buffer_load_dwordx4 v10, s[12:15], s25 offen offset:0 sc1 lds
    buffer_load_dwordx4 v11, s[12:15], s25 offen offset:1024 sc1 lds
    buffer_load_dwordx4 v12, s[12:15], s25 offen offset:2048 sc1 lds
    buffer_load_dwordx4 v13, s[12:15], s25 offen offset:3072 sc1 lds
    s_add_u32 s25, s25, 4096
    s_mov_b32 m0, 96512
    s_nop 0
    buffer_load_dwordx4 v10, s[12:15], s25 offen offset:0 sc1 lds
    buffer_load_dwordx4 v11, s[12:15], s25 offen offset:1024 sc1 lds
    buffer_load_dwordx4 v12, s[12:15], s25 offen offset:2048 sc1 lds
    buffer_load_dwordx4 v13, s[12:15], s25 offen offset:3072 sc1 lds
    s_add_u32 s25, s25, 4096
    s_mov_b32 m0, 100608
    s_nop 0
    buffer_load_dwordx4 v10, s[12:15], s25 offen offset:0 sc1 lds
    buffer_load_dwordx4 v11, s[12:15], s25 offen offset:1024 sc1 lds
    buffer_load_dwordx4 v12, s[12:15], s25 offen offset:2048 sc1 lds
    buffer_load_dwordx4 v13, s[12:15], s25 offen offset:3072 sc1 lds
    s_add_u32 s25, s25, 4096
    s_mov_b32 m0, 104704
    s_nop 0
    buffer_load_dwordx4 v10, s[12:15], s25 offen offset:0 sc1 lds
    buffer_load_dwordx4 v11, s[12:15], s25 offen offset:1024 sc1 lds
    buffer_load_dwordx4 v12, s[12:15], s25 offen offset:2048 sc1 lds
    buffer_load_dwordx4 v13, s[12:15], s25 offen offset:3072 sc1 lds
    s_add_u32 s25, s25, 4096
    s_mov_b32 m0, 108800
    s_nop 0
    buffer_load_dwordx4 v10, s[12:15], s25 offen offset:0 sc1 lds
    buffer_load_dwordx4 v11, s[12:15], s25 offen offset:1024 sc1 lds
    buffer_load_dwordx4 v12, s[12:15], s25 offen offset:2048 sc1 lds
    buffer_load_dwordx4 v13, s[12:15], s25 offen offset:3072 sc1 lds
    s_add_u32 s25, s25, 4096
    s_waitcnt vmcnt(0) lgkmcnt(0)
    s_mov_b32 s30, 76032
    s_branch cv_ch
cv_agent:
    s_sub_u32 s11, s11, 24
    s_waitcnt lgkmcnt(0)
    s_mov_b32 s12, s86
    s_mov_b32 s13, s87
    s_mov_b32 s14, 18874368
    s_mov_b32 s15, 0x20000
    s_mov_b32 s16, s90
    s_mov_b32 s17, s91
    s_mov_b32 s18, 18874368
    s_mov_b32 s19, 0x20000
    s_add_u32 s4, s98, 31850496
    s_addc_u32 s5, s99, 0
    s_mov_b32 s6, 83968
    s_mov_b32 s7, 0x20000
    s_cmp_lg_u32 s2, 255
    s_cbranch_scc1 ag_nz
    v_lshlrev_b32 v8, 4, v1
    v_add_u32 v8, 73728, v8
    v_mov_b32 v4, 0
    v_mov_b32 v5, 0
    v_mov_b32 v6, 0
    v_mov_b32 v7, 0
    buffer_store_dwordx4 v[4:7], v8, s[4:7], 0 offen offset:0 sc1
    buffer_store_dwordx4 v[4:7], v8, s[4:7], 0 offen offset:1024 sc1
    buffer_store_dwordx4 v[4:7], v8, s[4:7], 0 offen offset:2048 sc1
    buffer_store_dwordx4 v[4:7], v8, s[4:7], 0 offen offset:3072 sc1
    v_add_u32 v8, 4096, v8
    buffer_store_dwordx4 v[4:7], v8, s[4:7], 0 offen offset:0 sc1
    buffer_store_dwordx4 v[4:7], v8, s[4:7], 0 offen offset:1024 sc1
    buffer_store_dwordx4 v[4:7], v8, s[4:7], 0 offen offset:2048 sc1
    buffer_store_dwordx4 v[4:7], v8, s[4:7], 0 offen offset:3072 sc1
    v_add_u32 v8, 4096, v8
    buffer_store_dwordx4 v[4:7], v8, s[4:7], 0 offen offset:0 sc1
    buffer_store_dwordx4 v[4:7], v8, s[4:7], 0 offen offset:1024 sc1
    s_mov_b32 s40, s96
    s_mov_b32 s41, s97
    s_mov_b32 s42, 256
    s_mov_b32 s43, 0x20000
    v_mov_b32 v9, 1
    s_waitcnt vmcnt(0)
    s_mov_b64 exec, 1
    buffer_store_dword v9, v4, s[40:43], 0 offen sc1
    s_mov_b64 exec, -1
ag_nz:
    s_setprio 3
    v_lshrrev_b32 v4, 3, v1
    v_and_b32 v5, 7, v1
    v_mul_u32_u24 v8, 9216, v4
    v_lshl_add_u32 v8, v5, 7, v8
    v_lshrrev_b32 v9, 4, v1
    v_bfe_u32 v6, v1, 1, 3
    v_lshl_add_u32 v9, v9, 6, v6
    v_mul_u32_u24 v9, 9216, v9
    v_and_b32 v6, 1, v1
    v_lshl_add_u32 v9, v6, 7, v9
    v_add_u32 v9, 1024, v9
    v_lshrrev_b32 v10, 4, v1
    v_lshlrev_b32 v10, 12, v10
    v_and_b32 v11, 15, v1
    v_lshl_add_u32 v10, v11, 7, v10
    s_lshr_b32 s56, s3, 1
    s_mul_i32 s56, s56, 2304
    s_and_b32 s25, s3, 1
    s_lshl_b32 s25, s25, 10
    s_add_u32 s56, s56, s25
    s_mul_i32 s25, s11, 73728
    s_add_u32 s56, s56, s25
    s_lshr_b32 s58, s3, 1
    s_mul_i32 s58, s58, 4718592
    s_and_b32 s25, s3, 1
    s_lshl_b32 s25, s25, 11
    s_add_u32 s58, s58, s25
    s_lshl_b32 s25, s11, 14
    s_add_u32 s58, s58, s25
    v_lshlrev_b32 v12, 7, v1
    v_mul_u32_u24 v13, 18432, v4
    v_lshl_add_u32 v13, v5, 7, v13
    v_add_u32 v13, 8192, v13
    s_lshr_b32 s57, s11, 1
    s_mul_i32 s57, s57, 589824
    s_and_b32 s25, s11, 1
    s_mul_i32 s25, s25, 9216
    s_add_u32 s57, s57, s25
    s_mov_b32 s36, s98
    s_mov_b32 s37, s99
    s_mov_b32 s38, 2359296
    s_mov_b32 s39, 0x20000
    s_and_b32 s59, s2, 7
    s_mul_i32 s59, s59, 2
    s_add_u32 s56, s56, 0
    s_add_u32 s57, s57, 36864
    buffer_load_dword v20, v9, s[12:15], s56 offen
    s_waitcnt vmcnt(2)
    buffer_load_dword v20, v8, s[12:15], s56 offen
    s_add_u32 s56, s56, 589824
    s_waitcnt vmcnt(2)
    buffer_load_dword v20, v8, s[12:15], s56 offen
    s_add_u32 s56, s56, 589824
    s_waitcnt vmcnt(2)
    buffer_load_dword v20, v8, s[12:15], s56 offen
    s_add_u32 s56, s56, 589824
    s_waitcnt vmcnt(2)
    buffer_load_dword v20, v8, s[12:15], s56 offen
    s_add_u32 s56, s56, 589824
    s_waitcnt vmcnt(2)
    buffer_load_dword v20, v9, s[12:15], s56 offen
    s_waitcnt vmcnt(2)
    buffer_load_dword v20, v8, s[12:15], s56 offen
    s_add_u32 s56, s56, 589824
    s_waitcnt vmcnt(2)
    buffer_load_dword v20, v8, s[12:15], s56 offen
    s_add_u32 s56, s56, 589824
    s_waitcnt vmcnt(2)
    buffer_load_dword v20, v8, s[12:15], s56 offen
    s_add_u32 s56, s56, 589824
    s_waitcnt vmcnt(2)
    buffer_load_dword v20, v8, s[12:15], s56 offen
    s_add_u32 s56, s56, 589824
    s_waitcnt vmcnt(2)
    buffer_load_dword v20, v9, s[12:15], s56 offen
    s_waitcnt vmcnt(2)
    buffer_load_dword v20, v8, s[12:15], s56 offen
    s_add_u32 s56, s56, 589824
    s_waitcnt vmcnt(2)
    buffer_load_dword v20, v8, s[12:15], s56 offen
    s_add_u32 s56, s56, 589824
    s_waitcnt vmcnt(2)
    buffer_load_dword v20, v8, s[12:15], s56 offen
    s_add_u32 s56, s56, 589824
    s_waitcnt vmcnt(2)
    buffer_load_dword v20, v8, s[12:15], s56 offen
    s_add_u32 s56, s56, 589824
    s_waitcnt vmcnt(2)
    buffer_load_dword v20, v9, s[12:15], s56 offen
    s_waitcnt vmcnt(2)
    buffer_load_dword v20, v8, s[12:15], s56 offen
    s_add_u32 s56, s56, 589824
    s_waitcnt vmcnt(2)
    buffer_load_dword v20, v8, s[12:15], s56 offen
    s_add_u32 s56, s56, 589824
    s_waitcnt vmcnt(2)
    s_mov_b32 s40, s96
    s_mov_b32 s41, s97
    s_mov_b32 s42, 256
    s_mov_b32 s43, 0x20000
    v_and_b32 v70, 0, v1
    v_lshlrev_b32 v70, 7, v70
    v_add_u32 v70, 0, v70
    s_mov_b32 s24, 0
aggo_p:
    buffer_load_dword v71, v70, s[40:43], 0 offen sc1
    s_add_u32 s24, s24, 1
    s_waitcnt vmcnt(0)
    v_cmp_gt_u32 vcc, 1, v71
    s_cmp_ge_u32 s24, 0x40000
    s_cbranch_scc1 aggo_g
    s_cmp_eq_u64 vcc, 0
    s_cbranch_scc1 aggo_g
    s_sleep 8
    s_branch aggo_p
aggo_g:
    s_and_b32 s24, s2, 15
    s_lshl_b32 s24, s24, 7
    s_add_u32 s62, s24, 75776
    v_mov_b32 v70, s62
    s_mov_b64 exec, 1
    s_mov_b32 s24, 0
agln_p:
    buffer_load_dword v71, v70, s[4:7], 0 offen sc1
    s_add_u32 s24, s24, 1
    s_waitcnt vmcnt(0)
    v_readfirstlane_b32 s25, v71
    s_cmp_ge_u32 s24, 0x40000
    s_cbranch_scc1 agln_g
    s_cmp_ge_u32 s25, 8
    s_cbranch_scc1 agln_g
    s_sleep 2
    s_branch agln_p
agln_g:
    s_mov_b64 exec, -1
    s_and_b32 s24, s2, 15
    s_lshl_b32 s24, s24, 7
    s_add_u32 s62, s24, 77824
    v_mov_b32 v70, s62
    s_mov_b64 exec, 1
    s_mov_b32 s24, 0
aglo_p:
    buffer_load_dword v71, v70, s[4:7], 0 offen sc1
    s_add_u32 s24, s24, 1
    s_waitcnt vmcnt(0)
    v_readfirstlane_b32 s25, v71
    s_cmp_ge_u32 s24, 0x40000
    s_cbranch_scc1 aglo_g
    s_cmp_ge_u32 s25, 8
    s_cbranch_scc1 aglo_g
    s_sleep 2
    s_branch aglo_p
aglo_g:
    s_mov_b64 exec, -1
    s_add_u32 s40, s98, 2359296
    s_addc_u32 s41, s99, 0
    s_mov_b32 s42, 2359296
    s_mov_b32 s43, 0x20000
    v_lshlrev_b32 v2, 4, v1
    v_add_u32 v2, 0, v2
    v_mov_b32 v4, 0
    v_mov_b32 v5, 0
    v_mov_b32 v6, 0
    v_mov_b32 v7, 0
    ds_write_b128 v2, v[4:7] offset:0
    ds_write_b128 v2, v[4:7] offset:1024
    ds_write_b128 v2, v[4:7] offset:2048
    ds_write_b128 v2, v[4:7] offset:3072
    v_lshrrev_b32 v2, 3, v1
    v_lshlrev_b32 v2, 7, v2
    v_and_b32 v3, 7, v1
    v_lshrrev_b32 v14, 5, v1
    v_xor_b32 v3, v3, v14
    s_waitcnt lgkmcnt(0)
    v_xor_b32 v7, 0, v3
    v_lshl_add_u32 v24, v7, 4, v2
    v_xor_b32 v7, 2, v3
    v_lshl_add_u32 v25, v7, 4, v2
    v_xor_b32 v7, 4, v3
    v_lshl_add_u32 v26, v7, 4, v2
    v_xor_b32 v7, 6, v3
    v_lshl_add_u32 v27, v7, 4, v2
    s_lshl_b32 s25, s22, 15
    s_mov_b32 m0, 4096
    s_nop 0
    buffer_load_dwordx4 v24, s[40:43], s25 offen offset:0 sc1 lds
    buffer_load_dwordx4 v25, s[40:43], s25 offen offset:1024 sc1 lds
    buffer_load_dwordx4 v26, s[40:43], s25 offen offset:2048 sc1 lds
    buffer_load_dwordx4 v27, s[40:43], s25 offen offset:3072 sc1 lds
    s_add_u32 s25, s25, 4096
    s_mov_b32 m0, 8192
    s_nop 0
    buffer_load_dwordx4 v24, s[40:43], s25 offen offset:0 sc1 lds
    buffer_load_dwordx4 v25, s[40:43], s25 offen offset:1024 sc1 lds
    buffer_load_dwordx4 v26, s[40:43], s25 offen offset:2048 sc1 lds
    buffer_load_dwordx4 v27, s[40:43], s25 offen offset:3072 sc1 lds
    s_add_u32 s25, s25, 4096
    s_mov_b32 m0, 12288
    s_nop 0
    buffer_load_dwordx4 v24, s[40:43], s25 offen offset:0 sc1 lds
    buffer_load_dwordx4 v25, s[40:43], s25 offen offset:1024 sc1 lds
    buffer_load_dwordx4 v26, s[40:43], s25 offen offset:2048 sc1 lds
    buffer_load_dwordx4 v27, s[40:43], s25 offen offset:3072 sc1 lds
    s_add_u32 s25, s25, 4096
    s_mov_b32 m0, 16384
    s_nop 0
    buffer_load_dwordx4 v24, s[40:43], s25 offen offset:0 sc1 lds
    buffer_load_dwordx4 v25, s[40:43], s25 offen offset:1024 sc1 lds
    buffer_load_dwordx4 v26, s[40:43], s25 offen offset:2048 sc1 lds
    buffer_load_dwordx4 v27, s[40:43], s25 offen offset:3072 sc1 lds
    s_add_u32 s25, s25, 4096
    s_mov_b32 m0, 20480
    s_nop 0
    buffer_load_dwordx4 v24, s[40:43], s25 offen offset:0 sc1 lds
    buffer_load_dwordx4 v25, s[40:43], s25 offen offset:1024 sc1 lds
    buffer_load_dwordx4 v26, s[40:43], s25 offen offset:2048 sc1 lds
    buffer_load_dwordx4 v27, s[40:43], s25 offen offset:3072 sc1 lds
    s_add_u32 s25, s25, 4096
    s_mov_b32 m0, 24576
    s_nop 0
    buffer_load_dwordx4 v24, s[40:43], s25 offen offset:0 sc1 lds
    buffer_load_dwordx4 v25, s[40:43], s25 offen offset:1024 sc1 lds
    buffer_load_dwordx4 v26, s[40:43], s25 offen offset:2048 sc1 lds
    buffer_load_dwordx4 v27, s[40:43], s25 offen offset:3072 sc1 lds
    s_add_u32 s25, s25, 4096
    s_mov_b32 m0, 28672
    s_nop 0
    buffer_load_dwordx4 v24, s[40:43], s25 offen offset:0 sc1 lds
    buffer_load_dwordx4 v25, s[40:43], s25 offen offset:1024 sc1 lds
    buffer_load_dwordx4 v26, s[40:43], s25 offen offset:2048 sc1 lds
    buffer_load_dwordx4 v27, s[40:43], s25 offen offset:3072 sc1 lds
    s_add_u32 s25, s25, 4096
    s_mov_b32 m0, 32768
    s_nop 0
    buffer_load_dwordx4 v24, s[40:43], s25 offen offset:0 sc1 lds
    buffer_load_dwordx4 v25, s[40:43], s25 offen offset:1024 sc1 lds
    buffer_load_dwordx4 v26, s[40:43], s25 offen offset:2048 sc1 lds
    buffer_load_dwordx4 v27, s[40:43], s25 offen offset:3072 sc1 lds
    s_add_u32 s25, s25, 4096
    s_waitcnt vmcnt(0) lgkmcnt(0)
    v_mov_b32 v191, 1
    ds_write_b32 v190, v191
    buffer_load_dword v20, v8, s[12:15], s56 offen
    s_add_u32 s56, s56, 589824
    s_waitcnt vmcnt(2)
    buffer_load_dword v20, v8, s[12:15], s56 offen
    s_add_u32 s56, s56, 589824
    s_waitcnt vmcnt(2)
    buffer_load_dword v20, v9, s[12:15], s56 offen
    s_waitcnt vmcnt(2)
    buffer_load_dword v20, v8, s[12:15], s56 offen
    s_add_u32 s56, s56, 589824
    s_waitcnt vmcnt(2)
    buffer_load_dword v20, v8, s[12:15], s56 offen
    s_add_u32 s56, s56, 589824
    s_waitcnt vmcnt(2)
    buffer_load_dword v20, v8, s[12:15], s56 offen
    s_add_u32 s56, s56, 589824
    s_waitcnt vmcnt(2)
    buffer_load_dword v20, v8, s[12:15], s56 offen
    s_add_u32 s56, s56, 589824
    s_waitcnt vmcnt(2)
    buffer_load_dword v20, v9, s[12:15], s56 offen
    s_waitcnt vmcnt(2)
    buffer_load_dword v20, v8, s[12:15], s56 offen
    s_add_u32 s56, s56, 589824
    s_waitcnt vmcnt(2)
    buffer_load_dword v20, v8, s[12:15], s56 offen
    s_add_u32 s56, s56, 589824
    s_waitcnt vmcnt(2)
    buffer_load_dword v20, v8, s[12:15], s56 offen
    s_add_u32 s56, s56, 589824
    s_waitcnt vmcnt(2)
    buffer_load_dword v20, v8, s[12:15], s56 offen
    s_add_u32 s56, s56, 589824
    s_waitcnt vmcnt(2)
    buffer_load_dword v20, v9, s[12:15], s56 offen
    s_waitcnt vmcnt(2)
    buffer_load_dword v20, v8, s[12:15], s56 offen
    s_add_u32 s56, s56, 589824
    s_waitcnt vmcnt(2)
    buffer_load_dword v20, v8, s[12:15], s56 offen
    s_add_u32 s56, s56, 589824
    s_waitcnt vmcnt(2)
    buffer_load_dword v20, v8, s[12:15], s56 offen
    s_add_u32 s56, s56, 589824
    s_waitcnt vmcnt(2)
    buffer_load_dword v20, v8, s[12:15], s56 offen
    s_add_u32 s56, s56, 589824
    s_waitcnt vmcnt(2)
    buffer_load_dword v20, v9, s[12:15], s56 offen
    s_waitcnt vmcnt(2)
    buffer_load_dword v20, v8, s[12:15], s56 offen
    s_add_u32 s56, s56, 589824
    s_waitcnt vmcnt(2)
    buffer_load_dword v20, v8, s[12:15], s56 offen
    s_add_u32 s56, s56, 589824
    s_waitcnt vmcnt(2)
    buffer_load_dword v20, v8, s[12:15], s56 offen
    s_add_u32 s56, s56, 589824
    s_waitcnt vmcnt(2)
    buffer_load_dword v20, v8, s[12:15], s56 offen
    s_add_u32 s56, s56, 589824
    s_waitcnt vmcnt(2)
    s_add_u32 s25, s58, 0
    buffer_load_dword v20, v10, s[16:19], s25 offen
    s_waitcnt vmcnt(2)
    s_add_u32 s25, s58, 229376
    buffer_load_dword v20, v10, s[16:19], s25 offen
    s_waitcnt vmcnt(2)
    s_add_u32 s25, s58, 458752
    buffer_load_dword v20, v10, s[16:19], s25 offen
    s_waitcnt vmcnt(2)
    s_add_u32 s25, s58, 688128
    buffer_load_dword v20, v10, s[16:19], s25 offen
    s_waitcnt vmcnt(2)
    s_add_u32 s25, s58, 917504
    buffer_load_dword v20, v10, s[16:19], s25 offen
    s_waitcnt vmcnt(2)
    s_add_u32 s25, s58, 1146880
    buffer_load_dword v20, v10, s[16:19], s25 offen
    s_waitcnt vmcnt(2)
    s_add_u32 s25, s58, 1376256
    buffer_load_dword v20, v10, s[16:19], s25 offen
    s_waitcnt vmcnt(2)
    s_add_u32 s25, s58, 1605632
    buffer_load_dword v20, v10, s[16:19], s25 offen
    s_waitcnt vmcnt(2)
    s_add_u32 s25, s58, 1835008
    buffer_load_dword v20, v10, s[16:19], s25 offen
    s_waitcnt vmcnt(2)
    s_add_u32 s25, s58, 2064384
    buffer_load_dword v20, v10, s[16:19], s25 offen
    s_waitcnt vmcnt(2)
    s_add_u32 s25, s58, 2293760
    buffer_load_dword v20, v10, s[16:19], s25 offen
    s_waitcnt vmcnt(2)
    s_add_u32 s25, s58, 2523136
    buffer_load_dword v20, v10, s[16:19], s25 offen
    s_waitcnt vmcnt(2)
    s_add_u32 s25, s58, 2752512
    buffer_load_dword v20, v10, s[16:19], s25 offen
    s_waitcnt vmcnt(2)
    s_add_u32 s25, s58, 2981888
    buffer_load_dword v20, v10, s[16:19], s25 offen
    s_waitcnt vmcnt(2)
    s_add_u32 s25, s58, 3211264
    buffer_load_dword v20, v10, s[16:19], s25 offen
    s_waitcnt vmcnt(2)
    s_add_u32 s25, s58, 3440640
    buffer_load_dword v20, v10, s[16:19], s25 offen
    s_waitcnt vmcnt(2)
    s_add_u32 s25, s58, 3670016
    buffer_load_dword v20, v10, s[16:19], s25 offen
    s_waitcnt vmcnt(2)
    s_add_u32 s25, s58, 3899392
    buffer_load_dword v20, v10, s[16:19], s25 offen
    s_waitcnt vmcnt(2)
    s_add_u32 s25, s58, 4128768
    buffer_load_dword v20, v10, s[16:19], s25 offen
    s_waitcnt vmcnt(2)
    s_add_u32 s25, s58, 4358144
    buffer_load_dword v20, v10, s[16:19], s25 offen
    s_waitcnt vmcnt(2)
    s_add_u32 s25, s58, 4587520
    buffer_load_dword v20, v10, s[16:19], s25 offen
    s_waitcnt vmcnt(2)
cv_done:
    s_setprio 0
    s_cmp_ge_u32 s10, 4
    s_cbranch_scc1 g2_load
    s_barrier
    s_branch g2_cons
g2_load:
    s_bfe_u32 s27, s2, 0x20001
    s_and_b32 s28, s2, 1
    s_lshr_b32 s3, s2, 3
    s_lshl_b32 s25, s28, 1
    s_add_u32 s3, s3, s25
    s_and_b32 s29, s3, 3
    s_bfe_u32 s3, s3, 0x30002
    s_lshl_b32 s28, s28, 3
    s_add_u32 s28, s28, s3
    v_lshlrev_b32 v2, 4, v1
    v_lshrrev_b32 v7, 4, v1
    v_and_b32 v8, 15, v1
    s_add_u32 s30, s3, 0
    s_cmp_ge_u32 s30, 6
    s_cselect_b32 s25, 6, 0
    s_sub_u32 s30, s30, s25
    v_add_u32 v9, 0, v7
    v_and_b32 v10, 7, v9
    v_lshlrev_b32 v10, 1, v10
    v_xor_b32 v10, v10, v8
    v_lshlrev_b32 v9, 12, v9
    v_lshl_add_u32 v9, v10, 4, v9
    v_subrev_u32 v3, 0, v9
    v_add_u32 v9, 4, v7
    v_and_b32 v10, 7, v9
    v_lshlrev_b32 v10, 1, v10
    v_xor_b32 v10, v10, v8
    v_lshlrev_b32 v9, 12, v9
    v_lshl_add_u32 v9, v10, 4, v9
    v_subrev_u32 v4, 1024, v9
    v_add_u32 v9, 8, v7
    v_and_b32 v10, 7, v9
    v_lshlrev_b32 v10, 1, v10
    v_xor_b32 v10, v10, v8
    v_lshlrev_b32 v9, 12, v9
    v_lshl_add_u32 v9, v10, 4, v9
    v_subrev_u32 v5, 2048, v9
    v_add_u32 v9, 12, v7
    v_and_b32 v10, 7, v9
    v_lshlrev_b32 v10, 1, v10
    v_xor_b32 v10, v10, v8
    v_lshlrev_b32 v9, 12, v9
    v_lshl_add_u32 v9, v10, 4, v9
    v_subrev_u32 v6, 3072, v9
    s_mul_i32 s20, s29, 1327104
    s_mul_i32 s25, s27, 331776
    s_add_u32 s20, s20, s25
    s_mul_i32 s21, s27, 4718592
    s_lshl_b32 s25, s28, 8
    s_add_u32 s21, s21, s25
    s_add_u32 s12, s98, 11796480
    s_addc_u32 s13, s99, 0
    s_mov_b32 s14, 5308416
    s_mov_b32 s15, 0x20000
    s_mov_b32 s16, s90
    s_mov_b32 s17, s91
    s_mov_b32 s18, 18874368
    s_mov_b32 s19, 0x20000
    s_add_u32 s4, s98, 31850496
    s_addc_u32 s5, s99, 0
    s_mov_b32 s6, 83968
    s_mov_b32 s7, 0x20000
    s_and_b32 s25, s2, 1
    s_lshl_b32 s25, s25, 2
    s_add_u32 s55, s3, s25
    s_cmp_ge_u32 s55, 9
    s_cselect_b32 s25, 9, 0
    s_sub_u32 s55, s55, s25
    s_mul_i32 s25, s55, 36864
    s_add_u32 s20, s20, s25
    s_lshl_b32 s25, s55, 19
    s_add_u32 s21, s21, s25
    s_lshl_b32 s54, s55, 1
    s_sub_u32 s54, 18, s54
    s_mov_b32 s50, -331776
    s_mov_b32 s51, -4718592
    v_min_u32 v74, 8, v1
    v_add_u32 v74, s55, v74
    v_subrev_u32 v75, 9, v74
    v_min_u32 v74, v74, v75
    s_lshl_b32 s22, s27, 2
    s_add_u32 s22, s22, s29
    s_mul_i32 s22, s22, 9
    v_add_u32 v74, s22, v74
    v_lshlrev_b32 v74, 7, v74
    v_add_u32 v73, 53248, v74
    s_waitcnt vmcnt(0)
    s_barrier
    s_add_u32 s31, s30, 1
    s_cmp_ge_u32 s31, 6
    s_cselect_b32 s25, 6, 0
    s_sub_u32 s31, s31, s25
    s_add_u32 s32, s30, 2
    s_cmp_ge_u32 s32, 6
    s_cselect_b32 s25, 6, 0
    s_sub_u32 s32, s32, s25
    s_add_u32 s33, s30, 3
    s_cmp_ge_u32 s33, 6
    s_cselect_b32 s25, 6, 0
    s_sub_u32 s33, s33, s25
    s_add_u32 s34, s30, 4
    s_cmp_ge_u32 s34, 6
    s_cselect_b32 s25, 6, 0
    s_sub_u32 s34, s34, s25
    s_add_u32 s35, s30, 5
    s_cmp_ge_u32 s35, 6
    s_cselect_b32 s25, 6, 0
    s_sub_u32 s35, s35, s25
    s_add_u32 s36, s29, 1
    s_cmp_ge_u32 s36, 4
    s_cselect_b32 s25, 4, 0
    s_sub_u32 s36, s36, s25
    s_add_u32 s37, s29, 2
    s_cmp_ge_u32 s37, 4
    s_cselect_b32 s25, 4, 0
    s_sub_u32 s37, s37, s25
    s_add_u32 s38, s29, 3
    s_cmp_ge_u32 s38, 4
    s_cselect_b32 s25, 4, 0
    s_sub_u32 s38, s38, s25
    s_setprio 3
    s_cmp_eq_u32 s10, 5
    s_cbranch_scc1 g2l_5
    s_cmp_eq_u32 s10, 6
    s_cbranch_scc1 g2l_6
    s_cmp_eq_u32 s10, 7
    s_cbranch_scc1 g2l_7
    s_mul_i32 s41, s30, 3072
    s_add_u32 s40, s41, s20
    s_mul_i32 s43, s31, 3072
    s_add_u32 s42, s43, s20
    s_mov_b32 s44, 0
    s_mov_b32 s45, 0
    s_mul_i32 s46, s29, 65536
    s_add_u32 s46, s46, s21
    s_mul_i32 s47, s29, 4096
    s_add_u32 s47, s47, 73728
    s_mov_b32 s48, 0
    s_mov_b32 s49, 0
    s_mov_b32 m0, s47
    s_add_u32 s47, s47, 16384
    buffer_load_dwordx4 v3, s[16:19], s46 offen offset:0  lds
    buffer_load_dwordx4 v4, s[16:19], s46 offen offset:1024  lds
    buffer_load_dwordx4 v5, s[16:19], s46 offen offset:2048  lds
    buffer_load_dwordx4 v6, s[16:19], s46 offen offset:3072  lds
    s_add_u32 s46, s46, 262144
    s_mov_b32 m0, s47
    s_add_u32 s47, s47, 16384
    buffer_load_dwordx4 v3, s[16:19], s46 offen offset:0  lds
    buffer_load_dwordx4 v4, s[16:19], s46 offen offset:1024  lds
    buffer_load_dwordx4 v5, s[16:19], s46 offen offset:2048  lds
    buffer_load_dwordx4 v6, s[16:19], s46 offen offset:3072  lds
    s_add_u32 s46, s46, 262144
    s_barrier
    s_cmp_lg_u32 s23, 0
    s_cselect_b32 s52, 1, 0
    v_mov_b32 v72, 0
    s_mov_b32 s24, 0
g2h:
    v_cmp_le_u32 vcc, 1, v72
    s_nop 1
    s_and_b32 s25, vcc_lo, 0x1ff
    s_or_b32 s52, s52, s25
    s_bitcmp1_b32 s52, 0
    s_cbranch_scc1 g2h_d
    s_add_u32 s24, s24, 1
    s_cmp_ge_u32 s24, 0x40000
    s_cbranch_scc1 g2h_d
    buffer_load_dword v72, v73, s[4:7], 0 offen sc1
    s_waitcnt vmcnt(0)
    s_branch g2h
g2h_d:
    buffer_load_dword v72, v73, s[4:7], 0 offen sc1
    s_barrier
    s_cmp_eq_u32 s23, 0
    s_cbranch_scc1 g2l4_nk
    s_waitcnt vmcnt(1)
g2l4_nk:
    s_mov_b32 m0, s41
    s_add_u32 s41, s41, 18432
    s_cmp_lg_u32 s23, 0
    s_cbranch_scc1 g2l4_k0_40
    buffer_load_dwordx4 v2, s[12:15], s40 offen offset:0 sc1  lds
    buffer_load_dwordx4 v2, s[12:15], s40 offen offset:1024 sc1  lds
    buffer_load_dwordx4 v2, s[12:15], s40 offen offset:2048 sc1  lds
g2l4_k0_40:
    s_add_u32 s40, s40, 18432
    s_mov_b32 m0, s43
    s_add_u32 s43, s43, 18432
    s_cmp_lg_u32 s23, 0
    s_cbranch_scc1 g2l4_k0_42
    buffer_load_dwordx4 v2, s[12:15], s42 offen offset:0 sc1  lds
g2l4_k0_42:
    s_add_u32 s42, s42, 18432
    s_add_u32 s45, s45, 1
    s_cmp_eq_u32 s45, s54
    s_cselect_b32 s24, s50, 0
    s_cselect_b32 s25, s51, 0
    s_add_u32 s40, s40, s24
    s_add_u32 s42, s42, s24
    s_add_u32 s44, s44, 1
    s_cmp_lg_u32 s44, 4
    s_cbranch_scc1 g2l4_w0
    s_mov_b32 s44, 0
    s_sub_u32 s41, s41, 73728
    s_sub_u32 s43, s43, 73728
g2l4_w0:
    s_add_u32 s49, s49, 1
    s_cmp_eq_u32 s49, s54
    s_cselect_b32 s24, s50, 0
    s_cselect_b32 s25, s51, 0
    s_add_u32 s46, s46, s25
    s_add_u32 s48, s48, 1
    s_cmp_lg_u32 s48, 4
    s_cbranch_scc1 g2l4_w1
    s_mov_b32 s48, 0
    s_sub_u32 s47, s47, 65536
g2l4_w1:
    s_mov_b32 m0, s41
    s_add_u32 s41, s41, 18432
    s_cmp_lg_u32 s23, 0
    s_cbranch_scc1 g2l4_k2_40
    buffer_load_dwordx4 v2, s[12:15], s40 offen offset:0 sc1  lds
    buffer_load_dwordx4 v2, s[12:15], s40 offen offset:1024 sc1  lds
    buffer_load_dwordx4 v2, s[12:15], s40 offen offset:2048 sc1  lds
g2l4_k2_40:
    s_add_u32 s40, s40, 18432
    s_mov_b32 m0, s43
    s_add_u32 s43, s43, 18432
    s_cmp_lg_u32 s23, 0
    s_cbranch_scc1 g2l4_k2_42
    buffer_load_dwordx4 v2, s[12:15], s42 offen offset:0 sc1  lds
g2l4_k2_42:
    s_add_u32 s42, s42, 18432
    s_add_u32 s45, s45, 1
    s_cmp_eq_u32 s45, s54
    s_cselect_b32 s24, s50, 0
    s_cselect_b32 s25, s51, 0
    s_add_u32 s40, s40, s24
    s_add_u32 s42, s42, s24
    s_add_u32 s44, s44, 1
    s_cmp_lg_u32 s44, 4
    s_cbranch_scc1 g2l4_w2
    s_mov_b32 s44, 0
    s_sub_u32 s41, s41, 73728
    s_sub_u32 s43, s43, 73728
g2l4_w2:
    s_add_u32 s49, s49, 1
    s_cmp_eq_u32 s49, s54
    s_cselect_b32 s24, s50, 0
    s_cselect_b32 s25, s51, 0
    s_add_u32 s46, s46, s25
    s_add_u32 s48, s48, 1
    s_cmp_lg_u32 s48, 4
    s_cbranch_scc1 g2l4_w3
    s_mov_b32 s48, 0
    s_sub_u32 s47, s47, 65536
g2l4_w3:
    s_waitcnt vmcnt(4)
    s_barrier
    s_cmp_eq_u32 s52, 0x1ff
    s_cbranch_scc1 g2l4_q0
    buffer_load_dword v72, v73, s[4:7], 0 offen sc1
g2l4_q0:
    s_mov_b32 m0, s47
    s_add_u32 s47, s47, 16384
    buffer_load_dwordx4 v3, s[16:19], s46 offen offset:0  lds
    buffer_load_dwordx4 v4, s[16:19], s46 offen offset:1024  lds
    buffer_load_dwordx4 v5, s[16:19], s46 offen offset:2048  lds
    buffer_load_dwordx4 v6, s[16:19], s46 offen offset:3072  lds
    s_add_u32 s46, s46, 262144
    s_waitcnt vmcnt(4)
    s_cmp_eq_u32 s52, 0x1ff
    s_cbranch_scc1 g2l4_r1_x
    s_mov_b32 s24, 0
g2l4_r1:
    v_cmp_le_u32 vcc, 1, v72
    s_nop 1
    s_and_b32 s25, vcc_lo, 0x1ff
    s_or_b32 s52, s52, s25
    s_bitcmp1_b32 s52, 1
    s_cbranch_scc1 g2l4_r1_d
    s_add_u32 s24, s24, 1
    s_cmp_ge_u32 s24, 0x40000
    s_cbranch_scc1 g2l4_r1_d
    buffer_load_dword v72, v73, s[4:7], 0 offen sc1
    s_waitcnt vmcnt(0)
    s_branch g2l4_r1
g2l4_r1_d:
g2l4_r1_x:
    s_barrier
    s_cmp_eq_u32 s52, 0x1ff
    s_cbranch_scc1 g2l4_q1
    buffer_load_dword v72, v73, s[4:7], 0 offen sc1
g2l4_q1:
    s_mov_b32 m0, s41
    s_add_u32 s41, s41, 18432
    buffer_load_dwordx4 v2, s[12:15], s40 offen offset:0 sc1  lds
    buffer_load_dwordx4 v2, s[12:15], s40 offen offset:1024 sc1  lds
    buffer_load_dwordx4 v2, s[12:15], s40 offen offset:2048 sc1  lds
    s_add_u32 s40, s40, 18432
    s_mov_b32 m0, s43
    s_add_u32 s43, s43, 18432
    buffer_load_dwordx4 v2, s[12:15], s42 offen offset:0 sc1  lds
    s_add_u32 s42, s42, 18432
    s_add_u32 s45, s45, 1
    s_cmp_eq_u32 s45, s54
    s_cselect_b32 s24, s50, 0
    s_cselect_b32 s25, s51, 0
    s_add_u32 s40, s40, s24
    s_add_u32 s42, s42, s24
    s_add_u32 s44, s44, 1
    s_cmp_lg_u32 s44, 4
    s_cbranch_scc1 g2l4_w4
    s_mov_b32 s44, 0
    s_sub_u32 s41, s41, 73728
    s_sub_u32 s43, s43, 73728
g2l4_w4:
    s_add_u32 s49, s49, 1
    s_cmp_eq_u32 s49, s54
    s_cselect_b32 s24, s50, 0
    s_cselect_b32 s25, s51, 0
    s_add_u32 s46, s46, s25
    s_add_u32 s48, s48, 1
    s_cmp_lg_u32 s48, 4
    s_cbranch_scc1 g2l4_w5
    s_mov_b32 s48, 0
    s_sub_u32 s47, s47, 65536
g2l4_w5:
    s_mov_b32 m0, s41
    s_add_u32 s41, s41, 18432
    buffer_load_dwordx4 v2, s[12:15], s40 offen offset:0 sc1  lds
    buffer_load_dwordx4 v2, s[12:15], s40 offen offset:1024 sc1  lds
    buffer_load_dwordx4 v2, s[12:15], s40 offen offset:2048 sc1  lds
    s_add_u32 s40, s40, 18432
    s_mov_b32 m0, s43
    s_add_u32 s43, s43, 18432
    buffer_load_dwordx4 v2, s[12:15], s42 offen offset:0 sc1  lds
    s_add_u32 s42, s42, 18432
    s_add_u32 s45, s45, 1
    s_cmp_eq_u32 s45, s54
    s_cselect_b32 s24, s50, 0
    s_cselect_b32 s25, s51, 0
    s_add_u32 s40, s40, s24
    s_add_u32 s42, s42, s24
    s_add_u32 s44, s44, 1
    s_cmp_lg_u32 s44, 4
    s_cbranch_scc1 g2l4_w6
    s_mov_b32 s44, 0
    s_sub_u32 s41, s41, 73728
    s_sub_u32 s43, s43, 73728
g2l4_w6:
    s_mov_b32 m0, s47
    s_add_u32 s47, s47, 16384
    buffer_load_dwordx4 v3, s[16:19], s46 offen offset:0  lds
    buffer_load_dwordx4 v4, s[16:19], s46 offen offset:1024  lds
    buffer_load_dwordx4 v5, s[16:19], s46 offen offset:2048  lds
    buffer_load_dwordx4 v6, s[16:19], s46 offen offset:3072  lds
    s_add_u32 s46, s46, 262144
    s_add_u32 s49, s49, 1
    s_cmp_eq_u32 s49, s54
    s_cselect_b32 s24, s50, 0
    s_cselect_b32 s25, s51, 0
    s_add_u32 s46, s46, s25
    s_add_u32 s48, s48, 1
    s_cmp_lg_u32 s48, 4
    s_cbranch_scc1 g2l4_w7
    s_mov_b32 s48, 0
    s_sub_u32 s47, s47, 65536
g2l4_w7:
    s_mov_b32 s26, 0
g2l4_loop:
    s_waitcnt vmcnt(8)
    s_cmp_eq_u32 s52, 0x1ff
    s_cbranch_scc1 g2l4_r2_x
    s_add_u32 s53, s26, 4
    s_lshr_b32 s53, s53, 1
    s_min_u32 s53, s53, 8
    s_mov_b32 s24, 0
g2l4_r2:
    v_cmp_le_u32 vcc, 1, v72
    s_nop 1
    s_and_b32 s25, vcc_lo, 0x1ff
    s_or_b32 s52, s52, s25
    s_bitcmp1_b32 s52, s53
    s_cbranch_scc1 g2l4_r2_d
    s_add_u32 s24, s24, 1
    s_cmp_ge_u32 s24, 0x40000
    s_cbranch_scc1 g2l4_r2_d
    buffer_load_dword v72, v73, s[4:7], 0 offen sc1
    s_waitcnt vmcnt(0)
    s_branch g2l4_r2
g2l4_r2_d:
g2l4_r2_x:
    s_cmp_lg_u32 s26, 13
    s_cbranch_scc1 g2l4_c15
    v_cmp_gt_u32 vcc, 16, v75
    s_nop 1
    s_cmp_eq_u64 vcc, 0
    s_cbranch_scc1 g2l4_c15
    v_and_b32 v70, 15, v1
    v_lshlrev_b32 v70, 7, v70
    v_add_u32 v70, 32768, v70
    s_mov_b32 s24, 0
g2y_p:
    buffer_load_dword v71, v70, s[4:7], 0 offen sc1
    s_add_u32 s24, s24, 1
    s_waitcnt vmcnt(0)
    v_cmp_gt_u32 vcc, 16, v71
    s_cmp_ge_u32 s24, 0x40000
    s_cbranch_scc1 g2y_g
    s_cmp_eq_u64 vcc, 0
    s_cbranch_scc1 g2y_g
    s_sleep 8
    s_branch g2y_p
g2y_g:
g2l4_c15:
    s_barrier
    s_cmp_eq_u32 s52, 0x1ff
    s_cbranch_scc1 g2l4_q2
    buffer_load_dword v72, v73, s[4:7], 0 offen sc1
g2l4_q2:
    s_cmp_lg_u32 s26, 12
    s_cbranch_scc1 g2l4_a15
    v_and_b32 v74, 15, v1
    v_lshlrev_b32 v74, 7, v74
    v_add_u32 v74, 32768, v74
    buffer_load_dword v75, v74, s[4:7], 0 offen sc1
g2l4_a15:
    s_mov_b32 m0, s41
    s_add_u32 s41, s41, 18432
    buffer_load_dwordx4 v2, s[12:15], s40 offen offset:0 sc1  lds
    buffer_load_dwordx4 v2, s[12:15], s40 offen offset:1024 sc1  lds
    buffer_load_dwordx4 v2, s[12:15], s40 offen offset:2048 sc1  lds
    s_add_u32 s40, s40, 18432
    s_mov_b32 m0, s43
    s_add_u32 s43, s43, 18432
    buffer_load_dwordx4 v2, s[12:15], s42 offen offset:0 sc1  lds
    s_add_u32 s42, s42, 18432
    s_add_u32 s45, s45, 1
    s_cmp_eq_u32 s45, s54
    s_cselect_b32 s24, s50, 0
    s_cselect_b32 s25, s51, 0
    s_add_u32 s40, s40, s24
    s_add_u32 s42, s42, s24
    s_add_u32 s44, s44, 1
    s_cmp_lg_u32 s44, 4
    s_cbranch_scc1 g2l4_w8
    s_mov_b32 s44, 0
    s_sub_u32 s41, s41, 73728
    s_sub_u32 s43, s43, 73728
g2l4_w8:
    s_mov_b32 m0, s47
    s_add_u32 s47, s47, 16384
    buffer_load_dwordx4 v3, s[16:19], s46 offen offset:0  lds
    buffer_load_dwordx4 v4, s[16:19], s46 offen offset:1024  lds
    buffer_load_dwordx4 v5, s[16:19], s46 offen offset:2048  lds
    buffer_load_dwordx4 v6, s[16:19], s46 offen offset:3072  lds
    s_add_u32 s46, s46, 262144
    s_add_u32 s49, s49, 1
    s_cmp_eq_u32 s49, s54
    s_cselect_b32 s24, s50, 0
    s_cselect_b32 s25, s51, 0
    s_add_u32 s46, s46, s25
    s_add_u32 s48, s48, 1
    s_cmp_lg_u32 s48, 4
    s_cbranch_scc1 g2l4_w9
    s_mov_b32 s48, 0
    s_sub_u32 s47, s47, 65536
g2l4_w9:
    s_add_u32 s26, s26, 1
    s_cmp_lt_u32 s26, 14
    s_cbranch_scc1 g2l4_loop
    s_lshl_b32 s33, s28, 2
    s_add_u32 s33, s33, s29
    s_lshl_b32 s33, s33, 2
    s_add_u32 s12, s98, 17104896
    s_addc_u32 s13, s99, 0
    s_mov_b32 s14, 9437184
    s_mov_b32 s15, 0x20000
    s_add_u32 s52, s98, 9437184
    s_addc_u32 s53, s99, 0
    s_mov_b32 s54, 2359296
    s_mov_b32 s55, 0x20000
    s_mov_b32 s36, s92
    s_mov_b32 s37, s93
    s_mov_b32 s38, 4096
    s_mov_b32 s39, 0x20000
    s_mov_b32 s40, s94
    s_mov_b32 s41, s95
    s_mov_b32 s42, 2359296
    s_mov_b32 s43, 0x20000
    v_lshlrev_b32 v184, 4, v1
    v_lshrrev_b32 v189, 4, v1
    v_and_b32 v190, 15, v1
    s_lshl_b32 s3, s27, 4
    v_add_u32 v190, s3, v190
    s_lshl_b32 s3, s28, 7
    v_add_u32 v186, s3, v190
    v_lshlrev_b32 v187, 1, v186
    v_mul_u32_u24 v185, 1152, v186
    s_mul_i32 s30, s29, 144
    s_lshl_b32 s3, s10, 5
    s_add_u32 s30, s30, s3
    s_mov_b32 s44, 73728
    v_lshlrev_b32 v189, 2, v189
    v_add_u32 v189, s30, v189
    v_lshl_add_u32 v185, v189, 1, v185
    v_lshlrev_b32 v186, 12, v189
    v_lshl_add_u32 v186, v190, 2, v186
    s_lshl_b32 s3, s28, 8
    v_add_u32 v186, s3, v186
    s_add_u32 s23, s33, s27
    s_mul_i32 s31, s23, 36864
    s_lshl_b32 s34, s10, 11
    s_add_u32 s31, s31, s34
    s_lshl_b32 s23, s23, 7
    s_lshl_b32 s34, s10, 12
    v_add_u32 v188, s34, v184
    s_add_u32 s3, s27, 1
    s_and_b32 s3, s3, 3
    s_mul_i32 s3, s3, 9216
    s_add_u32 s45, s3, s31
    s_add_u32 s3, s27, 2
    s_and_b32 s3, s3, 3
    s_mul_i32 s3, s3, 9216
    s_add_u32 s46, s3, s31
    s_add_u32 s3, s27, 3
    s_and_b32 s3, s3, 3
    s_mul_i32 s3, s3, 9216
    s_add_u32 s47, s3, s31
    s_add_u32 s49, s33, s10
    s_lshl_b32 s48, s49, 2
    s_add_u32 s48, s48, s27
    s_mul_i32 s48, s48, 9216
    s_lshl_b32 s49, s49, 7
    s_mov_b32 s16, s84
    s_mov_b32 s17, s85
    s_mov_b32 s18, 2359296
    s_mov_b32 s19, 0x20000
    buffer_load_dwordx2 v[156:157], v185, s[16:19], 0 offen
    buffer_load_dwordx2 v[160:161], v185, s[16:19], s44 offen
    buffer_load_ushort v164, v187, s[36:39], 0 offen
    buffer_load_ushort v165, v187, s[36:39], 0 offen offset:128
    s_mov_b32 s3, 0
    buffer_load_dword v148, v186, s[52:55], s3 offen sc1
    s_add_u32 s3, s3, 4096
    buffer_load_dword v149, v186, s[52:55], s3 offen sc1
    s_add_u32 s3, s3, 4096
    buffer_load_dword v150, v186, s[52:55], s3 offen sc1
    s_add_u32 s3, s3, 4096
    buffer_load_dword v151, v186, s[52:55], s3 offen sc1
    s_add_u32 s3, s3, 4096
    s_waitcnt vmcnt(16)
    s_barrier
    s_waitcnt vmcnt(8)
    s_barrier
    s_branch g2_l0
g2l_5:
    s_mul_i32 s41, s32, 3072
    s_add_u32 s40, s41, s20
    s_mul_i32 s43, s31, 3072
    s_add_u32 s42, s43, s20
    s_mov_b32 s44, 0
    s_mov_b32 s45, 0
    s_mul_i32 s46, s36, 65536
    s_add_u32 s46, s46, s21
    s_mul_i32 s47, s36, 4096
    s_add_u32 s47, s47, 73728
    s_mov_b32 s48, 0
    s_mov_b32 s49, 0
    s_mov_b32 m0, s47
    s_add_u32 s47, s47, 16384
    buffer_load_dwordx4 v3, s[16:19], s46 offen offset:0  lds
    buffer_load_dwordx4 v4, s[16:19], s46 offen offset:1024  lds
    buffer_load_dwordx4 v5, s[16:19], s46 offen offset:2048  lds
    buffer_load_dwordx4 v6, s[16:19], s46 offen offset:3072  lds
    s_add_u32 s46, s46, 262144
    s_mov_b32 m0, s47
    s_add_u32 s47, s47, 16384
    buffer_load_dwordx4 v3, s[16:19], s46 offen offset:0  lds
    buffer_load_dwordx4 v4, s[16:19], s46 offen offset:1024  lds
    buffer_load_dwordx4 v5, s[16:19], s46 offen offset:2048  lds
    buffer_load_dwordx4 v6, s[16:19], s46 offen offset:3072  lds
    s_add_u32 s46, s46, 262144
    s_barrier
    s_barrier
    s_cmp_eq_u32 s23, 0
    s_cbranch_scc1 g2l5_nk
    s_waitcnt vmcnt(0)
g2l5_nk:
    s_mov_b32 m0, s41
    s_add_u32 s41, s41, 18432
    s_cmp_lg_u32 s23, 0
    s_cbranch_scc1 g2l5_k0_40
    buffer_load_dwordx4 v2, s[12:15], s40 offen offset:0 sc1  lds
    buffer_load_dwordx4 v2, s[12:15], s40 offen offset:1024 sc1  lds
    buffer_load_dwordx4 v2, s[12:15], s40 offen offset:2048 sc1  lds
g2l5_k0_40:
    s_add_u32 s40, s40, 18432
    s_mov_b32 m0, s43
    s_add_u32 s43, s43, 18432
    s_cmp_lg_u32 s23, 0
    s_cbranch_scc1 g2l5_k0_42
    buffer_load_dwordx4 v2, s[12:15], s42 offen offset:1024 sc1  lds
    buffer_load_dwordx4 v2, s[12:15], s42 offen offset:2048 sc1  lds
g2l5_k0_42:
    s_add_u32 s42, s42, 18432
    s_add_u32 s45, s45, 1
    s_cmp_eq_u32 s45, s54
    s_cselect_b32 s24, s50, 0
    s_cselect_b32 s25, s51, 0
    s_add_u32 s40, s40, s24
    s_add_u32 s42, s42, s24
    s_add_u32 s44, s44, 1
    s_cmp_lg_u32 s44, 4
    s_cbranch_scc1 g2l5_w0
    s_mov_b32 s44, 0
    s_sub_u32 s41, s41, 73728
    s_sub_u32 s43, s43, 73728
g2l5_w0:
    s_add_u32 s49, s49, 1
    s_cmp_eq_u32 s49, s54
    s_cselect_b32 s24, s50, 0
    s_cselect_b32 s25, s51, 0
    s_add_u32 s46, s46, s25
    s_add_u32 s48, s48, 1
    s_cmp_lg_u32 s48, 4
    s_cbranch_scc1 g2l5_w1
    s_mov_b32 s48, 0
    s_sub_u32 s47, s47, 65536
g2l5_w1:
    s_mov_b32 m0, s41
    s_add_u32 s41, s41, 18432
    s_cmp_lg_u32 s23, 0
    s_cbranch_scc1 g2l5_k2_40
    buffer_load_dwordx4 v2, s[12:15], s40 offen offset:0 sc1  lds
    buffer_load_dwordx4 v2, s[12:15], s40 offen offset:1024 sc1  lds
    buffer_load_dwordx4 v2, s[12:15], s40 offen offset:2048 sc1  lds
g2l5_k2_40:
    s_add_u32 s40, s40, 18432
    s_mov_b32 m0, s43
    s_add_u32 s43, s43, 18432
    s_cmp_lg_u32 s23, 0
    s_cbranch_scc1 g2l5_k2_42
    buffer_load_dwordx4 v2, s[12:15], s42 offen offset:1024 sc1  lds
    buffer_load_dwordx4 v2, s[12:15], s42 offen offset:2048 sc1  lds
g2l5_k2_42:
    s_add_u32 s42, s42, 18432
    s_add_u32 s45, s45, 1
    s_cmp_eq_u32 s45, s54
    s_cselect_b32 s24, s50, 0
    s_cselect_b32 s25, s51, 0
    s_add_u32 s40, s40, s24
    s_add_u32 s42, s42, s24
    s_add_u32 s44, s44, 1
    s_cmp_lg_u32 s44, 4
    s_cbranch_scc1 g2l5_w2
    s_mov_b32 s44, 0
    s_sub_u32 s41, s41, 73728
    s_sub_u32 s43, s43, 73728
g2l5_w2:
    s_add_u32 s49, s49, 1
    s_cmp_eq_u32 s49, s54
    s_cselect_b32 s24, s50, 0
    s_cselect_b32 s25, s51, 0
    s_add_u32 s46, s46, s25
    s_add_u32 s48, s48, 1
    s_cmp_lg_u32 s48, 4
    s_cbranch_scc1 g2l5_w3
    s_mov_b32 s48, 0
    s_sub_u32 s47, s47, 65536
g2l5_w3:
    s_waitcnt vmcnt(5)
    s_barrier
    s_mov_b32 m0, s47
    s_add_u32 s47, s47, 16384
    buffer_load_dwordx4 v3, s[16:19], s46 offen offset:0  lds
    buffer_load_dwordx4 v4, s[16:19], s46 offen offset:1024  lds
    buffer_load_dwordx4 v5, s[16:19], s46 offen offset:2048  lds
    buffer_load_dwordx4 v6, s[16:19], s46 offen offset:3072  lds
    s_add_u32 s46, s46, 262144
    s_waitcnt vmcnt(4)
    s_barrier
    s_mov_b32 m0, s41
    s_add_u32 s41, s41, 18432
    buffer_load_dwordx4 v2, s[12:15], s40 offen offset:0 sc1  lds
    buffer_load_dwordx4 v2, s[12:15], s40 offen offset:1024 sc1  lds
    buffer_load_dwordx4 v2, s[12:15], s40 offen offset:2048 sc1  lds
    s_add_u32 s40, s40, 18432
    s_mov_b32 m0, s43
    s_add_u32 s43, s43, 18432
    buffer_load_dwordx4 v2, s[12:15], s42 offen offset:1024 sc1  lds
    buffer_load_dwordx4 v2, s[12:15], s42 offen offset:2048 sc1  lds
    s_add_u32 s42, s42, 18432
    s_add_u32 s45, s45, 1
    s_cmp_eq_u32 s45, s54
    s_cselect_b32 s24, s50, 0
    s_cselect_b32 s25, s51, 0
    s_add_u32 s40, s40, s24
    s_add_u32 s42, s42, s24
    s_add_u32 s44, s44, 1
    s_cmp_lg_u32 s44, 4
    s_cbranch_scc1 g2l5_w4
    s_mov_b32 s44, 0
    s_sub_u32 s41, s41, 73728
    s_sub_u32 s43, s43, 73728
g2l5_w4:
    s_add_u32 s49, s49, 1
    s_cmp_eq_u32 s49, s54
    s_cselect_b32 s24, s50, 0
    s_cselect_b32 s25, s51, 0
    s_add_u32 s46, s46, s25
    s_add_u32 s48, s48, 1
    s_cmp_lg_u32 s48, 4
    s_cbranch_scc1 g2l5_w5
    s_mov_b32 s48, 0
    s_sub_u32 s47, s47, 65536
g2l5_w5:
    s_mov_b32 m0, s41
    s_add_u32 s41, s41, 18432
    buffer_load_dwordx4 v2, s[12:15], s40 offen offset:0 sc1  lds
    buffer_load_dwordx4 v2, s[12:15], s40 offen offset:1024 sc1  lds
    buffer_load_dwordx4 v2, s[12:15], s40 offen offset:2048 sc1  lds
    s_add_u32 s40, s40, 18432
    s_mov_b32 m0, s43
    s_add_u32 s43, s43, 18432
    buffer_load_dwordx4 v2, s[12:15], s42 offen offset:1024 sc1  lds
    buffer_load_dwordx4 v2, s[12:15], s42 offen offset:2048 sc1  lds
    s_add_u32 s42, s42, 18432
    s_add_u32 s45, s45, 1
    s_cmp_eq_u32 s45, s54
    s_cselect_b32 s24, s50, 0
    s_cselect_b32 s25, s51, 0
    s_add_u32 s40, s40, s24
    s_add_u32 s42, s42, s24
    s_add_u32 s44, s44, 1
    s_cmp_lg_u32 s44, 4
    s_cbranch_scc1 g2l5_w6
    s_mov_b32 s44, 0
    s_sub_u32 s41, s41, 73728
    s_sub_u32 s43, s43, 73728
g2l5_w6:
    s_mov_b32 m0, s47
    s_add_u32 s47, s47, 16384
    buffer_load_dwordx4 v3, s[16:19], s46 offen offset:0  lds
    buffer_load_dwordx4 v4, s[16:19], s46 offen offset:1024  lds
    buffer_load_dwordx4 v5, s[16:19], s46 offen offset:2048  lds
    buffer_load_dwordx4 v6, s[16:19], s46 offen offset:3072  lds
    s_add_u32 s46, s46, 262144
    s_add_u32 s49, s49, 1
    s_cmp_eq_u32 s49, s54
    s_cselect_b32 s24, s50, 0
    s_cselect_b32 s25, s51, 0
    s_add_u32 s46, s46, s25
    s_add_u32 s48, s48, 1
    s_cmp_lg_u32 s48, 4
    s_cbranch_scc1 g2l5_w7
    s_mov_b32 s48, 0
    s_sub_u32 s47, s47, 65536
g2l5_w7:
    s_mov_b32 s26, 0
g2l5_loop:
    s_waitcnt vmcnt(9)
    s_barrier
    s_mov_b32 m0, s41
    s_add_u32 s41, s41, 18432
    buffer_load_dwordx4 v2, s[12:15], s40 offen offset:0 sc1  lds
    buffer_load_dwordx4 v2, s[12:15], s40 offen offset:1024 sc1  lds
    buffer_load_dwordx4 v2, s[12:15], s40 offen offset:2048 sc1  lds
    s_add_u32 s40, s40, 18432
    s_mov_b32 m0, s43
    s_add_u32 s43, s43, 18432
    buffer_load_dwordx4 v2, s[12:15], s42 offen offset:1024 sc1  lds
    buffer_load_dwordx4 v2, s[12:15], s42 offen offset:2048 sc1  lds
    s_add_u32 s42, s42, 18432
    s_add_u32 s45, s45, 1
    s_cmp_eq_u32 s45, s54
    s_cselect_b32 s24, s50, 0
    s_cselect_b32 s25, s51, 0
    s_add_u32 s40, s40, s24
    s_add_u32 s42, s42, s24
    s_add_u32 s44, s44, 1
    s_cmp_lg_u32 s44, 4
    s_cbranch_scc1 g2l5_w8
    s_mov_b32 s44, 0
    s_sub_u32 s41, s41, 73728
    s_sub_u32 s43, s43, 73728
g2l5_w8:
    s_mov_b32 m0, s47
    s_add_u32 s47, s47, 16384
    buffer_load_dwordx4 v3, s[16:19], s46 offen offset:0  lds
    buffer_load_dwordx4 v4, s[16:19], s46 offen offset:1024  lds
    buffer_load_dwordx4 v5, s[16:19], s46 offen offset:2048  lds
    buffer_load_dwordx4 v6, s[16:19], s46 offen offset:3072  lds
    s_add_u32 s46, s46, 262144
    s_add_u32 s49, s49, 1
    s_cmp_eq_u32 s49, s54
    s_cselect_b32 s24, s50, 0
    s_cselect_b32 s25, s51, 0
    s_add_u32 s46, s46, s25
    s_add_u32 s48, s48, 1
    s_cmp_lg_u32 s48, 4
    s_cbranch_scc1 g2l5_w9
    s_mov_b32 s48, 0
    s_sub_u32 s47, s47, 65536
g2l5_w9:
    s_add_u32 s26, s26, 1
    s_cmp_lt_u32 s26, 14
    s_cbranch_scc1 g2l5_loop
    s_mov_b32 s50, 0
    s_lshl_b32 s33, s28, 2
    s_add_u32 s33, s33, s29
    s_lshl_b32 s33, s33, 2
    s_add_u32 s12, s98, 17104896
    s_addc_u32 s13, s99, 0
    s_mov_b32 s14, 9437184
    s_mov_b32 s15, 0x20000
    s_add_u32 s52, s98, 9437184
    s_addc_u32 s53, s99, 0
    s_mov_b32 s54, 2359296
    s_mov_b32 s55, 0x20000
    s_mov_b32 s36, s92
    s_mov_b32 s37, s93
    s_mov_b32 s38, 4096
    s_mov_b32 s39, 0x20000
    s_mov_b32 s40, s94
    s_mov_b32 s41, s95
    s_mov_b32 s42, 2359296
    s_mov_b32 s43, 0x20000
    v_lshlrev_b32 v184, 4, v1
    v_lshrrev_b32 v189, 4, v1
    v_and_b32 v190, 15, v1
    s_lshl_b32 s3, s27, 4
    v_add_u32 v190, s3, v190
    s_lshl_b32 s3, s28, 7
    v_add_u32 v186, s3, v190
    v_lshlrev_b32 v187, 1, v186
    v_mul_u32_u24 v185, 1152, v186
    s_mul_i32 s30, s29, 144
    s_lshl_b32 s3, s50, 5
    s_add_u32 s30, s30, s3
    s_mov_b32 s44, 73728
    v_lshlrev_b32 v189, 3, v189
    v_add_u32 v189, s30, v189
    v_lshl_add_u32 v185, v189, 1, v185
    v_lshlrev_b32 v186, 12, v189
    v_lshl_add_u32 v186, v190, 2, v186
    s_lshl_b32 s3, s28, 8
    v_add_u32 v186, s3, v186
    s_add_u32 s23, s33, s27
    s_mul_i32 s31, s23, 36864
    s_lshl_b32 s34, s10, 11
    s_add_u32 s31, s31, s34
    s_lshl_b32 s23, s23, 7
    s_lshl_b32 s34, s50, 12
    v_add_u32 v188, s34, v184
    s_add_u32 s3, s27, 1
    s_and_b32 s3, s3, 3
    s_mul_i32 s3, s3, 9216
    s_add_u32 s45, s3, s31
    s_add_u32 s3, s27, 2
    s_and_b32 s3, s3, 3
    s_mul_i32 s3, s3, 9216
    s_add_u32 s46, s3, s31
    s_add_u32 s3, s27, 3
    s_and_b32 s3, s3, 3
    s_mul_i32 s3, s3, 9216
    s_add_u32 s47, s3, s31
    s_add_u32 s49, s33, s10
    s_lshl_b32 s48, s49, 2
    s_add_u32 s48, s48, s27
    s_mul_i32 s48, s48, 9216
    s_lshl_b32 s49, s49, 7
    s_mov_b32 s16, s84
    s_mov_b32 s17, s85
    s_mov_b32 s18, 2359296
    s_mov_b32 s19, 0x20000
    buffer_load_dwordx4 v[156:159], v185, s[16:19], 0 offen
    buffer_load_dwordx4 v[160:163], v185, s[16:19], s44 offen
    buffer_load_ushort v164, v187, s[36:39], 0 offen
    buffer_load_ushort v165, v187, s[36:39], 0 offen offset:128
    s_mov_b32 s3, 0
    buffer_load_dword v148, v186, s[52:55], s3 offen sc1
    s_add_u32 s3, s3, 4096
    buffer_load_dword v149, v186, s[52:55], s3 offen sc1
    s_add_u32 s3, s3, 4096
    buffer_load_dword v150, v186, s[52:55], s3 offen sc1
    s_add_u32 s3, s3, 4096
    buffer_load_dword v151, v186, s[52:55], s3 offen sc1
    s_add_u32 s3, s3, 4096
    buffer_load_dword v152, v186, s[52:55], s3 offen sc1
    s_add_u32 s3, s3, 4096
    buffer_load_dword v153, v186, s[52:55], s3 offen sc1
    s_add_u32 s3, s3, 4096
    buffer_load_dword v154, v186, s[52:55], s3 offen sc1
    s_add_u32 s3, s3, 4096
    buffer_load_dword v155, v186, s[52:55], s3 offen sc1
    s_add_u32 s3, s3, 4096
    s_mov_b32 s50, 3
    s_lshl_b32 s33, s28, 2
    s_add_u32 s33, s33, s29
    s_lshl_b32 s33, s33, 2
    s_add_u32 s12, s98, 17104896
    s_addc_u32 s13, s99, 0
    s_mov_b32 s14, 9437184
    s_mov_b32 s15, 0x20000
    s_add_u32 s52, s98, 9437184
    s_addc_u32 s53, s99, 0
    s_mov_b32 s54, 2359296
    s_mov_b32 s55, 0x20000
    s_mov_b32 s36, s92
    s_mov_b32 s37, s93
    s_mov_b32 s38, 4096
    s_mov_b32 s39, 0x20000
    s_mov_b32 s40, s94
    s_mov_b32 s41, s95
    s_mov_b32 s42, 2359296
    s_mov_b32 s43, 0x20000
    v_lshlrev_b32 v184, 4, v1
    v_lshrrev_b32 v189, 4, v1
    v_and_b32 v190, 15, v1
    s_lshl_b32 s3, s27, 4
    v_add_u32 v190, s3, v190
    s_lshl_b32 s3, s28, 7
    v_add_u32 v186, s3, v190
    v_lshlrev_b32 v187, 1, v186
    v_mul_u32_u24 v185, 1152, v186
    s_mul_i32 s30, s29, 144
    s_lshl_b32 s3, s50, 5
    s_add_u32 s30, s30, s3
    s_mov_b32 s44, 73728
    v_lshlrev_b32 v189, 3, v189
    v_add_u32 v189, s30, v189
    v_lshl_add_u32 v185, v189, 1, v185
    v_lshlrev_b32 v186, 12, v189
    v_lshl_add_u32 v186, v190, 2, v186
    s_lshl_b32 s3, s28, 8
    v_add_u32 v186, s3, v186
    s_add_u32 s23, s33, s27
    s_mul_i32 s31, s23, 36864
    s_lshl_b32 s34, s10, 11
    s_add_u32 s31, s31, s34
    s_lshl_b32 s23, s23, 7
    s_lshl_b32 s34, s50, 12
    v_add_u32 v188, s34, v184
    s_add_u32 s3, s27, 1
    s_and_b32 s3, s3, 3
    s_mul_i32 s3, s3, 9216
    s_add_u32 s45, s3, s31
    s_add_u32 s3, s27, 2
    s_and_b32 s3, s3, 3
    s_mul_i32 s3, s3, 9216
    s_add_u32 s46, s3, s31
    s_add_u32 s3, s27, 3
    s_and_b32 s3, s3, 3
    s_mul_i32 s3, s3, 9216
    s_add_u32 s47, s3, s31
    s_add_u32 s49, s33, s10
    s_lshl_b32 s48, s49, 2
    s_add_u32 s48, s48, s27
    s_mul_i32 s48, s48, 9216
    s_lshl_b32 s49, s49, 7
    s_mov_b32 s16, s84
    s_mov_b32 s17, s85
    s_mov_b32 s18, 2359296
    s_mov_b32 s19, 0x20000
    buffer_load_dwordx4 v[132:135], v185, s[16:19], 0 offen
    buffer_load_dwordx4 v[136:139], v185, s[16:19], s44 offen
    buffer_load_ushort v140, v187, s[36:39], 0 offen
    buffer_load_ushort v141, v187, s[36:39], 0 offen offset:128
    s_mov_b32 s3, 0
    buffer_load_dword v124, v186, s[52:55], s3 offen sc1
    s_add_u32 s3, s3, 4096
    buffer_load_dword v125, v186, s[52:55], s3 offen sc1
    s_add_u32 s3, s3, 4096
    buffer_load_dword v126, v186, s[52:55], s3 offen sc1
    s_add_u32 s3, s3, 4096
    buffer_load_dword v127, v186, s[52:55], s3 offen sc1
    s_add_u32 s3, s3, 4096
    buffer_load_dword v128, v186, s[52:55], s3 offen sc1
    s_add_u32 s3, s3, 4096
    buffer_load_dword v129, v186, s[52:55], s3 offen sc1
    s_add_u32 s3, s3, 4096
    buffer_load_dword v130, v186, s[52:55], s3 offen sc1
    s_add_u32 s3, s3, 4096
    buffer_load_dword v131, v186, s[52:55], s3 offen sc1
    s_add_u32 s3, s3, 4096
    s_waitcnt vmcnt(33)
    s_barrier
    s_waitcnt vmcnt(24)
    s_barrier
    s_waitcnt vmcnt(0)
    v_lshlrev_b32 v164, 16, v164
    v_lshlrev_b32 v24, 16, v156
    v_and_b32 v25, 0xffff0000, v156
    v_add_f32 v24, v24, v164
    v_add_f32 v25, v25, v164
    v_lshlrev_b32 v26, 16, v157
    v_and_b32 v27, 0xffff0000, v157
    v_add_f32 v26, v26, v164
    v_add_f32 v27, v27, v164
    v_lshlrev_b32 v32, 16, v158
    v_and_b32 v33, 0xffff0000, v158
    v_add_f32 v32, v32, v164
    v_add_f32 v33, v33, v164
    v_lshlrev_b32 v34, 16, v159
    v_and_b32 v35, 0xffff0000, v159
    v_add_f32 v34, v34, v164
    v_add_f32 v35, v35, v164
    v_lshlrev_b32 v165, 16, v165
    v_lshlrev_b32 v28, 16, v160
    v_and_b32 v29, 0xffff0000, v160
    v_add_f32 v28, v28, v165
    v_add_f32 v29, v29, v165
    v_lshlrev_b32 v30, 16, v161
    v_and_b32 v31, 0xffff0000, v161
    v_add_f32 v30, v30, v165
    v_add_f32 v31, v31, v165
    v_lshlrev_b32 v36, 16, v162
    v_and_b32 v37, 0xffff0000, v162
    v_add_f32 v36, v36, v165
    v_add_f32 v37, v37, v165
    v_lshlrev_b32 v38, 16, v163
    v_and_b32 v39, 0xffff0000, v163
    v_add_f32 v38, v38, v165
    v_add_f32 v39, v39, v165
    v_lshlrev_b32 v166, 16, v148
    v_and_b32 v167, 0xffff0000, v148
    v_add_f32 v24, v24, v166
    v_add_f32 v28, v28, v167
    v_lshlrev_b32 v166, 16, v149
    v_and_b32 v167, 0xffff0000, v149
    v_add_f32 v25, v25, v166
    v_add_f32 v29, v29, v167
    v_lshlrev_b32 v166, 16, v150
    v_and_b32 v167, 0xffff0000, v150
    v_add_f32 v26, v26, v166
    v_add_f32 v30, v30, v167
    v_lshlrev_b32 v166, 16, v151
    v_and_b32 v167, 0xffff0000, v151
    v_add_f32 v27, v27, v166
    v_add_f32 v31, v31, v167
    v_lshlrev_b32 v166, 16, v152
    v_and_b32 v167, 0xffff0000, v152
    v_add_f32 v32, v32, v166
    v_add_f32 v36, v36, v167
    v_lshlrev_b32 v166, 16, v153
    v_and_b32 v167, 0xffff0000, v153
    v_add_f32 v33, v33, v166
    v_add_f32 v37, v37, v167
    v_lshlrev_b32 v166, 16, v154
    v_and_b32 v167, 0xffff0000, v154
    v_add_f32 v34, v34, v166
    v_add_f32 v38, v38, v167
    v_lshlrev_b32 v166, 16, v155
    v_and_b32 v167, 0xffff0000, v155
    v_add_f32 v35, v35, v166
    v_add_f32 v39, v39, v167
    v_add_u32 v188, 139264, v184
    ds_write_b128 v188, v[24:27] offset:0
    ds_write_b128 v188, v[28:31] offset:1024
    ds_write_b128 v188, v[32:35] offset:2048
    ds_write_b128 v188, v[36:39] offset:3072
    s_waitcnt vmcnt(0)
    v_lshlrev_b32 v140, 16, v140
    v_lshlrev_b32 v24, 16, v132
    v_and_b32 v25, 0xffff0000, v132
    v_add_f32 v24, v24, v140
    v_add_f32 v25, v25, v140
    v_lshlrev_b32 v26, 16, v133
    v_and_b32 v27, 0xffff0000, v133
    v_add_f32 v26, v26, v140
    v_add_f32 v27, v27, v140
    v_lshlrev_b32 v32, 16, v134
    v_and_b32 v33, 0xffff0000, v134
    v_add_f32 v32, v32, v140
    v_add_f32 v33, v33, v140
    v_lshlrev_b32 v34, 16, v135
    v_and_b32 v35, 0xffff0000, v135
    v_add_f32 v34, v34, v140
    v_add_f32 v35, v35, v140
    v_lshlrev_b32 v141, 16, v141
    v_lshlrev_b32 v28, 16, v136
    v_and_b32 v29, 0xffff0000, v136
    v_add_f32 v28, v28, v141
    v_add_f32 v29, v29, v141
    v_lshlrev_b32 v30, 16, v137
    v_and_b32 v31, 0xffff0000, v137
    v_add_f32 v30, v30, v141
    v_add_f32 v31, v31, v141
    v_lshlrev_b32 v36, 16, v138
    v_and_b32 v37, 0xffff0000, v138
    v_add_f32 v36, v36, v141
    v_add_f32 v37, v37, v141
    v_lshlrev_b32 v38, 16, v139
    v_and_b32 v39, 0xffff0000, v139
    v_add_f32 v38, v38, v141
    v_add_f32 v39, v39, v141
    v_lshlrev_b32 v166, 16, v124
    v_and_b32 v167, 0xffff0000, v124
    v_add_f32 v24, v24, v166
    v_add_f32 v28, v28, v167
    v_lshlrev_b32 v166, 16, v125
    v_and_b32 v167, 0xffff0000, v125
    v_add_f32 v25, v25, v166
    v_add_f32 v29, v29, v167
    v_lshlrev_b32 v166, 16, v126
    v_and_b32 v167, 0xffff0000, v126
    v_add_f32 v26, v26, v166
    v_add_f32 v30, v30, v167
    v_lshlrev_b32 v166, 16, v127
    v_and_b32 v167, 0xffff0000, v127
    v_add_f32 v27, v27, v166
    v_add_f32 v31, v31, v167
    v_lshlrev_b32 v166, 16, v128
    v_and_b32 v167, 0xffff0000, v128
    v_add_f32 v32, v32, v166
    v_add_f32 v36, v36, v167
    v_lshlrev_b32 v166, 16, v129
    v_and_b32 v167, 0xffff0000, v129
    v_add_f32 v33, v33, v166
    v_add_f32 v37, v37, v167
    v_lshlrev_b32 v166, 16, v130
    v_and_b32 v167, 0xffff0000, v130
    v_add_f32 v34, v34, v166
    v_add_f32 v38, v38, v167
    v_lshlrev_b32 v166, 16, v131
    v_and_b32 v167, 0xffff0000, v131
    v_add_f32 v35, v35, v166
    v_add_f32 v39, v39, v167
    v_add_u32 v188, 151552, v184
    ds_write_b128 v188, v[24:27] offset:0
    ds_write_b128 v188, v[28:31] offset:1024
    ds_write_b128 v188, v[32:35] offset:2048
    ds_write_b128 v188, v[36:39] offset:3072
    s_waitcnt lgkmcnt(0)
    s_barrier
    s_endpgm
g2l_6:
    s_mul_i32 s41, s33, 3072
    s_add_u32 s40, s41, s20
    s_mul_i32 s43, s34, 3072
    s_add_u32 s42, s43, s20
    s_mov_b32 s44, 0
    s_mov_b32 s45, 0
    s_mul_i32 s46, s37, 65536
    s_add_u32 s46, s46, s21
    s_mul_i32 s47, s37, 4096
    s_add_u32 s47, s47, 73728
    s_mov_b32 s48, 0
    s_mov_b32 s49, 0
    s_mov_b32 m0, s47
    s_add_u32 s47, s47, 16384
    buffer_load_dwordx4 v3, s[16:19], s46 offen offset:0  lds
    buffer_load_dwordx4 v4, s[16:19], s46 offen offset:1024  lds
    buffer_load_dwordx4 v5, s[16:19], s46 offen offset:2048  lds
    buffer_load_dwordx4 v6, s[16:19], s46 offen offset:3072  lds
    s_add_u32 s46, s46, 262144
    s_mov_b32 m0, s47
    s_add_u32 s47, s47, 16384
    buffer_load_dwordx4 v3, s[16:19], s46 offen offset:0  lds
    buffer_load_dwordx4 v4, s[16:19], s46 offen offset:1024  lds
    buffer_load_dwordx4 v5, s[16:19], s46 offen offset:2048  lds
    buffer_load_dwordx4 v6, s[16:19], s46 offen offset:3072  lds
    s_add_u32 s46, s46, 262144
    s_barrier
    s_barrier
    s_cmp_eq_u32 s23, 0
    s_cbranch_scc1 g2l6_nk
    s_waitcnt vmcnt(0)
g2l6_nk:
    s_mov_b32 m0, s41
    s_add_u32 s41, s41, 18432
    s_cmp_lg_u32 s23, 0
    s_cbranch_scc1 g2l6_k0_40
    buffer_load_dwordx4 v2, s[12:15], s40 offen offset:0 sc1  lds
    buffer_load_dwordx4 v2, s[12:15], s40 offen offset:1024 sc1  lds
    buffer_load_dwordx4 v2, s[12:15], s40 offen offset:2048 sc1  lds
g2l6_k0_40:
    s_add_u32 s40, s40, 18432
    s_mov_b32 m0, s43
    s_add_u32 s43, s43, 18432
    s_cmp_lg_u32 s23, 0
    s_cbranch_scc1 g2l6_k0_42
    buffer_load_dwordx4 v2, s[12:15], s42 offen offset:0 sc1  lds
g2l6_k0_42:
    s_add_u32 s42, s42, 18432
    s_add_u32 s45, s45, 1
    s_cmp_eq_u32 s45, s54
    s_cselect_b32 s24, s50, 0
    s_cselect_b32 s25, s51, 0
    s_add_u32 s40, s40, s24
    s_add_u32 s42, s42, s24
    s_add_u32 s44, s44, 1
    s_cmp_lg_u32 s44, 4
    s_cbranch_scc1 g2l6_w0
    s_mov_b32 s44, 0
    s_sub_u32 s41, s41, 73728
    s_sub_u32 s43, s43, 73728
g2l6_w0:
    s_add_u32 s49, s49, 1
    s_cmp_eq_u32 s49, s54
    s_cselect_b32 s24, s50, 0
    s_cselect_b32 s25, s51, 0
    s_add_u32 s46, s46, s25
    s_add_u32 s48, s48, 1
    s_cmp_lg_u32 s48, 4
    s_cbranch_scc1 g2l6_w1
    s_mov_b32 s48, 0
    s_sub_u32 s47, s47, 65536
g2l6_w1:
    s_mov_b32 m0, s41
    s_add_u32 s41, s41, 18432
    s_cmp_lg_u32 s23, 0
    s_cbranch_scc1 g2l6_k2_40
    buffer_load_dwordx4 v2, s[12:15], s40 offen offset:0 sc1  lds
    buffer_load_dwordx4 v2, s[12:15], s40 offen offset:1024 sc1  lds
    buffer_load_dwordx4 v2, s[12:15], s40 offen offset:2048 sc1  lds
g2l6_k2_40:
    s_add_u32 s40, s40, 18432
    s_mov_b32 m0, s43
    s_add_u32 s43, s43, 18432
    s_cmp_lg_u32 s23, 0
    s_cbranch_scc1 g2l6_k2_42
    buffer_load_dwordx4 v2, s[12:15], s42 offen offset:0 sc1  lds
g2l6_k2_42:
    s_add_u32 s42, s42, 18432
    s_add_u32 s45, s45, 1
    s_cmp_eq_u32 s45, s54
    s_cselect_b32 s24, s50, 0
    s_cselect_b32 s25, s51, 0
    s_add_u32 s40, s40, s24
    s_add_u32 s42, s42, s24
    s_add_u32 s44, s44, 1
    s_cmp_lg_u32 s44, 4
    s_cbranch_scc1 g2l6_w2
    s_mov_b32 s44, 0
    s_sub_u32 s41, s41, 73728
    s_sub_u32 s43, s43, 73728
g2l6_w2:
    s_add_u32 s49, s49, 1
    s_cmp_eq_u32 s49, s54
    s_cselect_b32 s24, s50, 0
    s_cselect_b32 s25, s51, 0
    s_add_u32 s46, s46, s25
    s_add_u32 s48, s48, 1
    s_cmp_lg_u32 s48, 4
    s_cbranch_scc1 g2l6_w3
    s_mov_b32 s48, 0
    s_sub_u32 s47, s47, 65536
g2l6_w3:
    s_waitcnt vmcnt(4)
    s_barrier
    s_mov_b32 m0, s47
    s_add_u32 s47, s47, 16384
    buffer_load_dwordx4 v3, s[16:19], s46 offen offset:0  lds
    buffer_load_dwordx4 v4, s[16:19], s46 offen offset:1024  lds
    buffer_load_dwordx4 v5, s[16:19], s46 offen offset:2048  lds
    buffer_load_dwordx4 v6, s[16:19], s46 offen offset:3072  lds
    s_add_u32 s46, s46, 262144
    s_waitcnt vmcnt(4)
    s_barrier
    s_mov_b32 m0, s41
    s_add_u32 s41, s41, 18432
    buffer_load_dwordx4 v2, s[12:15], s40 offen offset:0 sc1  lds
    buffer_load_dwordx4 v2, s[12:15], s40 offen offset:1024 sc1  lds
    buffer_load_dwordx4 v2, s[12:15], s40 offen offset:2048 sc1  lds
    s_add_u32 s40, s40, 18432
    s_mov_b32 m0, s43
    s_add_u32 s43, s43, 18432
    buffer_load_dwordx4 v2, s[12:15], s42 offen offset:0 sc1  lds
    s_add_u32 s42, s42, 18432
    s_add_u32 s45, s45, 1
    s_cmp_eq_u32 s45, s54
    s_cselect_b32 s24, s50, 0
    s_cselect_b32 s25, s51, 0
    s_add_u32 s40, s40, s24
    s_add_u32 s42, s42, s24
    s_add_u32 s44, s44, 1
    s_cmp_lg_u32 s44, 4
    s_cbranch_scc1 g2l6_w4
    s_mov_b32 s44, 0
    s_sub_u32 s41, s41, 73728
    s_sub_u32 s43, s43, 73728
g2l6_w4:
    s_add_u32 s49, s49, 1
    s_cmp_eq_u32 s49, s54
    s_cselect_b32 s24, s50, 0
    s_cselect_b32 s25, s51, 0
    s_add_u32 s46, s46, s25
    s_add_u32 s48, s48, 1
    s_cmp_lg_u32 s48, 4
    s_cbranch_scc1 g2l6_w5
    s_mov_b32 s48, 0
    s_sub_u32 s47, s47, 65536
g2l6_w5:
    s_mov_b32 m0, s41
    s_add_u32 s41, s41, 18432
    buffer_load_dwordx4 v2, s[12:15], s40 offen offset:0 sc1  lds
    buffer_load_dwordx4 v2, s[12:15], s40 offen offset:1024 sc1  lds
    buffer_load_dwordx4 v2, s[12:15], s40 offen offset:2048 sc1  lds
    s_add_u32 s40, s40, 18432
    s_mov_b32 m0, s43
    s_add_u32 s43, s43, 18432
    buffer_load_dwordx4 v2, s[12:15], s42 offen offset:0 sc1  lds
    s_add_u32 s42, s42, 18432
    s_add_u32 s45, s45, 1
    s_cmp_eq_u32 s45, s54
    s_cselect_b32 s24, s50, 0
    s_cselect_b32 s25, s51, 0
    s_add_u32 s40, s40, s24
    s_add_u32 s42, s42, s24
    s_add_u32 s44, s44, 1
    s_cmp_lg_u32 s44, 4
    s_cbranch_scc1 g2l6_w6
    s_mov_b32 s44, 0
    s_sub_u32 s41, s41, 73728
    s_sub_u32 s43, s43, 73728
g2l6_w6:
    s_mov_b32 m0, s47
    s_add_u32 s47, s47, 16384
    buffer_load_dwordx4 v3, s[16:19], s46 offen offset:0  lds
    buffer_load_dwordx4 v4, s[16:19], s46 offen offset:1024  lds
    buffer_load_dwordx4 v5, s[16:19], s46 offen offset:2048  lds
    buffer_load_dwordx4 v6, s[16:19], s46 offen offset:3072  lds
    s_add_u32 s46, s46, 262144
    s_add_u32 s49, s49, 1
    s_cmp_eq_u32 s49, s54
    s_cselect_b32 s24, s50, 0
    s_cselect_b32 s25, s51, 0
    s_add_u32 s46, s46, s25
    s_add_u32 s48, s48, 1
    s_cmp_lg_u32 s48, 4
    s_cbranch_scc1 g2l6_w7
    s_mov_b32 s48, 0
    s_sub_u32 s47, s47, 65536
g2l6_w7:
    s_mov_b32 s26, 0
g2l6_loop:
    s_waitcnt vmcnt(8)
    s_barrier
    s_mov_b32 m0, s41
    s_add_u32 s41, s41, 18432
    buffer_load_dwordx4 v2, s[12:15], s40 offen offset:0 sc1  lds
    buffer_load_dwordx4 v2, s[12:15], s40 offen offset:1024 sc1  lds
    buffer_load_dwordx4 v2, s[12:15], s40 offen offset:2048 sc1  lds
    s_add_u32 s40, s40, 18432
    s_mov_b32 m0, s43
    s_add_u32 s43, s43, 18432
    buffer_load_dwordx4 v2, s[12:15], s42 offen offset:0 sc1  lds
    s_add_u32 s42, s42, 18432
    s_add_u32 s45, s45, 1
    s_cmp_eq_u32 s45, s54
    s_cselect_b32 s24, s50, 0
    s_cselect_b32 s25, s51, 0
    s_add_u32 s40, s40, s24
    s_add_u32 s42, s42, s24
    s_add_u32 s44, s44, 1
    s_cmp_lg_u32 s44, 4
    s_cbranch_scc1 g2l6_w8
    s_mov_b32 s44, 0
    s_sub_u32 s41, s41, 73728
    s_sub_u32 s43, s43, 73728
g2l6_w8:
    s_mov_b32 m0, s47
    s_add_u32 s47, s47, 16384
    buffer_load_dwordx4 v3, s[16:19], s46 offen offset:0  lds
    buffer_load_dwordx4 v4, s[16:19], s46 offen offset:1024  lds
    buffer_load_dwordx4 v5, s[16:19], s46 offen offset:2048  lds
    buffer_load_dwordx4 v6, s[16:19], s46 offen offset:3072  lds
    s_add_u32 s46, s46, 262144
    s_add_u32 s49, s49, 1
    s_cmp_eq_u32 s49, s54
    s_cselect_b32 s24, s50, 0
    s_cselect_b32 s25, s51, 0
    s_add_u32 s46, s46, s25
    s_add_u32 s48, s48, 1
    s_cmp_lg_u32 s48, 4
    s_cbranch_scc1 g2l6_w9
    s_mov_b32 s48, 0
    s_sub_u32 s47, s47, 65536
g2l6_w9:
    s_add_u32 s26, s26, 1
    s_cmp_lt_u32 s26, 14
    s_cbranch_scc1 g2l6_loop
    s_mov_b32 s50, 1
    s_lshl_b32 s33, s28, 2
    s_add_u32 s33, s33, s29
    s_lshl_b32 s33, s33, 2
    s_add_u32 s12, s98, 17104896
    s_addc_u32 s13, s99, 0
    s_mov_b32 s14, 9437184
    s_mov_b32 s15, 0x20000
    s_add_u32 s52, s98, 9437184
    s_addc_u32 s53, s99, 0
    s_mov_b32 s54, 2359296
    s_mov_b32 s55, 0x20000
    s_mov_b32 s36, s92
    s_mov_b32 s37, s93
    s_mov_b32 s38, 4096
    s_mov_b32 s39, 0x20000
    s_mov_b32 s40, s94
    s_mov_b32 s41, s95
    s_mov_b32 s42, 2359296
    s_mov_b32 s43, 0x20000
    v_lshlrev_b32 v184, 4, v1
    v_lshrrev_b32 v189, 4, v1
    v_and_b32 v190, 15, v1
    s_lshl_b32 s3, s27, 4
    v_add_u32 v190, s3, v190
    s_lshl_b32 s3, s28, 7
    v_add_u32 v186, s3, v190
    v_lshlrev_b32 v187, 1, v186
    v_mul_u32_u24 v185, 1152, v186
    s_mul_i32 s30, s29, 144
    s_lshl_b32 s3, s50, 5
    s_add_u32 s30, s30, s3
    s_mov_b32 s44, 73728
    v_lshlrev_b32 v189, 3, v189
    v_add_u32 v189, s30, v189
    v_lshl_add_u32 v185, v189, 1, v185
    v_lshlrev_b32 v186, 12, v189
    v_lshl_add_u32 v186, v190, 2, v186
    s_lshl_b32 s3, s28, 8
    v_add_u32 v186, s3, v186
    s_add_u32 s23, s33, s27
    s_mul_i32 s31, s23, 36864
    s_lshl_b32 s34, s10, 11
    s_add_u32 s31, s31, s34
    s_lshl_b32 s23, s23, 7
    s_lshl_b32 s34, s50, 12
    v_add_u32 v188, s34, v184
    s_add_u32 s3, s27, 1
    s_and_b32 s3, s3, 3
    s_mul_i32 s3, s3, 9216
    s_add_u32 s45, s3, s31
    s_add_u32 s3, s27, 2
    s_and_b32 s3, s3, 3
    s_mul_i32 s3, s3, 9216
    s_add_u32 s46, s3, s31
    s_add_u32 s3, s27, 3
    s_and_b32 s3, s3, 3
    s_mul_i32 s3, s3, 9216
    s_add_u32 s47, s3, s31
    s_add_u32 s49, s33, s10
    s_lshl_b32 s48, s49, 2
    s_add_u32 s48, s48, s27
    s_mul_i32 s48, s48, 9216
    s_lshl_b32 s49, s49, 7
    s_mov_b32 s16, s84
    s_mov_b32 s17, s85
    s_mov_b32 s18, 2359296
    s_mov_b32 s19, 0x20000
    buffer_load_dwordx4 v[156:159], v185, s[16:19], 0 offen
    buffer_load_dwordx4 v[160:163], v185, s[16:19], s44 offen
    buffer_load_ushort v164, v187, s[36:39], 0 offen
    buffer_load_ushort v165, v187, s[36:39], 0 offen offset:128
    s_mov_b32 s3, 0
    buffer_load_dword v148, v186, s[52:55], s3 offen sc1
    s_add_u32 s3, s3, 4096
    buffer_load_dword v149, v186, s[52:55], s3 offen sc1
    s_add_u32 s3, s3, 4096
    buffer_load_dword v150, v186, s[52:55], s3 offen sc1
    s_add_u32 s3, s3, 4096
    buffer_load_dword v151, v186, s[52:55], s3 offen sc1
    s_add_u32 s3, s3, 4096
    buffer_load_dword v152, v186, s[52:55], s3 offen sc1
    s_add_u32 s3, s3, 4096
    buffer_load_dword v153, v186, s[52:55], s3 offen sc1
    s_add_u32 s3, s3, 4096
    buffer_load_dword v154, v186, s[52:55], s3 offen sc1
    s_add_u32 s3, s3, 4096
    buffer_load_dword v155, v186, s[52:55], s3 offen sc1
    s_add_u32 s3, s3, 4096
    s_waitcnt vmcnt(20)
    s_barrier
    s_waitcnt vmcnt(12)
    s_barrier
    s_waitcnt vmcnt(0)
    v_lshlrev_b32 v164, 16, v164
    v_lshlrev_b32 v24, 16, v156
    v_and_b32 v25, 0xffff0000, v156
    v_add_f32 v24, v24, v164
    v_add_f32 v25, v25, v164
    v_lshlrev_b32 v26, 16, v157
    v_and_b32 v27, 0xffff0000, v157
    v_add_f32 v26, v26, v164
    v_add_f32 v27, v27, v164
    v_lshlrev_b32 v32, 16, v158
    v_and_b32 v33, 0xffff0000, v158
    v_add_f32 v32, v32, v164
    v_add_f32 v33, v33, v164
    v_lshlrev_b32 v34, 16, v159
    v_and_b32 v35, 0xffff0000, v159
    v_add_f32 v34, v34, v164
    v_add_f32 v35, v35, v164
    v_lshlrev_b32 v165, 16, v165
    v_lshlrev_b32 v28, 16, v160
    v_and_b32 v29, 0xffff0000, v160
    v_add_f32 v28, v28, v165
    v_add_f32 v29, v29, v165
    v_lshlrev_b32 v30, 16, v161
    v_and_b32 v31, 0xffff0000, v161
    v_add_f32 v30, v30, v165
    v_add_f32 v31, v31, v165
    v_lshlrev_b32 v36, 16, v162
    v_and_b32 v37, 0xffff0000, v162
    v_add_f32 v36, v36, v165
    v_add_f32 v37, v37, v165
    v_lshlrev_b32 v38, 16, v163
    v_and_b32 v39, 0xffff0000, v163
    v_add_f32 v38, v38, v165
    v_add_f32 v39, v39, v165
    v_lshlrev_b32 v166, 16, v148
    v_and_b32 v167, 0xffff0000, v148
    v_add_f32 v24, v24, v166
    v_add_f32 v28, v28, v167
    v_lshlrev_b32 v166, 16, v149
    v_and_b32 v167, 0xffff0000, v149
    v_add_f32 v25, v25, v166
    v_add_f32 v29, v29, v167
    v_lshlrev_b32 v166, 16, v150
    v_and_b32 v167, 0xffff0000, v150
    v_add_f32 v26, v26, v166
    v_add_f32 v30, v30, v167
    v_lshlrev_b32 v166, 16, v151
    v_and_b32 v167, 0xffff0000, v151
    v_add_f32 v27, v27, v166
    v_add_f32 v31, v31, v167
    v_lshlrev_b32 v166, 16, v152
    v_and_b32 v167, 0xffff0000, v152
    v_add_f32 v32, v32, v166
    v_add_f32 v36, v36, v167
    v_lshlrev_b32 v166, 16, v153
    v_and_b32 v167, 0xffff0000, v153
    v_add_f32 v33, v33, v166
    v_add_f32 v37, v37, v167
    v_lshlrev_b32 v166, 16, v154
    v_and_b32 v167, 0xffff0000, v154
    v_add_f32 v34, v34, v166
    v_add_f32 v38, v38, v167
    v_lshlrev_b32 v166, 16, v155
    v_and_b32 v167, 0xffff0000, v155
    v_add_f32 v35, v35, v166
    v_add_f32 v39, v39, v167
    v_add_u32 v188, 143360, v184
    ds_write_b128 v188, v[24:27] offset:0
    ds_write_b128 v188, v[28:31] offset:1024
    ds_write_b128 v188, v[32:35] offset:2048
    ds_write_b128 v188, v[36:39] offset:3072
    s_waitcnt lgkmcnt(0)
    s_barrier
    s_endpgm
g2l_7:
    s_mul_i32 s41, s35, 3072
    s_add_u32 s40, s41, s20
    s_mul_i32 s43, s34, 3072
    s_add_u32 s42, s43, s20
    s_mov_b32 s44, 0
    s_mov_b32 s45, 0
    s_mul_i32 s46, s38, 65536
    s_add_u32 s46, s46, s21
    s_mul_i32 s47, s38, 4096
    s_add_u32 s47, s47, 73728
    s_mov_b32 s48, 0
    s_mov_b32 s49, 0
    s_mov_b32 m0, s47
    s_add_u32 s47, s47, 16384
    buffer_load_dwordx4 v3, s[16:19], s46 offen offset:0  lds
    buffer_load_dwordx4 v4, s[16:19], s46 offen offset:1024  lds
    buffer_load_dwordx4 v5, s[16:19], s46 offen offset:2048  lds
    buffer_load_dwordx4 v6, s[16:19], s46 offen offset:3072  lds
    s_add_u32 s46, s46, 262144
    s_mov_b32 m0, s47
    s_add_u32 s47, s47, 16384
    buffer_load_dwordx4 v3, s[16:19], s46 offen offset:0  lds
    buffer_load_dwordx4 v4, s[16:19], s46 offen offset:1024  lds
    buffer_load_dwordx4 v5, s[16:19], s46 offen offset:2048  lds
    buffer_load_dwordx4 v6, s[16:19], s46 offen offset:3072  lds
    s_add_u32 s46, s46, 262144
    s_lshr_b32 s24, s2, 3
    s_sub_u32 s24, s24, 18
    s_cmp_ge_u32 s24, 6
    s_cbranch_scc1 g2_nv
    v_lshrrev_b32 v20, 4, v1
    v_lshlrev_b32 v20, 12, v20
    v_and_b32 v21, 15, v1
    v_lshl_add_u32 v20, v21, 7, v20
    s_add_u32 s24, s24, 8
    s_lshl_b32 s24, s24, 14
    s_mul_i32 s25, s27, 4718592
    s_add_u32 s24, s24, s25
    s_and_b32 s25, s2, 1
    s_lshl_b32 s25, s25, 11
    s_add_u32 s24, s24, s25
    s_mov_b32 s26, 0
g2_v:
    buffer_load_dword v22, v20, s[16:19], s24 offen
    s_add_u32 s24, s24, 229376
    s_add_u32 s26, s26, 1
    s_waitcnt vmcnt(3)
    s_cmp_lt_u32 s26, 20
    s_cbranch_scc1 g2_v
g2_nv:
    s_barrier
    s_barrier
    s_cmp_eq_u32 s23, 0
    s_cbranch_scc1 g2l7_nk
    s_waitcnt vmcnt(0)
g2l7_nk:
    s_mov_b32 m0, s41
    s_add_u32 s41, s41, 18432
    s_cmp_lg_u32 s23, 0
    s_cbranch_scc1 g2l7_k0_40
    buffer_load_dwordx4 v2, s[12:15], s40 offen offset:0 sc1  lds
    buffer_load_dwordx4 v2, s[12:15], s40 offen offset:1024 sc1  lds
    buffer_load_dwordx4 v2, s[12:15], s40 offen offset:2048 sc1  lds
g2l7_k0_40:
    s_add_u32 s40, s40, 18432
    s_mov_b32 m0, s43
    s_add_u32 s43, s43, 18432
    s_cmp_lg_u32 s23, 0
    s_cbranch_scc1 g2l7_k0_42
    buffer_load_dwordx4 v2, s[12:15], s42 offen offset:1024 sc1  lds
    buffer_load_dwordx4 v2, s[12:15], s42 offen offset:2048 sc1  lds
g2l7_k0_42:
    s_add_u32 s42, s42, 18432
    s_add_u32 s45, s45, 1
    s_cmp_eq_u32 s45, s54
    s_cselect_b32 s24, s50, 0
    s_cselect_b32 s25, s51, 0
    s_add_u32 s40, s40, s24
    s_add_u32 s42, s42, s24
    s_add_u32 s44, s44, 1
    s_cmp_lg_u32 s44, 4
    s_cbranch_scc1 g2l7_w0
    s_mov_b32 s44, 0
    s_sub_u32 s41, s41, 73728
    s_sub_u32 s43, s43, 73728
g2l7_w0:
    s_add_u32 s49, s49, 1
    s_cmp_eq_u32 s49, s54
    s_cselect_b32 s24, s50, 0
    s_cselect_b32 s25, s51, 0
    s_add_u32 s46, s46, s25
    s_add_u32 s48, s48, 1
    s_cmp_lg_u32 s48, 4
    s_cbranch_scc1 g2l7_w1
    s_mov_b32 s48, 0
    s_sub_u32 s47, s47, 65536
g2l7_w1:
    s_mov_b32 m0, s41
    s_add_u32 s41, s41, 18432
    s_cmp_lg_u32 s23, 0
    s_cbranch_scc1 g2l7_k2_40
    buffer_load_dwordx4 v2, s[12:15], s40 offen offset:0 sc1  lds
    buffer_load_dwordx4 v2, s[12:15], s40 offen offset:1024 sc1  lds
    buffer_load_dwordx4 v2, s[12:15], s40 offen offset:2048 sc1  lds
g2l7_k2_40:
    s_add_u32 s40, s40, 18432
    s_mov_b32 m0, s43
    s_add_u32 s43, s43, 18432
    s_cmp_lg_u32 s23, 0
    s_cbranch_scc1 g2l7_k2_42
    buffer_load_dwordx4 v2, s[12:15], s42 offen offset:1024 sc1  lds
    buffer_load_dwordx4 v2, s[12:15], s42 offen offset:2048 sc1  lds
g2l7_k2_42:
    s_add_u32 s42, s42, 18432
    s_add_u32 s45, s45, 1
    s_cmp_eq_u32 s45, s54
    s_cselect_b32 s24, s50, 0
    s_cselect_b32 s25, s51, 0
    s_add_u32 s40, s40, s24
    s_add_u32 s42, s42, s24
    s_add_u32 s44, s44, 1
    s_cmp_lg_u32 s44, 4
    s_cbranch_scc1 g2l7_w2
    s_mov_b32 s44, 0
    s_sub_u32 s41, s41, 73728
    s_sub_u32 s43, s43, 73728
g2l7_w2:
    s_add_u32 s49, s49, 1
    s_cmp_eq_u32 s49, s54
    s_cselect_b32 s24, s50, 0
    s_cselect_b32 s25, s51, 0
    s_add_u32 s46, s46, s25
    s_add_u32 s48, s48, 1
    s_cmp_lg_u32 s48, 4
    s_cbranch_scc1 g2l7_w3
    s_mov_b32 s48, 0
    s_sub_u32 s47, s47, 65536
g2l7_w3:
    s_waitcnt vmcnt(5)
    s_barrier
    s_mov_b32 m0, s47
    s_add_u32 s47, s47, 16384
    buffer_load_dwordx4 v3, s[16:19], s46 offen offset:0  lds
    buffer_load_dwordx4 v4, s[16:19], s46 offen offset:1024  lds
    buffer_load_dwordx4 v5, s[16:19], s46 offen offset:2048  lds
    buffer_load_dwordx4 v6, s[16:19], s46 offen offset:3072  lds
    s_add_u32 s46, s46, 262144
    s_waitcnt vmcnt(4)
    s_barrier
    s_mov_b32 m0, s41
    s_add_u32 s41, s41, 18432
    buffer_load_dwordx4 v2, s[12:15], s40 offen offset:0 sc1  lds
    buffer_load_dwordx4 v2, s[12:15], s40 offen offset:1024 sc1  lds
    buffer_load_dwordx4 v2, s[12:15], s40 offen offset:2048 sc1  lds
    s_add_u32 s40, s40, 18432
    s_mov_b32 m0, s43
    s_add_u32 s43, s43, 18432
    buffer_load_dwordx4 v2, s[12:15], s42 offen offset:1024 sc1  lds
    buffer_load_dwordx4 v2, s[12:15], s42 offen offset:2048 sc1  lds
    s_add_u32 s42, s42, 18432
    s_add_u32 s45, s45, 1
    s_cmp_eq_u32 s45, s54
    s_cselect_b32 s24, s50, 0
    s_cselect_b32 s25, s51, 0
    s_add_u32 s40, s40, s24
    s_add_u32 s42, s42, s24
    s_add_u32 s44, s44, 1
    s_cmp_lg_u32 s44, 4
    s_cbranch_scc1 g2l7_w4
    s_mov_b32 s44, 0
    s_sub_u32 s41, s41, 73728
    s_sub_u32 s43, s43, 73728
g2l7_w4:
    s_add_u32 s49, s49, 1
    s_cmp_eq_u32 s49, s54
    s_cselect_b32 s24, s50, 0
    s_cselect_b32 s25, s51, 0
    s_add_u32 s46, s46, s25
    s_add_u32 s48, s48, 1
    s_cmp_lg_u32 s48, 4
    s_cbranch_scc1 g2l7_w5
    s_mov_b32 s48, 0
    s_sub_u32 s47, s47, 65536
g2l7_w5:
    s_mov_b32 m0, s41
    s_add_u32 s41, s41, 18432
    buffer_load_dwordx4 v2, s[12:15], s40 offen offset:0 sc1  lds
    buffer_load_dwordx4 v2, s[12:15], s40 offen offset:1024 sc1  lds
    buffer_load_dwordx4 v2, s[12:15], s40 offen offset:2048 sc1  lds
    s_add_u32 s40, s40, 18432
    s_mov_b32 m0, s43
    s_add_u32 s43, s43, 18432
    buffer_load_dwordx4 v2, s[12:15], s42 offen offset:1024 sc1  lds
    buffer_load_dwordx4 v2, s[12:15], s42 offen offset:2048 sc1  lds
    s_add_u32 s42, s42, 18432
    s_add_u32 s45, s45, 1
    s_cmp_eq_u32 s45, s54
    s_cselect_b32 s24, s50, 0
    s_cselect_b32 s25, s51, 0
    s_add_u32 s40, s40, s24
    s_add_u32 s42, s42, s24
    s_add_u32 s44, s44, 1
    s_cmp_lg_u32 s44, 4
    s_cbranch_scc1 g2l7_w6
    s_mov_b32 s44, 0
    s_sub_u32 s41, s41, 73728
    s_sub_u32 s43, s43, 73728
g2l7_w6:
    s_mov_b32 m0, s47
    s_add_u32 s47, s47, 16384
    buffer_load_dwordx4 v3, s[16:19], s46 offen offset:0  lds
    buffer_load_dwordx4 v4, s[16:19], s46 offen offset:1024  lds
    buffer_load_dwordx4 v5, s[16:19], s46 offen offset:2048  lds
    buffer_load_dwordx4 v6, s[16:19], s46 offen offset:3072  lds
    s_add_u32 s46, s46, 262144
    s_add_u32 s49, s49, 1
    s_cmp_eq_u32 s49, s54
    s_cselect_b32 s24, s50, 0
    s_cselect_b32 s25, s51, 0
    s_add_u32 s46, s46, s25
    s_add_u32 s48, s48, 1
    s_cmp_lg_u32 s48, 4
    s_cbranch_scc1 g2l7_w7
    s_mov_b32 s48, 0
    s_sub_u32 s47, s47, 65536
g2l7_w7:
    s_mov_b32 s26, 0
g2l7_loop:
    s_waitcnt vmcnt(9)
    s_barrier
    s_mov_b32 m0, s41
    s_add_u32 s41, s41, 18432
    buffer_load_dwordx4 v2, s[12:15], s40 offen offset:0 sc1  lds
    buffer_load_dwordx4 v2, s[12:15], s40 offen offset:1024 sc1  lds
    buffer_load_dwordx4 v2, s[12:15], s40 offen offset:2048 sc1  lds
    s_add_u32 s40, s40, 18432
    s_mov_b32 m0, s43
    s_add_u32 s43, s43, 18432
    buffer_load_dwordx4 v2, s[12:15], s42 offen offset:1024 sc1  lds
    buffer_load_dwordx4 v2, s[12:15], s42 offen offset:2048 sc1  lds
    s_add_u32 s42, s42, 18432
    s_add_u32 s45, s45, 1
    s_cmp_eq_u32 s45, s54
    s_cselect_b32 s24, s50, 0
    s_cselect_b32 s25, s51, 0
    s_add_u32 s40, s40, s24
    s_add_u32 s42, s42, s24
    s_add_u32 s44, s44, 1
    s_cmp_lg_u32 s44, 4
    s_cbranch_scc1 g2l7_w8
    s_mov_b32 s44, 0
    s_sub_u32 s41, s41, 73728
    s_sub_u32 s43, s43, 73728
g2l7_w8:
    s_mov_b32 m0, s47
    s_add_u32 s47, s47, 16384
    buffer_load_dwordx4 v3, s[16:19], s46 offen offset:0  lds
    buffer_load_dwordx4 v4, s[16:19], s46 offen offset:1024  lds
    buffer_load_dwordx4 v5, s[16:19], s46 offen offset:2048  lds
    buffer_load_dwordx4 v6, s[16:19], s46 offen offset:3072  lds
    s_add_u32 s46, s46, 262144
    s_add_u32 s49, s49, 1
    s_cmp_eq_u32 s49, s54
    s_cselect_b32 s24, s50, 0
    s_cselect_b32 s25, s51, 0
    s_add_u32 s46, s46, s25
    s_add_u32 s48, s48, 1
    s_cmp_lg_u32 s48, 4
    s_cbranch_scc1 g2l7_w9
    s_mov_b32 s48, 0
    s_sub_u32 s47, s47, 65536
g2l7_w9:
    s_add_u32 s26, s26, 1
    s_cmp_lt_u32 s26, 14
    s_cbranch_scc1 g2l7_loop
    s_mov_b32 s50, 2
    s_lshl_b32 s33, s28, 2
    s_add_u32 s33, s33, s29
    s_lshl_b32 s33, s33, 2
    s_add_u32 s12, s98, 17104896
    s_addc_u32 s13, s99, 0
    s_mov_b32 s14, 9437184
    s_mov_b32 s15, 0x20000
    s_add_u32 s52, s98, 9437184
    s_addc_u32 s53, s99, 0
    s_mov_b32 s54, 2359296
    s_mov_b32 s55, 0x20000
    s_mov_b32 s36, s92
    s_mov_b32 s37, s93
    s_mov_b32 s38, 4096
    s_mov_b32 s39, 0x20000
    s_mov_b32 s40, s94
    s_mov_b32 s41, s95
    s_mov_b32 s42, 2359296
    s_mov_b32 s43, 0x20000
    v_lshlrev_b32 v184, 4, v1
    v_lshrrev_b32 v189, 4, v1
    v_and_b32 v190, 15, v1
    s_lshl_b32 s3, s27, 4
    v_add_u32 v190, s3, v190
    s_lshl_b32 s3, s28, 7
    v_add_u32 v186, s3, v190
    v_lshlrev_b32 v187, 1, v186
    v_mul_u32_u24 v185, 1152, v186
    s_mul_i32 s30, s29, 144
    s_lshl_b32 s3, s50, 5
    s_add_u32 s30, s30, s3
    s_mov_b32 s44, 73728
    v_lshlrev_b32 v189, 3, v189
    v_add_u32 v189, s30, v189
    v_lshl_add_u32 v185, v189, 1, v185
    v_lshlrev_b32 v186, 12, v189
    v_lshl_add_u32 v186, v190, 2, v186
    s_lshl_b32 s3, s28, 8
    v_add_u32 v186, s3, v186
    s_add_u32 s23, s33, s27
    s_mul_i32 s31, s23, 36864
    s_lshl_b32 s34, s10, 11
    s_add_u32 s31, s31, s34
    s_lshl_b32 s23, s23, 7
    s_lshl_b32 s34, s50, 12
    v_add_u32 v188, s34, v184
    s_add_u32 s3, s27, 1
    s_and_b32 s3, s3, 3
    s_mul_i32 s3, s3, 9216
    s_add_u32 s45, s3, s31
    s_add_u32 s3, s27, 2
    s_and_b32 s3, s3, 3
    s_mul_i32 s3, s3, 9216
    s_add_u32 s46, s3, s31
    s_add_u32 s3, s27, 3
    s_and_b32 s3, s3, 3
    s_mul_i32 s3, s3, 9216
    s_add_u32 s47, s3, s31
    s_add_u32 s49, s33, s10
    s_lshl_b32 s48, s49, 2
    s_add_u32 s48, s48, s27
    s_mul_i32 s48, s48, 9216
    s_lshl_b32 s49, s49, 7
    s_mov_b32 s16, s84
    s_mov_b32 s17, s85
    s_mov_b32 s18, 2359296
    s_mov_b32 s19, 0x20000
    buffer_load_dwordx4 v[156:159], v185, s[16:19], 0 offen
    buffer_load_dwordx4 v[160:163], v185, s[16:19], s44 offen
    buffer_load_ushort v164, v187, s[36:39], 0 offen
    buffer_load_ushort v165, v187, s[36:39], 0 offen offset:128
    s_mov_b32 s3, 0
    buffer_load_dword v148, v186, s[52:55], s3 offen sc1
    s_add_u32 s3, s3, 4096
    buffer_load_dword v149, v186, s[52:55], s3 offen sc1
    s_add_u32 s3, s3, 4096
    buffer_load_dword v150, v186, s[52:55], s3 offen sc1
    s_add_u32 s3, s3, 4096
    buffer_load_dword v151, v186, s[52:55], s3 offen sc1
    s_add_u32 s3, s3, 4096
    buffer_load_dword v152, v186, s[52:55], s3 offen sc1
    s_add_u32 s3, s3, 4096
    buffer_load_dword v153, v186, s[52:55], s3 offen sc1
    s_add_u32 s3, s3, 4096
    buffer_load_dword v154, v186, s[52:55], s3 offen sc1
    s_add_u32 s3, s3, 4096
    buffer_load_dword v155, v186, s[52:55], s3 offen sc1
    s_add_u32 s3, s3, 4096
    s_waitcnt vmcnt(21)
    s_barrier
    s_waitcnt vmcnt(12)
    s_barrier
    s_waitcnt vmcnt(0)
    v_lshlrev_b32 v164, 16, v164
    v_lshlrev_b32 v24, 16, v156
    v_and_b32 v25, 0xffff0000, v156
    v_add_f32 v24, v24, v164
    v_add_f32 v25, v25, v164
    v_lshlrev_b32 v26, 16, v157
    v_and_b32 v27, 0xffff0000, v157
    v_add_f32 v26, v26, v164
    v_add_f32 v27, v27, v164
    v_lshlrev_b32 v32, 16, v158
    v_and_b32 v33, 0xffff0000, v158
    v_add_f32 v32, v32, v164
    v_add_f32 v33, v33, v164
    v_lshlrev_b32 v34, 16, v159
    v_and_b32 v35, 0xffff0000, v159
    v_add_f32 v34, v34, v164
    v_add_f32 v35, v35, v164
    v_lshlrev_b32 v165, 16, v165
    v_lshlrev_b32 v28, 16, v160
    v_and_b32 v29, 0xffff0000, v160
    v_add_f32 v28, v28, v165
    v_add_f32 v29, v29, v165
    v_lshlrev_b32 v30, 16, v161
    v_and_b32 v31, 0xffff0000, v161
    v_add_f32 v30, v30, v165
    v_add_f32 v31, v31, v165
    v_lshlrev_b32 v36, 16, v162
    v_and_b32 v37, 0xffff0000, v162
    v_add_f32 v36, v36, v165
    v_add_f32 v37, v37, v165
    v_lshlrev_b32 v38, 16, v163
    v_and_b32 v39, 0xffff0000, v163
    v_add_f32 v38, v38, v165
    v_add_f32 v39, v39, v165
    v_lshlrev_b32 v166, 16, v148
    v_and_b32 v167, 0xffff0000, v148
    v_add_f32 v24, v24, v166
    v_add_f32 v28, v28, v167
    v_lshlrev_b32 v166, 16, v149
    v_and_b32 v167, 0xffff0000, v149
    v_add_f32 v25, v25, v166
    v_add_f32 v29, v29, v167
    v_lshlrev_b32 v166, 16, v150
    v_and_b32 v167, 0xffff0000, v150
    v_add_f32 v26, v26, v166
    v_add_f32 v30, v30, v167
    v_lshlrev_b32 v166, 16, v151
    v_and_b32 v167, 0xffff0000, v151
    v_add_f32 v27, v27, v166
    v_add_f32 v31, v31, v167
    v_lshlrev_b32 v166, 16, v152
    v_and_b32 v167, 0xffff0000, v152
    v_add_f32 v32, v32, v166
    v_add_f32 v36, v36, v167
    v_lshlrev_b32 v166, 16, v153
    v_and_b32 v167, 0xffff0000, v153
    v_add_f32 v33, v33, v166
    v_add_f32 v37, v37, v167
    v_lshlrev_b32 v166, 16, v154
    v_and_b32 v167, 0xffff0000, v154
    v_add_f32 v34, v34, v166
    v_add_f32 v38, v38, v167
    v_lshlrev_b32 v166, 16, v155
    v_and_b32 v167, 0xffff0000, v155
    v_add_f32 v35, v35, v166
    v_add_f32 v39, v39, v167
    v_add_u32 v188, 147456, v184
    ds_write_b128 v188, v[24:27] offset:0
    ds_write_b128 v188, v[28:31] offset:1024
    ds_write_b128 v188, v[32:35] offset:2048
    ds_write_b128 v188, v[36:39] offset:3072
    s_waitcnt lgkmcnt(0)
    s_barrier
    s_endpgm
g2_cons:
    s_bfe_u32 s27, s2, 0x20001
    s_and_b32 s28, s2, 1
    s_lshr_b32 s3, s2, 3
    s_lshl_b32 s25, s28, 1
    s_add_u32 s3, s3, s25
    s_and_b32 s29, s3, 3
    s_bfe_u32 s3, s3, 0x30002
    s_lshl_b32 s28, s28, 3
    s_add_u32 s28, s28, s3
    v_lshrrev_b32 v6, 4, v1
    v_and_b32 v7, 15, v1
    v_mul_u32_u24 v76, 2304, v6
    v_lshl_add_u32 v76, v7, 4, v76
    v_add_u32 v77, 55296, v76
    v_lshrrev_b32 v6, 2, v1
    v_and_b32 v7, 7, v6
    v_lshlrev_b32 v6, 8, v6
    v_and_b32 v8, 3, v1
    v_lshl_add_u32 v6, v8, 3, v6
    v_add_u32 v6, 73728, v6
    v_xor_b32 v7, s10, v7
    v_lshl_add_u32 v4, v7, 5, v6
    v_xor_b32 v7, 4, v7
    v_lshl_add_u32 v5, v7, 5, v6
    s_add_u32 s4, s98, 31850496
    s_addc_u32 s5, s99, 0
    s_mov_b32 s6, 83968
    s_mov_b32 s7, 0x20000
    s_waitcnt vmcnt(0) lgkmcnt(0)
    s_barrier
    s_cmp_lg_u32 s10, 1
    s_cbranch_scc1 g2_c
    s_cmp_eq_u32 s23, 0
    s_cbranch_scc1 g2_c
    v_mov_b32 v168, s23
    v_mov_b32 v169, 1
    s_mov_b64 exec, 1
    buffer_atomic_add v169, v168, s[4:7], 0 offen sc1
    s_mov_b64 exec, -1
g2_c:
    s_barrier
    v_mov_b32 v2, v76
    v_mov_b32 v3, v77
    s_cmp_lg_u32 s10, 0
    s_cbranch_scc1 g2_na
    s_and_b32 s22, s2, 15
    s_lshl_b32 s22, s22, 7
    s_add_u32 s22, s22, 32768
    v_mov_b32 v168, s22
    v_mov_b32 v169, 1
    s_mov_b64 exec, 1
    buffer_atomic_add v169, v168, s[4:7], 0 offen sc1
    s_mov_b64 exec, -1
g2_na:
    v_mov_b64 v[8:9], 0
    v_mov_b64 v[10:11], 0
    v_mov_b64 v[12:13], 0
    v_mov_b64 v[14:15], 0
    v_mov_b64 v[16:17], 0
    v_mov_b64 v[18:19], 0
    v_mov_b64 v[20:21], 0
    v_mov_b64 v[22:23], 0
    v_mov_b64 v[24:25], 0
    v_mov_b64 v[26:27], 0
    v_mov_b64 v[28:29], 0
    v_mov_b64 v[30:31], 0
    v_mov_b64 v[32:33], 0
    v_mov_b64 v[34:35], 0
    v_mov_b64 v[36:37], 0
    v_mov_b64 v[38:39], 0
    v_mov_b64 v[40:41], 0
    v_mov_b64 v[42:43], 0
    v_mov_b64 v[44:45], 0
    v_mov_b64 v[46:47], 0
    v_mov_b64 v[48:49], 0
    v_mov_b64 v[50:51], 0
    v_mov_b64 v[52:53], 0
    v_mov_b64 v[54:55], 0
    v_mov_b64 v[56:57], 0
    v_mov_b64 v[58:59], 0
    v_mov_b64 v[60:61], 0
    v_mov_b64 v[62:63], 0
    v_mov_b64 v[64:65], 0
    v_mov_b64 v[66:67], 0
    v_mov_b64 v[68:69], 0
    v_mov_b64 v[70:71], 0
    v_mov_b64 v[72:73], 0
    v_mov_b64 v[74:75], 0
    v_mov_b64 v[76:77], 0
    v_mov_b64 v[78:79], 0
    s_lshl_b32 s33, s28, 2
    s_add_u32 s33, s33, s29
    s_lshl_b32 s33, s33, 2
    s_add_u32 s12, s98, 17104896
    s_addc_u32 s13, s99, 0
    s_mov_b32 s14, 9437184
    s_mov_b32 s15, 0x20000
    s_add_u32 s52, s98, 9437184
    s_addc_u32 s53, s99, 0
    s_mov_b32 s54, 2359296
    s_mov_b32 s55, 0x20000
    s_mov_b32 s36, s92
    s_mov_b32 s37, s93
    s_mov_b32 s38, 4096
    s_mov_b32 s39, 0x20000
    s_mov_b32 s40, s94
    s_mov_b32 s41, s95
    s_mov_b32 s42, 2359296
    s_mov_b32 s43, 0x20000
    v_lshlrev_b32 v184, 4, v1
    v_lshrrev_b32 v189, 4, v1
    v_and_b32 v190, 15, v1
    s_lshl_b32 s3, s27, 4
    v_add_u32 v190, s3, v190
    s_lshl_b32 s3, s28, 7
    v_add_u32 v186, s3, v190
    v_lshlrev_b32 v187, 1, v186
    v_mul_u32_u24 v185, 1152, v186
    s_mul_i32 s30, s29, 144
    s_lshl_b32 s3, s10, 5
    s_add_u32 s30, s30, s3
    s_mov_b32 s44, 73728
    v_lshlrev_b32 v189, 3, v189
    v_add_u32 v189, s30, v189
    v_lshl_add_u32 v185, v189, 1, v185
    v_lshlrev_b32 v186, 12, v189
    v_lshl_add_u32 v186, v190, 2, v186
    s_lshl_b32 s3, s28, 8
    v_add_u32 v186, s3, v186
    s_add_u32 s23, s33, s27
    s_mul_i32 s31, s23, 36864
    s_lshl_b32 s34, s10, 11
    s_add_u32 s31, s31, s34
    s_lshl_b32 s23, s23, 7
    s_lshl_b32 s34, s10, 12
    v_add_u32 v188, s34, v184
    s_add_u32 s3, s27, 1
    s_and_b32 s3, s3, 3
    s_mul_i32 s3, s3, 9216
    s_add_u32 s45, s3, s31
    s_add_u32 s3, s27, 2
    s_and_b32 s3, s3, 3
    s_mul_i32 s3, s3, 9216
    s_add_u32 s46, s3, s31
    s_add_u32 s3, s27, 3
    s_and_b32 s3, s3, 3
    s_mul_i32 s3, s3, 9216
    s_add_u32 s47, s3, s31
    s_add_u32 s49, s33, s10
    s_lshl_b32 s48, s49, 2
    s_add_u32 s48, s48, s27
    s_mul_i32 s48, s48, 9216
    s_lshl_b32 s49, s49, 7
    s_waitcnt lgkmcnt(0)
    s_mov_b32 s26, 0
    s_barrier
    ds_read_b64_tr_b16 v[80:81], v4 offset:0
    ds_read_b64_tr_b16 v[82:83], v4 offset:4096
    ds_read_b64_tr_b16 v[84:85], v5 offset:0
    ds_read_b64_tr_b16 v[86:87], v5 offset:4096
    ds_read_b128 v[88:91], v2 offset:0
    ds_read_b128 v[92:95], v2 offset:256
    ds_read_b128 v[96:99], v2 offset:512
    ds_read_b128 v[100:103], v2 offset:768
    ds_read_b128 v[104:107], v2 offset:1024
    ds_read_b128 v[108:111], v2 offset:1280
    ds_read_b128 v[112:115], v2 offset:1536
    ds_read_b128 v[116:119], v2 offset:1792
    ds_read_b128 v[120:123], v2 offset:2048
    s_waitcnt lgkmcnt(0)
    s_branch g2c_mid
.p2align 6
g2c_loop:
    s_barrier
    s_waitcnt lgkmcnt(1)
    v_mfma_f32_16x16x32_bf16 v[8:11], v[132:135], v[124:127], v[8:11]
    ds_read_b64_tr_b16 v[80:81], v4 offset:0
    v_mfma_f32_16x16x32_bf16 v[12:15], v[132:135], v[128:131], v[12:15]
    ds_read_b64_tr_b16 v[82:83], v4 offset:4096
    v_mfma_f32_16x16x32_bf16 v[16:19], v[136:139], v[124:127], v[16:19]
    ds_read_b64_tr_b16 v[84:85], v5 offset:0
    v_mfma_f32_16x16x32_bf16 v[20:23], v[136:139], v[128:131], v[20:23]
    ds_read_b64_tr_b16 v[86:87], v5 offset:4096
    v_mfma_f32_16x16x32_bf16 v[24:27], v[140:143], v[124:127], v[24:27]
    ds_read_b128 v[88:91], v2 offset:0
    v_mfma_f32_16x16x32_bf16 v[28:31], v[140:143], v[128:131], v[28:31]
    ds_read_b128 v[92:95], v2 offset:256
    v_mfma_f32_16x16x32_bf16 v[32:35], v[144:147], v[124:127], v[32:35]
    ds_read_b128 v[96:99], v2 offset:512
    v_mfma_f32_16x16x32_bf16 v[36:39], v[144:147], v[128:131], v[36:39]
    ds_read_b128 v[100:103], v2 offset:768
    v_mfma_f32_16x16x32_bf16 v[40:43], v[148:151], v[124:127], v[40:43]
    ds_read_b128 v[104:107], v2 offset:1024
    v_mfma_f32_16x16x32_bf16 v[44:47], v[148:151], v[128:131], v[44:47]
    ds_read_b128 v[108:111], v2 offset:1280
    v_mfma_f32_16x16x32_bf16 v[48:51], v[152:155], v[124:127], v[48:51]
    ds_read_b128 v[112:115], v2 offset:1536
    v_mfma_f32_16x16x32_bf16 v[52:55], v[152:155], v[128:131], v[52:55]
    ds_read_b128 v[116:119], v2 offset:1792
    v_mfma_f32_16x16x32_bf16 v[56:59], v[156:159], v[124:127], v[56:59]
    ds_read_b128 v[120:123], v2 offset:2048
    v_mfma_f32_16x16x32_bf16 v[60:63], v[156:159], v[128:131], v[60:63]
    v_mfma_f32_16x16x32_bf16 v[64:67], v[160:163], v[124:127], v[64:67]
    v_mfma_f32_16x16x32_bf16 v[68:71], v[160:163], v[128:131], v[68:71]
    s_waitcnt lgkmcnt(3)
    v_mfma_f32_16x16x32_bf16 v[72:75], v[164:167], v[124:127], v[72:75]
    v_mfma_f32_16x16x32_bf16 v[76:79], v[164:167], v[128:131], v[76:79]
g2c_mid:
    v_mfma_f32_16x16x32_bf16 v[8:11], v[88:91], v[80:83], v[8:11]
    ds_read_b64_tr_b16 v[124:125], v4 offset:8192
    v_mfma_f32_16x16x32_bf16 v[12:15], v[88:91], v[84:87], v[12:15]
    ds_read_b64_tr_b16 v[126:127], v4 offset:12288
    v_mfma_f32_16x16x32_bf16 v[16:19], v[92:95], v[80:83], v[16:19]
    ds_read_b64_tr_b16 v[128:129], v5 offset:8192
    v_mfma_f32_16x16x32_bf16 v[20:23], v[92:95], v[84:87], v[20:23]
    ds_read_b64_tr_b16 v[130:131], v5 offset:12288
    v_mfma_f32_16x16x32_bf16 v[24:27], v[96:99], v[80:83], v[24:27]
    ds_read_b128 v[132:135], v2 offset:9216
    v_mfma_f32_16x16x32_bf16 v[28:31], v[96:99], v[84:87], v[28:31]
    ds_read_b128 v[136:139], v2 offset:9472
    v_mfma_f32_16x16x32_bf16 v[32:35], v[100:103], v[80:83], v[32:35]
    ds_read_b128 v[140:143], v2 offset:9728
    v_mfma_f32_16x16x32_bf16 v[36:39], v[100:103], v[84:87], v[36:39]
    ds_read_b128 v[144:147], v2 offset:9984
    v_mfma_f32_16x16x32_bf16 v[40:43], v[104:107], v[80:83], v[40:43]
    ds_read_b128 v[148:151], v2 offset:10240
    v_mfma_f32_16x16x32_bf16 v[44:47], v[104:107], v[84:87], v[44:47]
    ds_read_b128 v[152:155], v2 offset:10496
    v_mfma_f32_16x16x32_bf16 v[48:51], v[108:111], v[80:83], v[48:51]
    ds_read_b128 v[156:159], v2 offset:10752
    v_mfma_f32_16x16x32_bf16 v[52:55], v[108:111], v[84:87], v[52:55]
    ds_read_b128 v[160:163], v2 offset:11008
    s_waitcnt lgkmcnt(6)
    v_mfma_f32_16x16x32_bf16 v[56:59], v[112:115], v[80:83], v[56:59]
    ds_read_b128 v[164:167], v2 offset:11264
    v_mfma_f32_16x16x32_bf16 v[60:63], v[112:115], v[84:87], v[60:63]
    v_mfma_f32_16x16x32_bf16 v[64:67], v[116:119], v[80:83], v[64:67]
    v_mfma_f32_16x16x32_bf16 v[68:71], v[116:119], v[84:87], v[68:71]
    v_mfma_f32_16x16x32_bf16 v[72:75], v[120:123], v[80:83], v[72:75]
    v_mfma_f32_16x16x32_bf16 v[76:79], v[120:123], v[84:87], v[76:79]
    s_barrier
    s_waitcnt lgkmcnt(1)
    v_mfma_f32_16x16x32_bf16 v[8:11], v[132:135], v[124:127], v[8:11]
    ds_read_b64_tr_b16 v[80:81], v4 offset:16384
    v_mfma_f32_16x16x32_bf16 v[12:15], v[132:135], v[128:131], v[12:15]
    ds_read_b64_tr_b16 v[82:83], v4 offset:20480
    v_mfma_f32_16x16x32_bf16 v[16:19], v[136:139], v[124:127], v[16:19]
    ds_read_b64_tr_b16 v[84:85], v5 offset:16384
    v_mfma_f32_16x16x32_bf16 v[20:23], v[136:139], v[128:131], v[20:23]
    ds_read_b64_tr_b16 v[86:87], v5 offset:20480
    v_mfma_f32_16x16x32_bf16 v[24:27], v[140:143], v[124:127], v[24:27]
    ds_read_b128 v[88:91], v2 offset:18432
    v_mfma_f32_16x16x32_bf16 v[28:31], v[140:143], v[128:131], v[28:31]
    ds_read_b128 v[92:95], v2 offset:18688
    v_mfma_f32_16x16x32_bf16 v[32:35], v[144:147], v[124:127], v[32:35]
    ds_read_b128 v[96:99], v2 offset:18944
    v_mfma_f32_16x16x32_bf16 v[36:39], v[144:147], v[128:131], v[36:39]
    ds_read_b128 v[100:103], v2 offset:19200
    v_mfma_f32_16x16x32_bf16 v[40:43], v[148:151], v[124:127], v[40:43]
    ds_read_b128 v[104:107], v2 offset:19456
    v_mfma_f32_16x16x32_bf16 v[44:47], v[148:151], v[128:131], v[44:47]
    ds_read_b128 v[108:111], v2 offset:19712
    v_mfma_f32_16x16x32_bf16 v[48:51], v[152:155], v[124:127], v[48:51]
    ds_read_b128 v[112:115], v2 offset:19968
    v_mfma_f32_16x16x32_bf16 v[52:55], v[152:155], v[128:131], v[52:55]
    ds_read_b128 v[116:119], v2 offset:20224
    v_mfma_f32_16x16x32_bf16 v[56:59], v[156:159], v[124:127], v[56:59]
    ds_read_b128 v[120:123], v2 offset:20480
    v_mfma_f32_16x16x32_bf16 v[60:63], v[156:159], v[128:131], v[60:63]
    v_mfma_f32_16x16x32_bf16 v[64:67], v[160:163], v[124:127], v[64:67]
    v_mfma_f32_16x16x32_bf16 v[68:71], v[160:163], v[128:131], v[68:71]
    s_waitcnt lgkmcnt(3)
    v_mfma_f32_16x16x32_bf16 v[72:75], v[164:167], v[124:127], v[72:75]
    v_mfma_f32_16x16x32_bf16 v[76:79], v[164:167], v[128:131], v[76:79]
    v_mfma_f32_16x16x32_bf16 v[8:11], v[88:91], v[80:83], v[8:11]
    ds_read_b64_tr_b16 v[124:125], v4 offset:24576
    v_mfma_f32_16x16x32_bf16 v[12:15], v[88:91], v[84:87], v[12:15]
    ds_read_b64_tr_b16 v[126:127], v4 offset:28672
    v_mfma_f32_16x16x32_bf16 v[16:19], v[92:95], v[80:83], v[16:19]
    ds_read_b64_tr_b16 v[128:129], v5 offset:24576
    v_mfma_f32_16x16x32_bf16 v[20:23], v[92:95], v[84:87], v[20:23]
    ds_read_b64_tr_b16 v[130:131], v5 offset:28672
    v_mfma_f32_16x16x32_bf16 v[24:27], v[96:99], v[80:83], v[24:27]
    ds_read_b128 v[132:135], v2 offset:27648
    v_mfma_f32_16x16x32_bf16 v[28:31], v[96:99], v[84:87], v[28:31]
    ds_read_b128 v[136:139], v2 offset:27904
    v_mfma_f32_16x16x32_bf16 v[32:35], v[100:103], v[80:83], v[32:35]
    ds_read_b128 v[140:143], v2 offset:28160
    v_mfma_f32_16x16x32_bf16 v[36:39], v[100:103], v[84:87], v[36:39]
    ds_read_b128 v[144:147], v2 offset:28416
    v_mfma_f32_16x16x32_bf16 v[40:43], v[104:107], v[80:83], v[40:43]
    ds_read_b128 v[148:151], v2 offset:28672
    v_mfma_f32_16x16x32_bf16 v[44:47], v[104:107], v[84:87], v[44:47]
    ds_read_b128 v[152:155], v2 offset:28928
    v_mfma_f32_16x16x32_bf16 v[48:51], v[108:111], v[80:83], v[48:51]
    ds_read_b128 v[156:159], v2 offset:29184
    v_mfma_f32_16x16x32_bf16 v[52:55], v[108:111], v[84:87], v[52:55]
    ds_read_b128 v[160:163], v2 offset:29440
    s_waitcnt lgkmcnt(6)
    v_mfma_f32_16x16x32_bf16 v[56:59], v[112:115], v[80:83], v[56:59]
    ds_read_b128 v[164:167], v2 offset:29696
    v_mfma_f32_16x16x32_bf16 v[60:63], v[112:115], v[84:87], v[60:63]
    v_mfma_f32_16x16x32_bf16 v[64:67], v[116:119], v[80:83], v[64:67]
    v_mfma_f32_16x16x32_bf16 v[68:71], v[116:119], v[84:87], v[68:71]
    v_mfma_f32_16x16x32_bf16 v[72:75], v[120:123], v[80:83], v[72:75]
    v_mfma_f32_16x16x32_bf16 v[76:79], v[120:123], v[84:87], v[76:79]
    s_add_u32 s26, s26, 1
    s_cmp_eq_u32 s26, 5
    s_cbranch_scc1 g2c_done
    s_barrier
    s_waitcnt lgkmcnt(1)
    v_mfma_f32_16x16x32_bf16 v[8:11], v[132:135], v[124:127], v[8:11]
    ds_read_b64_tr_b16 v[80:81], v4 offset:32768
    v_mfma_f32_16x16x32_bf16 v[12:15], v[132:135], v[128:131], v[12:15]
    ds_read_b64_tr_b16 v[82:83], v4 offset:36864
    v_mfma_f32_16x16x32_bf16 v[16:19], v[136:139], v[124:127], v[16:19]
    ds_read_b64_tr_b16 v[84:85], v5 offset:32768
    v_mfma_f32_16x16x32_bf16 v[20:23], v[136:139], v[128:131], v[20:23]
    ds_read_b64_tr_b16 v[86:87], v5 offset:36864
    v_mfma_f32_16x16x32_bf16 v[24:27], v[140:143], v[124:127], v[24:27]
    ds_read_b128 v[88:91], v2 offset:36864
    v_mfma_f32_16x16x32_bf16 v[28:31], v[140:143], v[128:131], v[28:31]
    ds_read_b128 v[92:95], v2 offset:37120
    v_mfma_f32_16x16x32_bf16 v[32:35], v[144:147], v[124:127], v[32:35]
    ds_read_b128 v[96:99], v2 offset:37376
    v_mfma_f32_16x16x32_bf16 v[36:39], v[144:147], v[128:131], v[36:39]
    ds_read_b128 v[100:103], v2 offset:37632
    v_mfma_f32_16x16x32_bf16 v[40:43], v[148:151], v[124:127], v[40:43]
    ds_read_b128 v[104:107], v2 offset:37888
    v_mfma_f32_16x16x32_bf16 v[44:47], v[148:151], v[128:131], v[44:47]
    ds_read_b128 v[108:111], v2 offset:38144
    v_mfma_f32_16x16x32_bf16 v[48:51], v[152:155], v[124:127], v[48:51]
    ds_read_b128 v[112:115], v2 offset:38400
    v_mfma_f32_16x16x32_bf16 v[52:55], v[152:155], v[128:131], v[52:55]
    ds_read_b128 v[116:119], v2 offset:38656
    v_mfma_f32_16x16x32_bf16 v[56:59], v[156:159], v[124:127], v[56:59]
    ds_read_b128 v[120:123], v2 offset:38912
    v_mfma_f32_16x16x32_bf16 v[60:63], v[156:159], v[128:131], v[60:63]
    v_mfma_f32_16x16x32_bf16 v[64:67], v[160:163], v[124:127], v[64:67]
    v_mfma_f32_16x16x32_bf16 v[68:71], v[160:163], v[128:131], v[68:71]
    s_waitcnt lgkmcnt(3)
    v_mfma_f32_16x16x32_bf16 v[72:75], v[164:167], v[124:127], v[72:75]
    v_mfma_f32_16x16x32_bf16 v[76:79], v[164:167], v[128:131], v[76:79]
    v_mfma_f32_16x16x32_bf16 v[8:11], v[88:91], v[80:83], v[8:11]
    ds_read_b64_tr_b16 v[124:125], v4 offset:40960
    v_mfma_f32_16x16x32_bf16 v[12:15], v[88:91], v[84:87], v[12:15]
    ds_read_b64_tr_b16 v[126:127], v4 offset:45056
    v_mfma_f32_16x16x32_bf16 v[16:19], v[92:95], v[80:83], v[16:19]
    ds_read_b64_tr_b16 v[128:129], v5 offset:40960
    v_mfma_f32_16x16x32_bf16 v[20:23], v[92:95], v[84:87], v[20:23]
    ds_read_b64_tr_b16 v[130:131], v5 offset:45056
    v_mfma_f32_16x16x32_bf16 v[24:27], v[96:99], v[80:83], v[24:27]
    ds_read_b128 v[132:135], v2 offset:46080
    v_mfma_f32_16x16x32_bf16 v[28:31], v[96:99], v[84:87], v[28:31]
    ds_read_b128 v[136:139], v2 offset:46336
    v_mfma_f32_16x16x32_bf16 v[32:35], v[100:103], v[80:83], v[32:35]
    ds_read_b128 v[140:143], v2 offset:46592
    v_mfma_f32_16x16x32_bf16 v[36:39], v[100:103], v[84:87], v[36:39]
    ds_read_b128 v[144:147], v2 offset:46848
    v_mfma_f32_16x16x32_bf16 v[40:43], v[104:107], v[80:83], v[40:43]
    ds_read_b128 v[148:151], v2 offset:47104
    v_mfma_f32_16x16x32_bf16 v[44:47], v[104:107], v[84:87], v[44:47]
    ds_read_b128 v[152:155], v2 offset:47360
    v_mfma_f32_16x16x32_bf16 v[48:51], v[108:111], v[80:83], v[48:51]
    ds_read_b128 v[156:159], v2 offset:47616
    v_mfma_f32_16x16x32_bf16 v[52:55], v[108:111], v[84:87], v[52:55]
    ds_read_b128 v[160:163], v2 offset:47872
    s_waitcnt lgkmcnt(6)
    v_mfma_f32_16x16x32_bf16 v[56:59], v[112:115], v[80:83], v[56:59]
    ds_read_b128 v[164:167], v2 offset:48128
    v_mfma_f32_16x16x32_bf16 v[60:63], v[112:115], v[84:87], v[60:63]
    v_mfma_f32_16x16x32_bf16 v[64:67], v[116:119], v[80:83], v[64:67]
    v_mfma_f32_16x16x32_bf16 v[68:71], v[116:119], v[84:87], v[68:71]
    v_mfma_f32_16x16x32_bf16 v[72:75], v[120:123], v[80:83], v[72:75]
    v_mfma_f32_16x16x32_bf16 v[76:79], v[120:123], v[84:87], v[76:79]
    s_barrier
    s_waitcnt lgkmcnt(1)
    v_mfma_f32_16x16x32_bf16 v[8:11], v[132:135], v[124:127], v[8:11]
    ds_read_b64_tr_b16 v[80:81], v4 offset:49152
    v_mfma_f32_16x16x32_bf16 v[12:15], v[132:135], v[128:131], v[12:15]
    ds_read_b64_tr_b16 v[82:83], v4 offset:53248
    v_mfma_f32_16x16x32_bf16 v[16:19], v[136:139], v[124:127], v[16:19]
    ds_read_b64_tr_b16 v[84:85], v5 offset:49152
    v_mfma_f32_16x16x32_bf16 v[20:23], v[136:139], v[128:131], v[20:23]
    ds_read_b64_tr_b16 v[86:87], v5 offset:53248
    v_mfma_f32_16x16x32_bf16 v[24:27], v[140:143], v[124:127], v[24:27]
    ds_read_b128 v[88:91], v3 offset:0
    v_mfma_f32_16x16x32_bf16 v[28:31], v[140:143], v[128:131], v[28:31]
    ds_read_b128 v[92:95], v3 offset:256
    v_mfma_f32_16x16x32_bf16 v[32:35], v[144:147], v[124:127], v[32:35]
    ds_read_b128 v[96:99], v3 offset:512
    v_mfma_f32_16x16x32_bf16 v[36:39], v[144:147], v[128:131], v[36:39]
    ds_read_b128 v[100:103], v3 offset:768
    v_mfma_f32_16x16x32_bf16 v[40:43], v[148:151], v[124:127], v[40:43]
    ds_read_b128 v[104:107], v3 offset:1024
    v_mfma_f32_16x16x32_bf16 v[44:47], v[148:151], v[128:131], v[44:47]
    ds_read_b128 v[108:111], v3 offset:1280
    v_mfma_f32_16x16x32_bf16 v[48:51], v[152:155], v[124:127], v[48:51]
    ds_read_b128 v[112:115], v3 offset:1536
    v_mfma_f32_16x16x32_bf16 v[52:55], v[152:155], v[128:131], v[52:55]
    ds_read_b128 v[116:119], v3 offset:1792
    v_mfma_f32_16x16x32_bf16 v[56:59], v[156:159], v[124:127], v[56:59]
    ds_read_b128 v[120:123], v3 offset:2048
    v_mfma_f32_16x16x32_bf16 v[60:63], v[156:159], v[128:131], v[60:63]
    v_mfma_f32_16x16x32_bf16 v[64:67], v[160:163], v[124:127], v[64:67]
    v_mfma_f32_16x16x32_bf16 v[68:71], v[160:163], v[128:131], v[68:71]
    s_waitcnt lgkmcnt(3)
    v_mfma_f32_16x16x32_bf16 v[72:75], v[164:167], v[124:127], v[72:75]
    v_mfma_f32_16x16x32_bf16 v[76:79], v[164:167], v[128:131], v[76:79]
    v_mfma_f32_16x16x32_bf16 v[8:11], v[88:91], v[80:83], v[8:11]
    ds_read_b64_tr_b16 v[124:125], v4 offset:57344
    v_mfma_f32_16x16x32_bf16 v[12:15], v[88:91], v[84:87], v[12:15]
    ds_read_b64_tr_b16 v[126:127], v4 offset:61440
    v_mfma_f32_16x16x32_bf16 v[16:19], v[92:95], v[80:83], v[16:19]
    ds_read_b64_tr_b16 v[128:129], v5 offset:57344
    v_mfma_f32_16x16x32_bf16 v[20:23], v[92:95], v[84:87], v[20:23]
    ds_read_b64_tr_b16 v[130:131], v5 offset:61440
    v_mfma_f32_16x16x32_bf16 v[24:27], v[96:99], v[80:83], v[24:27]
    ds_read_b128 v[132:135], v3 offset:9216
    v_mfma_f32_16x16x32_bf16 v[28:31], v[96:99], v[84:87], v[28:31]
    ds_read_b128 v[136:139], v3 offset:9472
    v_mfma_f32_16x16x32_bf16 v[32:35], v[100:103], v[80:83], v[32:35]
    ds_read_b128 v[140:143], v3 offset:9728
    v_mfma_f32_16x16x32_bf16 v[36:39], v[100:103], v[84:87], v[36:39]
    ds_read_b128 v[144:147], v3 offset:9984
    v_mfma_f32_16x16x32_bf16 v[40:43], v[104:107], v[80:83], v[40:43]
    ds_read_b128 v[148:151], v3 offset:10240
    v_mfma_f32_16x16x32_bf16 v[44:47], v[104:107], v[84:87], v[44:47]
    ds_read_b128 v[152:155], v3 offset:10496
    v_mfma_f32_16x16x32_bf16 v[48:51], v[108:111], v[80:83], v[48:51]
    ds_read_b128 v[156:159], v3 offset:10752
    v_mfma_f32_16x16x32_bf16 v[52:55], v[108:111], v[84:87], v[52:55]
    ds_read_b128 v[160:163], v3 offset:11008
    s_waitcnt lgkmcnt(6)
    v_mfma_f32_16x16x32_bf16 v[56:59], v[112:115], v[80:83], v[56:59]
    ds_read_b128 v[164:167], v3 offset:11264
    v_mfma_f32_16x16x32_bf16 v[60:63], v[112:115], v[84:87], v[60:63]
    v_mfma_f32_16x16x32_bf16 v[64:67], v[116:119], v[80:83], v[64:67]
    v_mfma_f32_16x16x32_bf16 v[68:71], v[116:119], v[84:87], v[68:71]
    v_mfma_f32_16x16x32_bf16 v[72:75], v[120:123], v[80:83], v[72:75]
    v_mfma_f32_16x16x32_bf16 v[76:79], v[120:123], v[84:87], v[76:79]
    s_branch g2c_loop
g2c_done:
    s_cmp_eq_u32 s10, s27
    s_cbranch_scc1 g2_own
    s_waitcnt lgkmcnt(1)
    v_mfma_f32_16x16x32_bf16 v[8:11], v[132:135], v[124:127], v[8:11]
    v_mfma_f32_16x16x32_bf16 v[12:15], v[132:135], v[128:131], v[12:15]
    v_mfma_f32_16x16x32_bf16 v[16:19], v[136:139], v[124:127], v[16:19]
    v_mfma_f32_16x16x32_bf16 v[20:23], v[136:139], v[128:131], v[20:23]
    v_mfma_f32_16x16x32_bf16 v[24:27], v[140:143], v[124:127], v[24:27]
    v_mfma_f32_16x16x32_bf16 v[28:31], v[140:143], v[128:131], v[28:31]
    v_mfma_f32_16x16x32_bf16 v[32:35], v[144:147], v[124:127], v[32:35]
    v_mfma_f32_16x16x32_bf16 v[36:39], v[144:147], v[128:131], v[36:39]
    s_nop 0
    v_cvt_pk_bf16_f32 v80, v8, v9
    v_cvt_pk_bf16_f32 v81, v10, v11
    v_cvt_pk_bf16_f32 v82, v12, v13
    v_cvt_pk_bf16_f32 v83, v14, v15
    buffer_store_dwordx4 v[80:83], v184, s[12:15], s48 offen offset:0 sc1
    v_mfma_f32_16x16x32_bf16 v[40:43], v[148:151], v[124:127], v[40:43]
    v_mfma_f32_16x16x32_bf16 v[44:47], v[148:151], v[128:131], v[44:47]
    v_cvt_pk_bf16_f32 v84, v16, v17
    v_cvt_pk_bf16_f32 v85, v18, v19
    v_cvt_pk_bf16_f32 v86, v20, v21
    v_cvt_pk_bf16_f32 v87, v22, v23
    buffer_store_dwordx4 v[84:87], v184, s[12:15], s48 offen offset:1024 sc1
    v_mfma_f32_16x16x32_bf16 v[48:51], v[152:155], v[124:127], v[48:51]
    v_mfma_f32_16x16x32_bf16 v[52:55], v[152:155], v[128:131], v[52:55]
    v_cvt_pk_bf16_f32 v88, v24, v25
    v_cvt_pk_bf16_f32 v89, v26, v27
    v_cvt_pk_bf16_f32 v90, v28, v29
    v_cvt_pk_bf16_f32 v91, v30, v31
    buffer_store_dwordx4 v[88:91], v184, s[12:15], s48 offen offset:2048 sc1
    v_mfma_f32_16x16x32_bf16 v[56:59], v[156:159], v[124:127], v[56:59]
    v_mfma_f32_16x16x32_bf16 v[60:63], v[156:159], v[128:131], v[60:63]
    v_cvt_pk_bf16_f32 v92, v32, v33
    v_cvt_pk_bf16_f32 v93, v34, v35
    v_cvt_pk_bf16_f32 v94, v36, v37
    v_cvt_pk_bf16_f32 v95, v38, v39
    buffer_store_dwordx4 v[92:95], v184, s[12:15], s48 offen offset:3072 sc1
    v_mfma_f32_16x16x32_bf16 v[64:67], v[160:163], v[124:127], v[64:67]
    v_mfma_f32_16x16x32_bf16 v[68:71], v[160:163], v[128:131], v[68:71]
    v_cvt_pk_bf16_f32 v96, v40, v41
    v_cvt_pk_bf16_f32 v97, v42, v43
    v_cvt_pk_bf16_f32 v98, v44, v45
    v_cvt_pk_bf16_f32 v99, v46, v47
    s_add_u32 s48, s48, 4096
    buffer_store_dwordx4 v[96:99], v184, s[12:15], s48 offen offset:0 sc1
    s_waitcnt lgkmcnt(0)
    v_mfma_f32_16x16x32_bf16 v[72:75], v[164:167], v[124:127], v[72:75]
    v_mfma_f32_16x16x32_bf16 v[76:79], v[164:167], v[128:131], v[76:79]
    v_cvt_pk_bf16_f32 v100, v48, v49
    v_cvt_pk_bf16_f32 v101, v50, v51
    v_cvt_pk_bf16_f32 v102, v52, v53
    v_cvt_pk_bf16_f32 v103, v54, v55
    buffer_store_dwordx4 v[100:103], v184, s[12:15], s48 offen offset:1024 sc1
    v_cvt_pk_bf16_f32 v104, v56, v57
    v_cvt_pk_bf16_f32 v105, v58, v59
    v_cvt_pk_bf16_f32 v106, v60, v61
    v_cvt_pk_bf16_f32 v107, v62, v63
    buffer_store_dwordx4 v[104:107], v184, s[12:15], s48 offen offset:2048 sc1
    v_cvt_pk_bf16_f32 v108, v64, v65
    v_cvt_pk_bf16_f32 v109, v66, v67
    v_cvt_pk_bf16_f32 v110, v68, v69
    v_cvt_pk_bf16_f32 v111, v70, v71
    buffer_store_dwordx4 v[108:111], v184, s[12:15], s48 offen offset:3072 sc1
    v_cvt_pk_bf16_f32 v112, v72, v73
    v_cvt_pk_bf16_f32 v113, v74, v75
    v_cvt_pk_bf16_f32 v114, v76, v77
    v_cvt_pk_bf16_f32 v115, v78, v79
    s_add_u32 s48, s48, 4096
    buffer_store_dwordx4 v[112:115], v184, s[12:15], s48 offen offset:0 sc1
    s_branch g2_sent
g2_own:
    s_waitcnt lgkmcnt(1)
    v_mfma_f32_16x16x32_bf16 v[8:11], v[132:135], v[124:127], v[8:11]
    v_mfma_f32_16x16x32_bf16 v[12:15], v[132:135], v[128:131], v[12:15]
    v_mfma_f32_16x16x32_bf16 v[16:19], v[136:139], v[124:127], v[16:19]
    v_mfma_f32_16x16x32_bf16 v[20:23], v[136:139], v[128:131], v[20:23]
    v_mfma_f32_16x16x32_bf16 v[24:27], v[140:143], v[124:127], v[24:27]
    v_mfma_f32_16x16x32_bf16 v[28:31], v[140:143], v[128:131], v[28:31]
    v_mfma_f32_16x16x32_bf16 v[32:35], v[144:147], v[124:127], v[32:35]
    v_mfma_f32_16x16x32_bf16 v[36:39], v[144:147], v[128:131], v[36:39]
    v_mfma_f32_16x16x32_bf16 v[40:43], v[148:151], v[124:127], v[40:43]
    v_mfma_f32_16x16x32_bf16 v[44:47], v[148:151], v[128:131], v[44:47]
    v_mfma_f32_16x16x32_bf16 v[48:51], v[152:155], v[124:127], v[48:51]
    v_mfma_f32_16x16x32_bf16 v[52:55], v[152:155], v[128:131], v[52:55]
    v_mfma_f32_16x16x32_bf16 v[56:59], v[156:159], v[124:127], v[56:59]
    v_mfma_f32_16x16x32_bf16 v[60:63], v[156:159], v[128:131], v[60:63]
    v_mfma_f32_16x16x32_bf16 v[64:67], v[160:163], v[124:127], v[64:67]
    v_mfma_f32_16x16x32_bf16 v[68:71], v[160:163], v[128:131], v[68:71]
    s_waitcnt lgkmcnt(0)
    v_mfma_f32_16x16x32_bf16 v[72:75], v[164:167], v[124:127], v[72:75]
    v_mfma_f32_16x16x32_bf16 v[76:79], v[164:167], v[128:131], v[76:79]
    ds_write_b128 v184, v[8:11] offset:36864
    ds_write_b128 v184, v[12:15] offset:37888
    ds_write_b128 v184, v[16:19] offset:38912
    ds_write_b128 v184, v[20:23] offset:39936
    ds_write_b128 v184, v[24:27] offset:40960
    ds_write_b128 v184, v[28:31] offset:41984
    ds_write_b128 v184, v[32:35] offset:43008
    ds_write_b128 v184, v[36:39] offset:44032
    ds_write_b128 v184, v[40:43] offset:45056
    ds_write_b128 v184, v[44:47] offset:46080
    ds_write_b128 v184, v[48:51] offset:47104
    ds_write_b128 v184, v[52:55] offset:48128
    ds_write_b128 v184, v[56:59] offset:49152
    ds_write_b128 v184, v[60:63] offset:50176
    ds_write_b128 v184, v[64:67] offset:51200
    ds_write_b128 v184, v[68:71] offset:52224
    ds_write_b128 v184, v[72:75] offset:53248
    ds_write_b128 v184, v[76:79] offset:54272
    s_branch g2_fin
g2_sent:
    s_waitcnt vmcnt(0)
    v_mov_b32 v70, s49
    v_mov_b32 v71, 1
    s_mov_b64 exec, 1
    buffer_atomic_add v71, v70, s[4:7], 0 offen sc1
    s_mov_b64 exec, -1
g2_fin:
    s_waitcnt lgkmcnt(0)
    s_barrier
    buffer_load_dwordx4 v[124:127], v184, s[12:15], s45 offen offset:0 sc1
    buffer_load_dwordx4 v[128:131], v184, s[12:15], s45 offen offset:1024 sc1
    buffer_load_dwordx4 v[132:135], v184, s[12:15], s46 offen offset:0 sc1
    buffer_load_dwordx4 v[136:139], v184, s[12:15], s46 offen offset:1024 sc1
    buffer_load_dwordx4 v[140:143], v184, s[12:15], s47 offen offset:0 sc1
    buffer_load_dwordx4 v[144:147], v184, s[12:15], s47 offen offset:1024 sc1
    ds_read_b128 v[168:171], v188 offset:36864
    ds_read_b128 v[172:175], v188 offset:37888
    ds_read_b128 v[176:179], v188 offset:38912
    ds_read_b128 v[180:183], v188 offset:39936
    v_add_u32 v189, 139264, v188
    ds_read_b128 v[24:27], v189 offset:0
    ds_read_b128 v[28:31], v189 offset:1024
    ds_read_b128 v[32:35], v189 offset:2048
    ds_read_b128 v[36:39], v189 offset:3072
    s_waitcnt lgkmcnt(0)
    v_pk_add_f32 v[24:25], v[168:169], v[24:25]
    v_pk_add_f32 v[26:27], v[170:171], v[26:27]
    v_pk_add_f32 v[28:29], v[172:173], v[28:29]
    v_pk_add_f32 v[30:31], v[174:175], v[30:31]
    v_pk_add_f32 v[32:33], v[176:177], v[32:33]
    v_pk_add_f32 v[34:35], v[178:179], v[34:35]
    v_pk_add_f32 v[36:37], v[180:181], v[36:37]
    v_pk_add_f32 v[38:39], v[182:183], v[38:39]
    s_waitcnt vmcnt(4)
    v_lshlrev_b32 v8, 16, v124
    v_and_b32 v9, 0xffff0000, v124
    v_lshlrev_b32 v10, 16, v125
    v_and_b32 v11, 0xffff0000, v125
    v_lshlrev_b32 v12, 16, v126
    v_and_b32 v13, 0xffff0000, v126
    v_lshlrev_b32 v14, 16, v127
    v_and_b32 v15, 0xffff0000, v127
    v_lshlrev_b32 v16, 16, v128
    v_and_b32 v17, 0xffff0000, v128
    v_lshlrev_b32 v18, 16, v129
    v_and_b32 v19, 0xffff0000, v129
    v_lshlrev_b32 v20, 16, v130
    v_and_b32 v21, 0xffff0000, v130
    v_lshlrev_b32 v22, 16, v131
    v_and_b32 v23, 0xffff0000, v131
    v_pk_add_f32 v[24:25], v[24:25], v[8:9]
    v_pk_add_f32 v[26:27], v[26:27], v[10:11]
    v_pk_add_f32 v[28:29], v[28:29], v[12:13]
    v_pk_add_f32 v[30:31], v[30:31], v[14:15]
    v_pk_add_f32 v[32:33], v[32:33], v[16:17]
    v_pk_add_f32 v[34:35], v[34:35], v[18:19]
    v_pk_add_f32 v[36:37], v[36:37], v[20:21]
    v_pk_add_f32 v[38:39], v[38:39], v[22:23]
    s_waitcnt vmcnt(2)
    v_lshlrev_b32 v8, 16, v132
    v_and_b32 v9, 0xffff0000, v132
    v_lshlrev_b32 v10, 16, v133
    v_and_b32 v11, 0xffff0000, v133
    v_lshlrev_b32 v12, 16, v134
    v_and_b32 v13, 0xffff0000, v134
    v_lshlrev_b32 v14, 16, v135
    v_and_b32 v15, 0xffff0000, v135
    v_lshlrev_b32 v16, 16, v136
    v_and_b32 v17, 0xffff0000, v136
    v_lshlrev_b32 v18, 16, v137
    v_and_b32 v19, 0xffff0000, v137
    v_lshlrev_b32 v20, 16, v138
    v_and_b32 v21, 0xffff0000, v138
    v_lshlrev_b32 v22, 16, v139
    v_and_b32 v23, 0xffff0000, v139
    v_pk_add_f32 v[24:25], v[24:25], v[8:9]
    v_pk_add_f32 v[26:27], v[26:27], v[10:11]
    v_pk_add_f32 v[28:29], v[28:29], v[12:13]
    v_pk_add_f32 v[30:31], v[30:31], v[14:15]
    v_pk_add_f32 v[32:33], v[32:33], v[16:17]
    v_pk_add_f32 v[34:35], v[34:35], v[18:19]
    v_pk_add_f32 v[36:37], v[36:37], v[20:21]
    v_pk_add_f32 v[38:39], v[38:39], v[22:23]
    s_waitcnt vmcnt(0)
    v_lshlrev_b32 v8, 16, v140
    v_and_b32 v9, 0xffff0000, v140
    v_lshlrev_b32 v10, 16, v141
    v_and_b32 v11, 0xffff0000, v141
    v_lshlrev_b32 v12, 16, v142
    v_and_b32 v13, 0xffff0000, v142
    v_lshlrev_b32 v14, 16, v143
    v_and_b32 v15, 0xffff0000, v143
    v_lshlrev_b32 v16, 16, v144
    v_and_b32 v17, 0xffff0000, v144
    v_lshlrev_b32 v18, 16, v145
    v_and_b32 v19, 0xffff0000, v145
    v_lshlrev_b32 v20, 16, v146
    v_and_b32 v21, 0xffff0000, v146
    v_lshlrev_b32 v22, 16, v147
    v_and_b32 v23, 0xffff0000, v147
    v_pk_add_f32 v[24:25], v[24:25], v[8:9]
    v_pk_add_f32 v[26:27], v[26:27], v[10:11]
    v_pk_add_f32 v[28:29], v[28:29], v[12:13]
    v_pk_add_f32 v[30:31], v[30:31], v[14:15]
    v_pk_add_f32 v[32:33], v[32:33], v[16:17]
    v_pk_add_f32 v[34:35], v[34:35], v[18:19]
    v_pk_add_f32 v[36:37], v[36:37], v[20:21]
    v_pk_add_f32 v[38:39], v[38:39], v[22:23]
    v_cvt_pk_bf16_f32 v168, v24, v25
    v_cvt_pk_bf16_f32 v169, v26, v27
    v_cvt_pk_bf16_f32 v170, v32, v33
    v_cvt_pk_bf16_f32 v171, v34, v35
    buffer_store_dwordx4 v[168:171], v185, s[40:43], 0 offen
    v_cvt_pk_bf16_f32 v172, v28, v29
    v_cvt_pk_bf16_f32 v173, v30, v31
    v_cvt_pk_bf16_f32 v174, v36, v37
    v_cvt_pk_bf16_f32 v175, v38, v39
    buffer_store_dwordx4 v[172:175], v185, s[40:43], s44 offen
    s_endpgm
g2_l0:
    s_waitcnt vmcnt(0)
    v_lshlrev_b32 v164, 16, v164
    v_lshlrev_b32 v24, 16, v156
    v_and_b32 v25, 0xffff0000, v156
    v_add_f32 v24, v24, v164
    v_add_f32 v25, v25, v164
    v_lshlrev_b32 v26, 16, v157
    v_and_b32 v27, 0xffff0000, v157
    v_add_f32 v26, v26, v164
    v_add_f32 v27, v27, v164
    v_lshlrev_b32 v165, 16, v165
    v_lshlrev_b32 v28, 16, v160
    v_and_b32 v29, 0xffff0000, v160
    v_add_f32 v28, v28, v165
    v_add_f32 v29, v29, v165
    v_lshlrev_b32 v30, 16, v161
    v_and_b32 v31, 0xffff0000, v161
    v_add_f32 v30, v30, v165
    v_add_f32 v31, v31, v165
    v_lshlrev_b32 v166, 16, v148
    v_and_b32 v167, 0xffff0000, v148
    v_add_f32 v24, v24, v166
    v_add_f32 v28, v28, v167
    v_lshlrev_b32 v166, 16, v149
    v_and_b32 v167, 0xffff0000, v149
    v_add_f32 v25, v25, v166
    v_add_f32 v29, v29, v167
    v_lshlrev_b32 v166, 16, v150
    v_and_b32 v167, 0xffff0000, v150
    v_add_f32 v26, v26, v166
    v_add_f32 v30, v30, v167
    v_lshlrev_b32 v166, 16, v151
    v_and_b32 v167, 0xffff0000, v151
    v_add_f32 v27, v27, v166
    v_add_f32 v31, v31, v167
    v_mov_b32 v70, s23
    s_mov_b64 exec, 1
    s_mov_b32 s24, 0
g2x_p:
    buffer_load_dword v71, v70, s[4:7], 0 offen sc1
    s_add_u32 s24, s24, 1
    s_waitcnt vmcnt(0)
    v_readfirstlane_b32 s25, v71
    s_cmp_ge_u32 s24, 0x40000
    s_cbranch_scc1 g2x_g
    s_cmp_ge_u32 s25, 3
    s_cbranch_scc1 g2x_g
    s_branch g2x_p
g2x_g:
    s_mov_b64 exec, -1
    s_barrier
    buffer_load_dwordx4 v[124:127], v184, s[12:15], s45 offen offset:0 sc1
    buffer_load_dwordx4 v[132:135], v184, s[12:15], s46 offen offset:0 sc1
    buffer_load_dwordx4 v[140:143], v184, s[12:15], s47 offen offset:0 sc1
    ds_read_b128 v[168:171], v188 offset:36864
    ds_read_b128 v[172:175], v188 offset:37888
    s_waitcnt lgkmcnt(0)
    v_pk_add_f32 v[24:25], v[168:169], v[24:25]
    v_pk_add_f32 v[26:27], v[170:171], v[26:27]
    v_pk_add_f32 v[28:29], v[172:173], v[28:29]
    v_pk_add_f32 v[30:31], v[174:175], v[30:31]
    s_waitcnt vmcnt(2)
    v_lshlrev_b32 v8, 16, v124
    v_and_b32 v9, 0xffff0000, v124
    v_lshlrev_b32 v10, 16, v125
    v_and_b32 v11, 0xffff0000, v125
    v_lshlrev_b32 v12, 16, v126
    v_and_b32 v13, 0xffff0000, v126
    v_lshlrev_b32 v14, 16, v127
    v_and_b32 v15, 0xffff0000, v127
    v_pk_add_f32 v[24:25], v[24:25], v[8:9]
    v_pk_add_f32 v[26:27], v[26:27], v[10:11]
    v_pk_add_f32 v[28:29], v[28:29], v[12:13]
    v_pk_add_f32 v[30:31], v[30:31], v[14:15]
    s_waitcnt vmcnt(1)
    v_lshlrev_b32 v8, 16, v132
    v_and_b32 v9, 0xffff0000, v132
    v_lshlrev_b32 v10, 16, v133
    v_and_b32 v11, 0xffff0000, v133
    v_lshlrev_b32 v12, 16, v134
    v_and_b32 v13, 0xffff0000, v134
    v_lshlrev_b32 v14, 16, v135
    v_and_b32 v15, 0xffff0000, v135
    v_pk_add_f32 v[24:25], v[24:25], v[8:9]
    v_pk_add_f32 v[26:27], v[26:27], v[10:11]
    v_pk_add_f32 v[28:29], v[28:29], v[12:13]
    v_pk_add_f32 v[30:31], v[30:31], v[14:15]
    s_waitcnt vmcnt(0)
    v_lshlrev_b32 v8, 16, v140
    v_and_b32 v9, 0xffff0000, v140
    v_lshlrev_b32 v10, 16, v141
    v_and_b32 v11, 0xffff0000, v141
    v_lshlrev_b32 v12, 16, v142
    v_and_b32 v13, 0xffff0000, v142
    v_lshlrev_b32 v14, 16, v143
    v_and_b32 v15, 0xffff0000, v143
    v_pk_add_f32 v[24:25], v[24:25], v[8:9]
    v_pk_add_f32 v[26:27], v[26:27], v[10:11]
    v_pk_add_f32 v[28:29], v[28:29], v[12:13]
    v_pk_add_f32 v[30:31], v[30:31], v[14:15]
    v_cvt_pk_bf16_f32 v168, v24, v25
    v_cvt_pk_bf16_f32 v169, v26, v27
    buffer_store_dwordx2 v[168:169], v185, s[40:43], 0 offen
    v_cvt_pk_bf16_f32 v172, v28, v29
    v_cvt_pk_bf16_f32 v173, v30, v31
    buffer_store_dwordx2 v[172:173], v185, s[40:43], s44 offen
    s_endpgm
k2_end:
    s_endpgm
.section .rodata,"a"
.p2align 6
.amdhsa_kernel parallel_sum__ssm_conv_s4d__mixer_token_mlp__prompt_kernel
  .amdhsa_next_free_vgpr 208
  .amdhsa_next_free_sgpr 102
  .amdhsa_accum_offset 208
  .amdhsa_group_segment_fixed_size 0
  .amdhsa_kernarg_size 120
  .amdhsa_user_sgpr_count 2
  .amdhsa_user_sgpr_kernarg_segment_ptr 1
  .amdhsa_system_sgpr_workgroup_id_x 1
  .amdhsa_float_denorm_mode_32 3
.end_amdhsa_kernel
```
